```python
import torch

def _softmax(x, axis=-1):
    return torch.softmax(x, dim=axis)
def _gelu(x):
    return torch.nn.functional.gelu(x, approximate="tanh")
def _silu(x):
    return torch.nn.functional.silu(x)
def _sigmoid(x):
    return torch.sigmoid(x)
def _layernorm(x, axis=-1, eps=1e-5):
    m = x.mean(dim=axis, keepdim=True)
    v = x.var(dim=axis, keepdim=True, unbiased=False)
    return (x - m) / torch.sqrt(v + eps)
def _scatter_add(tgt, idx, src, axis=0):
    return tgt.clone().index_add_(axis, idx, src)
def _segment_sum(src, seg, n):
    out = torch.zeros((n,) + src.shape[1:], dtype=src.dtype)
    return out.index_add_(0, seg, src)
def _pad(x, pw):
    flat = tuple(v for pair in reversed(pw) for v in pair)
    return torch.nn.functional.pad(x, flat)

kernel_name = 'concat_heads__linear_attn_block__spectral_gfnet__prompt'

def setup_inputs():

    _w = (lambda a: (lambda t: t.to(torch.bfloat16) if t.is_floating_point() else t)(torch.as_tensor(a)))
    def _A_setup():
        B, S, D = 1, 2048, 512
        return {
            "x": _w((lambda *s: torch.randn(*s, dtype=torch.bfloat16) * 0.05)(B, S, D)),
            "wqkv": _w((lambda *s: torch.randn(*s, dtype=torch.bfloat16) * 0.4)(D, 3 * D)),
            "wo": _w((lambda *s: torch.randn(*s, dtype=torch.bfloat16) * 0.05)(D, D)),
        }
    _A_in = _A_setup()

    def _B_setup():
        B, S, D = 1, 2048, 512
        Df = D // 2 + 1
        return {
            "x": _w((lambda *s: torch.randn(*s, dtype=torch.bfloat16) * 0.05)(B, S, D)),
            "w_r": _w((lambda *s: torch.randn(*s, dtype=torch.bfloat16) * 1.6)(S, Df) * 0.02),
            "w_i": _w((lambda *s: torch.randn(*s, dtype=torch.bfloat16) * 1.6)(S, Df) * 0.02),
        }
    _B_in = _B_setup()

    return {
        "A_x": _A_in["x"],
        "A_wqkv": _A_in["wqkv"],
        "A_wo": _A_in["wo"],
        "B_x": _B_in["x"],
        "B_w_r": _B_in["w_r"],
        "B_w_i": _B_in["w_i"],
    }

def reference(A_x, A_wqkv, A_wo, B_x, B_w_r, B_w_i):
    def _A_ref(x, wqkv, wo):
        B, S, D = x.shape
        H = 32; Dh = D // H
        qkv = (lambda x, *d: x.permute(*d))((x @ wqkv).reshape(B, S, 3, H, Dh), 2, 0, 3, 1, 4)
        q, k, v = qkv[0], qkv[1], qkv[2]
        phi = lambda t: torch.where(t > 0, t + 1, torch.exp(t)) + 1e-6
        pq, pk = phi(q), phi(k)
        kv = torch.einsum("bhsd,bhse->bhde", pk, v)
        z = torch.einsum("bhsd->bhd", pk)
        num = torch.einsum("bhqd,bhde->bhqe", pq, kv)
        den = torch.einsum("bhqd,bhd->bhq", pq, z)[..., None] + 1e-6
        o = num / den
        return (lambda x, *d: x.permute(*d))(o, 0, 2, 1, 3).reshape(B, S, D) @ wo

    def _B_ref(x, w_r, w_i):
        B, S, D = x.shape
        X = (lambda x, axes=(-2,-1): torch.fft.rfft2(x.float(), dim=axes))(x, axes=(-2, -1))
        W = w_r + 1j * w_i
        X = X * W
        y = (lambda x, s, axes=(-2,-1): torch.fft.irfft2(x, s=s, dim=axes).to(torch.bfloat16))(X, (S, D), axes=(-2, -1))
        return y

    a = _A_ref(A_x, A_wqkv, A_wo)
    b = _B_ref(B_x, B_w_r, B_w_i)
    return torch.concatenate([a, b], axis=-1)
```

```asm
; @launch grid=(256,1,1) block=(512,1,1) lds=163840
.amdgcn_target "amdgcn-amd-amdhsa--gfx950"
.text
.globl concat_heads__linear_attn_block__spectral_gfnet__prompt_kernel
.p2align 8
.type concat_heads__linear_attn_block__spectral_gfnet__prompt_kernel,@function
concat_heads__linear_attn_block__spectral_gfnet__prompt_kernel:
CODE0:
    v_lshrrev_b32 v2, 6, v0
    v_and_b32 v1, 63, v0
    s_and_b32 s4, s2, 7
    v_readfirstlane_b32 s3, v2
    s_lshr_b32 s5, s2, 3
    s_cmp_ge_u32 s5, 32
    s_cbranch_scc1 EXIT
    s_sub_u32 s5, s5, 8
    s_cbranch_scc0 NOT_B
    s_load_dwordx2 s[44:45], s[0:1], 24
    s_getpc_b64 s[56:57]
PC_1:
    s_add_u32 s58, s56, TABLE-PC_1
    s_addc_u32 s59, s57, 0
    v_lshlrev_b32 v2, 4, v1
    s_mul_i32 s66, s3, 3072
    v_add_u32 v6, s66, v2
    v_mov_b32 v7, 0
    v_lshl_add_u64 v[6:7], v[6:7], 0, s[58:59]
    s_add_u32 m0, s66, 131072
    s_and_b32 s5, s5, 31
    global_load_lds_dwordx4 v[6:7], off offset:0
    global_load_lds_dwordx4 v[6:7], off offset:1024
    global_load_lds_dwordx4 v[6:7], off offset:2048
    s_and_b32 s61, s5, 7
    s_lshl3_add_u32 s60, s4, s61
    s_lshl_b32 s62, s3, 7
    s_add_u32 s62, s62, s60
    s_lshl_b32 s62, s62, 10
    s_add_u32 s63, s62, 0xffc00
    s_add_u32 s64, s62, 0xf800
    s_add_u32 s65, s62, 0x10f400
    s_lshl_b32 s70, s3, 12
    s_mov_b32 m0, s70
    s_mov_b32 s46, 0x200000
    s_mov_b32 s47, 0x20000
    s_waitcnt lgkmcnt(0)
    buffer_load_dwordx4 v2, s[44:47], s62 offen offset:0 nt lds
    buffer_load_dwordx4 v2, s[44:47], s63 offen offset:1024 nt lds
    buffer_load_dwordx4 v2, s[44:47], s64 offen offset:2048 nt lds
    buffer_load_dwordx4 v2, s[44:47], s65 offen offset:3072 nt lds
    s_cmp_ge_u32 s3, 1
    s_cbranch_scc1 ROLE_B
    s_add_u32 s56, s56, ROLE_B-PC_1
    s_addc_u32 s57, s57, 0
    s_mov_b32 s58, CODE_END-4-ROLE_B
    v_and_b32 v3, 15, v1
    v_lshlrev_b32 v3, 3, v3
    v_add_lshl_u32 v3, v3, s61, 7
    v_min_u32 v4, s58, v3
    v_mov_b32 v5, 0
    v_lshl_add_u64 v[4:5], v[4:5], 0, s[56:57]
    global_load_dword v0, v[4:5], off
    s_branch ROLE_B
EXIT:
    s_endpgm
NOT_B:
    s_cmp_ge_u32 s3, 4
    s_cbranch_scc1 LOADER
    s_cmp_lg_u32 s3, 0
    s_cbranch_scc1 COMPUTE
    s_getpc_b64 s[56:57]
PC_2:
    s_mov_b32 s58, ROLE_B-4-PC_2
    v_and_b32 v3, 7, v1
    v_mul_u32_u24_e64 v3, 24, v3
    v_add_lshl_u32 v3, v3, s5, 7
    v_min_u32 v4, s58, v3
    v_mov_b32 v5, 0
    v_lshl_add_u64 v[4:5], v[4:5], 0, s[56:57]
    global_load_dword v0, v[4:5], off
    s_branch COMPUTE
LOADER:
    s_load_dwordx4 s[44:47], s[0:1], 0
    s_lshr_b32 s60, s4, 1
    s_and_b32 s63, s5, 3
    s_lshl2_add_u32 s60, s60, s63
    s_bfe_u32 s65, s5, 0x20002
    s_lshr_b32 s66, s5, 4
    s_lshl_b32 s70, s65, s66
    s_add_u32 s70, s70, s63
    s_and_b32 s70, s70, 3
    s_and_b32 s71, s70, 1
    s_lshl_b32 s13, s4, 2
    s_xor_b32 s13, s13, s4
    s_and_b32 s13, s13, 4
    s_xor_b32 s70, s70, s13
    s_xor_b32 s71, s71, s13
    s_sub_u32 s58, s3, 4
    s_lshl2_add_u32 s63, s60, s58
    s_lshl_b32 s63, s63, 15
    v_lshrrev_b32 v2, 3, v1
    v_lshrrev_b32 v3, 4, v1
    v_and_b32 v12, 7, v1
    v_xor_b32_e64 v12, v12, v3
    v_lshl_add_u32 v12, v12, 4, s63
    v_lshl_add_u32 v4, v2, 10, v12
    v_xor_b32_e64 v5, 64, v4
    v_add_u32 v5, 0x1c00, v5
    v_add_u32 v6, 0x3800, v4
    v_add_u32 v7, 0x3800, v5
    s_lshl_b32 s59, s58, 12
    s_add_u32 m0, s59, 0
    s_xor_b32 s62, s70, 0
    s_lshl_b32 s63, s62, 7
    s_waitcnt lgkmcnt(0)
    s_mov_b64 s[48:49], s[46:47]
    s_mov_b32 s46, 0x200000
    s_mov_b32 s47, 0x20000
    buffer_load_dwordx4 v4, s[44:47], s63 offen offset:0 lds
    buffer_load_dwordx4 v5, s[44:47], s63 offen offset:1024 lds
    buffer_load_dwordx4 v6, s[44:47], s63 offen offset:2048 lds
    buffer_load_dwordx4 v7, s[44:47], s63 offen offset:3072 lds
    s_load_dwordx16 s[16:31], s[0:1], 0
    s_load_dwordx2 s[32:33], s[0:1], 64
    s_and_b32 s64, s4, 1
    s_lshl2_add_u32 s61, s64, s65
    s_lshl1_add_u32 s66, s64, s65
    s_lshl_b32 s63, s61, 7
    s_add_u32 s63, s63, 1024
    s_lshl_b32 s64, s66, 8
    s_cmp_ge_u32 s5, 16
    s_cselect_b32 s63, s64, s63
    s_cselect_b32 s64, 7, 10
    v_bfe_u32 v12, v1, 2, 2
    v_xor_b32 v12, v12, v3
    v_lshrrev_b32 v13, 1, v12
    v_lshlrev_b32 v13, s64, v13
    v_and_b32 v14, 1, v12
    v_lshl_add_u32 v13, v14, 6, v13
    v_and_b32_e64 v14, 3, v1
    v_lshl_add_u32 v13, v14, 4, v13
    v_mul_u32_u24 v15, 0xc00, v3
    s_mul_i32 s65, s58, 0xc000
    s_nop 0
    s_add_u32 s65, s65, s63
    v_add3_u32 v8, v13, v15, s65
    v_add_u32 v9, 0x2c00, v8
    v_add_u32 v10, 0x5800, v8
    v_add_u32 v11, 0x8400, v8
    s_mov_b32 s50, 0x180000
    s_mov_b32 s51, 0x20000
    s_add_u32 m0, s59, 16384
    s_mul_i32 s64, s62, 0x30000
    buffer_load_dwordx4 v8, s[48:51], s64 offen offset:0 lds
    buffer_load_dwordx4 v9, s[48:51], s64 offen offset:1024 lds
    buffer_load_dwordx4 v10, s[48:51], s64 offen offset:2048 lds
    buffer_load_dwordx4 v11, s[48:51], s64 offen offset:3072 lds
    s_add_u32 m0, s59, 32768
    s_xor_b32 s62, s70, 1
    s_lshl_b32 s63, s62, 7
    buffer_load_dwordx4 v4, s[44:47], s63 offen offset:0 lds
    buffer_load_dwordx4 v5, s[44:47], s63 offen offset:1024 lds
    buffer_load_dwordx4 v6, s[44:47], s63 offen offset:2048 lds
    buffer_load_dwordx4 v7, s[44:47], s63 offen offset:3072 lds
    s_nop 0
    s_waitcnt lgkmcnt(0)
    s_load_dwordx2 s[8:9], s[32:33], 0
    s_add_u32 m0, s59, 49152
    s_mul_i32 s64, s62, 0x30000
    buffer_load_dwordx4 v8, s[48:51], s64 offen offset:0 lds
    buffer_load_dwordx4 v9, s[48:51], s64 offen offset:1024 lds
    buffer_load_dwordx4 v10, s[48:51], s64 offen offset:2048 lds
    buffer_load_dwordx4 v11, s[48:51], s64 offen offset:3072 lds
    s_mov_b32 s36, s32
    s_mov_b32 s37, s33
    s_mov_b32 s38, 0x10000000
    s_mov_b32 s39, 0x20000
    s_mov_b32 s40, s28
    s_mov_b32 s41, s29
    s_mov_b32 s42, 0x400000
    s_mov_b32 s43, 0x20000
    s_waitcnt lgkmcnt(0)
    s_add_u32 s8, s8, 0x1e3779b1
    s_addc_u32 s9, s9, 0x5ebca6b
    s_and_b32 s6, s8, 0xbfffbfff
    s_and_b32 s7, s9, 0xbfffbfff
    s_bitcmp1_b32 s8, 0
    s_cselect_b32 s16, 0x10001, 0
    s_xor_b32 s17, s16, 0x10000
    s_xor_b32 s0, s16, 0x10001
    s_xor_b32 s1, s16, 1
    s_waitcnt vmcnt(8)
    s_barrier
    s_add_u32 m0, s59, 65536
    s_xor_b32 s62, s70, 2
    s_nop 0
    s_lshl_b32 s63, s62, 7
    buffer_load_dwordx4 v4, s[44:47], s63 offen offset:0 lds
    buffer_load_dwordx4 v5, s[44:47], s63 offen offset:1024 lds
    buffer_load_dwordx4 v6, s[44:47], s63 offen offset:2048 lds
    buffer_load_dwordx4 v7, s[44:47], s63 offen offset:3072 lds
    s_add_u32 m0, s59, 81920
    s_mul_i32 s64, s62, 0x30000
    buffer_load_dwordx4 v8, s[48:51], s64 offen offset:0 lds
    buffer_load_dwordx4 v9, s[48:51], s64 offen offset:1024 lds
    buffer_load_dwordx4 v10, s[48:51], s64 offen offset:2048 lds
    buffer_load_dwordx4 v11, s[48:51], s64 offen offset:3072 lds
    s_waitcnt vmcnt(8)
    s_barrier
    s_add_u32 m0, s59, 98304
    s_xor_b32 s62, s70, 3
    s_lshl_b32 s63, s62, 7
    buffer_load_dwordx4 v4, s[44:47], s63 offen offset:0 lds
    buffer_load_dwordx4 v5, s[44:47], s63 offen offset:1024 lds
    buffer_load_dwordx4 v6, s[44:47], s63 offen offset:2048 lds
    buffer_load_dwordx4 v7, s[44:47], s63 offen offset:3072 lds
    s_add_u32 m0, s59, 114688
    s_mul_i32 s64, s62, 0x30000
    buffer_load_dwordx4 v8, s[48:51], s64 offen offset:0 lds
    buffer_load_dwordx4 v9, s[48:51], s64 offen offset:1024 lds
    buffer_load_dwordx4 v10, s[48:51], s64 offen offset:2048 lds
    buffer_load_dwordx4 v11, s[48:51], s64 offen offset:3072 lds
    s_waitcnt vmcnt(8)
    s_barrier
    s_add_u32 m0, s59, 131072
    s_xor_b32 s62, s70, 4
    s_lshl_b32 s63, s62, 7
    buffer_load_dwordx4 v4, s[44:47], s63 offen offset:0 lds
    buffer_load_dwordx4 v5, s[44:47], s63 offen offset:1024 lds
    buffer_load_dwordx4 v6, s[44:47], s63 offen offset:2048 lds
    buffer_load_dwordx4 v7, s[44:47], s63 offen offset:3072 lds
    s_add_u32 m0, s59, 147456
    s_mul_i32 s64, s62, 0x30000
    buffer_load_dwordx4 v8, s[48:51], s64 offen offset:0 lds
    buffer_load_dwordx4 v9, s[48:51], s64 offen offset:1024 lds
    buffer_load_dwordx4 v10, s[48:51], s64 offen offset:2048 lds
    buffer_load_dwordx4 v11, s[48:51], s64 offen offset:3072 lds
    s_waitcnt vmcnt(8)
    s_barrier
    s_add_u32 m0, s59, 0
    s_xor_b32 s62, s70, 5
    s_nop 0
    s_lshl_b32 s63, s62, 7
    buffer_load_dwordx4 v4, s[44:47], s63 offen offset:0 lds
    buffer_load_dwordx4 v5, s[44:47], s63 offen offset:1024 lds
    buffer_load_dwordx4 v6, s[44:47], s63 offen offset:2048 lds
    buffer_load_dwordx4 v7, s[44:47], s63 offen offset:3072 lds
    s_add_u32 m0, s59, 16384
    s_mul_i32 s64, s62, 0x30000
    buffer_load_dwordx4 v8, s[48:51], s64 offen offset:0 lds
    buffer_load_dwordx4 v9, s[48:51], s64 offen offset:1024 lds
    buffer_load_dwordx4 v10, s[48:51], s64 offen offset:2048 lds
    buffer_load_dwordx4 v11, s[48:51], s64 offen offset:3072 lds
    s_waitcnt vmcnt(8)
    s_barrier
    s_add_u32 m0, s59, 32768
    s_xor_b32 s62, s70, 6
    s_lshl_b32 s63, s62, 7
    buffer_load_dwordx4 v4, s[44:47], s63 offen offset:0 lds
    buffer_load_dwordx4 v5, s[44:47], s63 offen offset:1024 lds
    buffer_load_dwordx4 v6, s[44:47], s63 offen offset:2048 lds
    buffer_load_dwordx4 v7, s[44:47], s63 offen offset:3072 lds
    s_add_u32 m0, s59, 49152
    s_mul_i32 s64, s62, 0x30000
    buffer_load_dwordx4 v8, s[48:51], s64 offen offset:0 lds
    buffer_load_dwordx4 v9, s[48:51], s64 offen offset:1024 lds
    buffer_load_dwordx4 v10, s[48:51], s64 offen offset:2048 lds
    buffer_load_dwordx4 v11, s[48:51], s64 offen offset:3072 lds
    s_waitcnt vmcnt(8)
    s_barrier
    s_add_u32 m0, s59, 65536
    s_xor_b32 s62, s70, 7
    s_lshl_b32 s63, s62, 7
    buffer_load_dwordx4 v4, s[44:47], s63 offen offset:0 lds
    buffer_load_dwordx4 v5, s[44:47], s63 offen offset:1024 lds
    buffer_load_dwordx4 v6, s[44:47], s63 offen offset:2048 lds
    buffer_load_dwordx4 v7, s[44:47], s63 offen offset:3072 lds
    s_add_u32 m0, s59, 81920
    s_mul_i32 s64, s62, 0x30000
    buffer_load_dwordx4 v8, s[48:51], s64 offen offset:0 lds
    buffer_load_dwordx4 v9, s[48:51], s64 offen offset:1024 lds
    buffer_load_dwordx4 v10, s[48:51], s64 offen offset:2048 lds
    buffer_load_dwordx4 v11, s[48:51], s64 offen offset:3072 lds
    s_cmp_ge_u32 s5, 16
    s_cbranch_scc1 QLOADER
    s_mov_b32 s52, s20
    s_mov_b32 s53, s21
    s_mov_b32 s54, 0x80000
    s_mov_b32 s55, 0x20000
    s_and_b32 s68, s5, 3
    s_lshl_b32 s69, s58, 13
    v_lshlrev_b32_e64 v16, 6, v12
    v_lshl_add_u32 v16, v14, 4, v16
    v_lshl_add_u32 v16, v3, 10, v16
    s_lshl_b32 s65, s58, 15
    s_lshr_b32 s14, s5, 2
    s_lshl_b32 s66, s14, 8
    s_add_u32 s65, s65, s66
    v_add_u32_e64 v16, s65, v16
    v_add_u32 v17, 0xc00, v16
    v_add_u32 v18, 0x1800, v16
    v_add_u32 v19, 0x2400, v16
    s_waitcnt vmcnt(8)
    s_barrier
    s_add_u32 m0, s69, 98304
    s_xor_b32 s63, s68, 0
    s_lshl_b32 s63, s63, 17
    buffer_load_dwordx4 v16, s[52:55], s63 offen offset:0 lds
    buffer_load_dwordx4 v17, s[52:55], s63 offen offset:1024 lds
    buffer_load_dwordx4 v18, s[52:55], s63 offen offset:2048 lds
    buffer_load_dwordx4 v19, s[52:55], s63 offen offset:3072 lds
    s_add_u32 m0, s69, 102400
    s_add_u32 s63, s63, 0x4000
    buffer_load_dwordx4 v16, s[52:55], s63 offen offset:0 lds
    buffer_load_dwordx4 v17, s[52:55], s63 offen offset:1024 lds
    buffer_load_dwordx4 v18, s[52:55], s63 offen offset:2048 lds
    buffer_load_dwordx4 v19, s[52:55], s63 offen offset:3072 lds
    s_waitcnt vmcnt(8)
    s_barrier
    s_add_u32 m0, s69, 131072
    s_xor_b32 s63, s68, 1
    s_lshl_b32 s63, s63, 17
    buffer_load_dwordx4 v16, s[52:55], s63 offen offset:0 lds
    buffer_load_dwordx4 v17, s[52:55], s63 offen offset:1024 lds
    buffer_load_dwordx4 v18, s[52:55], s63 offen offset:2048 lds
    buffer_load_dwordx4 v19, s[52:55], s63 offen offset:3072 lds
    s_add_u32 m0, s69, 135168
    s_add_u32 s63, s63, 0x4000
    buffer_load_dwordx4 v16, s[52:55], s63 offen offset:0 lds
    buffer_load_dwordx4 v17, s[52:55], s63 offen offset:1024 lds
    buffer_load_dwordx4 v18, s[52:55], s63 offen offset:2048 lds
    buffer_load_dwordx4 v19, s[52:55], s63 offen offset:3072 lds
    s_add_u32 m0, s69, 0
    s_xor_b32 s63, s68, 2
    s_nop 0
    s_lshl_b32 s63, s63, 17
    buffer_load_dwordx4 v16, s[52:55], s63 offen offset:0 lds
    buffer_load_dwordx4 v17, s[52:55], s63 offen offset:1024 lds
    buffer_load_dwordx4 v18, s[52:55], s63 offen offset:2048 lds
    buffer_load_dwordx4 v19, s[52:55], s63 offen offset:3072 lds
    s_add_u32 m0, s69, 4096
    s_add_u32 s63, s63, 0x4000
    buffer_load_dwordx4 v16, s[52:55], s63 offen offset:0 lds
    buffer_load_dwordx4 v17, s[52:55], s63 offen offset:1024 lds
    buffer_load_dwordx4 v18, s[52:55], s63 offen offset:2048 lds
    buffer_load_dwordx4 v19, s[52:55], s63 offen offset:3072 lds
WL_0:
    s_and_b32 s63, s3, 3
    v_bfe_u32 v14, v1, 2, 2
    v_lshrrev_b32 v15, 5, v1
    v_lshl_add_u32 v15, v15, 2, v14
    v_xor_b32 v14, s63, v14
    v_lshlrev_b32 v14, 6, v14
    v_lshl_add_u32 v14, v15, 8, v14
    v_and_b32_e64 v15, 1, v1
    v_lshl_add_u32 v14, v15, 5, v14
    v_bfe_u32 v15, v1, 4, 1
    v_lshl_add_u32 v14, v15, 4, v14
    v_bfe_u32 v15, v1, 1, 1
    v_lshl_add_u32 v14, v15, 3, v14
    v_add_u32 v15, 0x10000, v14
    v_add_u32 v0, 0x20000, v14
    v_lshlrev_b32 v2, 4, v1
    s_and_b32 s65, s5, 3
    s_lshl2_add_u32 s65, s4, s65
    s_lshl3_add_u32 s66, s65, s3
    s_lshl_b32 s67, s66, 13
    s_add_u32 s67, s67, 0x200000
    s_mul_i32 s70, s3, 2304
    s_mul_i32 s71, s4, 0x4800
    s_add_u32 s70, s70, s71
    s_add_u32 s70, s70, 0x10000
    s_add_u32 s71, s70, 1152
    v_lshrrev_b32 v8, 4, v1
    v_xor_b32 v8, 1, v8
    v_and_b32_e64 v9, 1, v1
    v_lshl_add_u32 v8, v8, 1, v9
    v_lshlrev_b32 v8, 4, v8
    s_lshl_b32 s63, s3, 12
    v_add_u32_e64 v13, s63, v2
    s_mov_b32 s10, 0xffff0000
    s_mov_b32 s11, 0xffff0000
    s_waitcnt vmcnt(0)
    s_barrier
    s_add_u32 m0, s69, 65536
    s_xor_b32 s63, s68, 3
    s_lshl_b32 s63, s63, 17
    buffer_load_dwordx4 v16, s[52:55], s63 offen offset:0 lds
    buffer_load_dwordx4 v17, s[52:55], s63 offen offset:1024 lds
    buffer_load_dwordx4 v18, s[52:55], s63 offen offset:2048 lds
    buffer_load_dwordx4 v19, s[52:55], s63 offen offset:3072 lds
    s_add_u32 m0, s69, 69632
    s_add_u32 s63, s63, 0x4000
    buffer_load_dwordx4 v16, s[52:55], s63 offen offset:0 lds
    buffer_load_dwordx4 v17, s[52:55], s63 offen offset:1024 lds
    buffer_load_dwordx4 v18, s[52:55], s63 offen offset:2048 lds
    buffer_load_dwordx4 v19, s[52:55], s63 offen offset:3072 lds
    ds_read_b64_tr_b16 v[128:129], v15 offset:32768
    ds_read_b64_tr_b16 v[130:131], v15 offset:34816
    ds_read_b64_tr_b16 v[132:133], v15 offset:36864
    ds_read_b64_tr_b16 v[134:135], v15 offset:38912
    ds_read_b64_tr_b16 v[136:137], v15 offset:40960
    ds_read_b64_tr_b16 v[138:139], v15 offset:43008
    ds_read_b64_tr_b16 v[140:141], v15 offset:45056
    ds_read_b64_tr_b16 v[142:143], v15 offset:47104
    ds_read_b64_tr_b16 v[144:145], v15 offset:49152
    ds_read_b64_tr_b16 v[146:147], v15 offset:51200
    ds_read_b64_tr_b16 v[148:149], v15 offset:53248
    ds_read_b64_tr_b16 v[150:151], v15 offset:55296
    ds_read_b64_tr_b16 v[152:153], v15 offset:57344
    ds_read_b64_tr_b16 v[154:155], v15 offset:59392
    ds_read_b64_tr_b16 v[156:157], v15 offset:61440
    ds_read_b64_tr_b16 v[158:159], v15 offset:63488
    ds_read_b64_tr_b16 v[160:161], v0 offset:0
    ds_read_b64_tr_b16 v[162:163], v0 offset:2048
    ds_read_b64_tr_b16 v[164:165], v0 offset:4096
    ds_read_b64_tr_b16 v[166:167], v0 offset:6144
    ds_read_b64_tr_b16 v[168:169], v0 offset:8192
    ds_read_b64_tr_b16 v[170:171], v0 offset:10240
    ds_read_b64_tr_b16 v[172:173], v0 offset:12288
    ds_read_b64_tr_b16 v[174:175], v0 offset:14336
    ds_read_b64_tr_b16 v[176:177], v0 offset:16384
    ds_read_b64_tr_b16 v[178:179], v0 offset:18432
    ds_read_b64_tr_b16 v[180:181], v0 offset:20480
    ds_read_b64_tr_b16 v[182:183], v0 offset:22528
    ds_read_b64_tr_b16 v[184:185], v0 offset:24576
    ds_read_b64_tr_b16 v[186:187], v0 offset:26624
    ds_read_b64_tr_b16 v[188:189], v0 offset:28672
    ds_read_b64_tr_b16 v[190:191], v0 offset:30720
    ds_read_b64_tr_b16 v[192:193], v14 offset:0
    ds_read_b64_tr_b16 v[194:195], v14 offset:2048
    ds_read_b64_tr_b16 v[196:197], v14 offset:4096
    ds_read_b64_tr_b16 v[198:199], v14 offset:6144
    ds_read_b64_tr_b16 v[200:201], v14 offset:8192
    ds_read_b64_tr_b16 v[202:203], v14 offset:10240
    ds_read_b64_tr_b16 v[204:205], v14 offset:12288
    ds_read_b64_tr_b16 v[206:207], v14 offset:14336
    ds_read_b64_tr_b16 v[208:209], v14 offset:16384
    ds_read_b64_tr_b16 v[210:211], v14 offset:18432
    ds_read_b64_tr_b16 v[212:213], v14 offset:20480
    ds_read_b64_tr_b16 v[214:215], v14 offset:22528
    ds_read_b64_tr_b16 v[216:217], v14 offset:24576
    ds_read_b64_tr_b16 v[218:219], v14 offset:26624
    ds_read_b64_tr_b16 v[220:221], v14 offset:28672
    ds_read_b64_tr_b16 v[222:223], v14 offset:30720
WL_1:
    s_branch KV_TAIL
QLOADER:
    s_lshl3_add_u32 s60, s4, s5
    s_sub_u32 s60, s60, 16
    s_lshr_b32 s61, s60, 2
    s_and_b32 s71, s60, 3
    s_lshl2_add_u32 s71, s58, s71
    s_mul_i32 s63, s61, 36864
    s_lshl_b32 s64, s71, 7
    s_add_u32 s63, s63, s64
    s_add_u32 s63, s63, 0x80000
    s_mul_i32 s67, s61, 1152
    s_add_u32 s67, s67, s64
    s_add_u32 s67, s67, 0x10000
    s_add_u32 s64, s63, 9216
    s_add_u32 s65, s63, 18432
    s_add_u32 s66, s63, 27648
    v_lshrrev_b32 v2, 3, v1
    v_and_b32 v3, 7, v1
    v_lshlrev_b32 v3, 4, v3
    v_mov_b32 v22, 1152
    v_mad_u32_u24 v20, v2, v22, v3
    v_mov_b32 v22, 0x4800
    v_mad_u32_u24 v21, v2, v22, v3
    v_and_b32 v2, 1, v1
    v_lshlrev_b32 v2, 4, v2
    v_mov_b32 v3, 0x3f80
    v_lshlrev_b32 v3, v2, v3
    v_and_b32 v2, 2, v1
    v_cmp_eq_u32 vcc, 0, v2
    v_mov_b32 v24, 0
    v_mov_b32 v25, 0
    v_mov_b32 v28, 0
    v_mov_b32 v29, 0
    v_cndmask_b32 v26, 0, v3, vcc
    v_cndmask_b32_e64 v27, v3, v25, vcc
    v_mov_b32 v32, 0xfffefffe
    v_mov_b32 v33, 0
    v_mov_b32 v34, 0
    v_mov_b32 v35, 0
    s_waitcnt vmcnt(8)
    s_barrier
    s_waitcnt vmcnt(0)
    s_barrier
    s_cmp_gt_u32 s71, 8
    s_cbranch_scc1 NOZ_3
    buffer_store_dwordx4 v[32:35], v21, s[36:39], s67 offen sc1
NOZ_3:
    s_getpc_b64 s[56:57]
PC_4:
    s_add_u32 s56, s56, TABLE-PC_4
    s_addc_u32 s57, s57, 0
    v_lshlrev_b32 v2, 4, v1
    v_add_u32 v4, s59, v2
    v_mov_b32 v5, 0
    v_lshl_add_u64 v[4:5], v[4:5], 0, s[56:57]
    s_add_u32 m0, s59, 131072
    s_nop 0
    global_load_lds_dwordx4 v[4:5], off offset:0
    global_load_lds_dwordx4 v[4:5], off offset:1024
    global_load_lds_dwordx4 v[4:5], off offset:2048
    global_load_lds_dwordx4 v[4:5], off offset:3072
    v_and_b32 v84, 7, v1
    v_lshlrev_b32_e64 v84, 6, v84
    s_add_u32 s62, s60, 512
    v_add_u32 v84, s62, v84
    v_cvt_f32_u32 v84, v84
    v_mul_f32 v84, 0x3a000000, v84
    s_lshr_b32 s62, s3, 1
    s_and_b32 s15, s3, 1
    s_lshl2_add_u32 s14, s62, s15
    s_lshl_b32 s14, s14, 1
    v_lshrrev_b32_e64 v85, 5, v1
    v_lshl_add_u32 v85, v85, 2, s14
    v_cvt_f32_u32_e64 v85, v85
    v_bfe_u32 v86, v1, 3, 1
    v_cvt_f32_u32_e64 v86, v86
    v_mul_f32 v86, 0xbe800000, v86
    v_fma_f32 v85, v85, v84, v86
    v_lshlrev_b32_e64 v86, 27, v1
    v_and_b32 v86, 0x80000000, v86
    v_or_b32 v86, 0x3e000000, v86
    v_add_f32 v87, v85, v86
    v_sub_f32 v86, v84, v86
    v_add_f32 v86, v85, v86
    v_cos_f32 v84, v87
    v_sin_f32 v87, v87
    v_cos_f32 v85, v86
    v_sin_f32 v86, v86
    s_lshl_b32 s62, s62, 10
    s_lshl3_add_u32 s62, s15, s62
    s_add_u32 s62, s62, 155648
    v_add_u32 v90, s62, v2
    v_cvt_pk_bf16_f32 v88, v84, -v87
    v_cvt_pk_bf16_f32 v89, v85, -v86
    ds_write_b64 v90, v[88:89]
    s_waitcnt vmcnt(0) lgkmcnt(0)
    s_barrier
    s_cmp_gt_u32 s71, 8
    s_cbranch_scc1 HELPER
WR_0:
    s_mov_b32 s12, 0x40000
POLL_6:
    buffer_load_dwordx4 v[40:43], v20, s[36:39], s63 offen sc1
    buffer_load_dwordx4 v[44:47], v20, s[36:39], s64 offen sc1
    buffer_load_dwordx4 v[48:51], v20, s[36:39], s65 offen sc1
    buffer_load_dwordx4 v[52:55], v20, s[36:39], s66 offen sc1
    s_waitcnt vmcnt(0)
    v_xor_b32 v40, s16, v40
    v_xor_b32_e64 v41, s1, v41
    v_bitop3_b32 v80, v40, v40, v41 bitop3:0xfd
    v_xor_b32 v42, s0, v42
    v_xor_b32 v43, s17, v43
    v_bitop3_b32 v80, v80, v42, v43 bitop3:0xfd
    v_xor_b32 v44, s16, v44
    v_xor_b32 v45, s1, v45
    v_bitop3_b32 v80, v80, v44, v45 bitop3:0xfd
    v_xor_b32 v46, s0, v46
    v_xor_b32 v47, s17, v47
    v_bitop3_b32 v80, v80, v46, v47 bitop3:0xfd
    v_xor_b32 v48, s16, v48
    v_xor_b32 v49, s1, v49
    v_bitop3_b32 v80, v80, v48, v49 bitop3:0xfd
    v_xor_b32 v50, s0, v50
    v_xor_b32 v51, s17, v51
    v_bitop3_b32 v80, v80, v50, v51 bitop3:0xfd
    v_xor_b32 v52, s16, v52
    v_xor_b32 v53, s1, v53
    v_bitop3_b32 v80, v80, v52, v53 bitop3:0xfd
    v_xor_b32 v54, s0, v54
    v_xor_b32 v55, s17, v55
    v_bitop3_b32 v80, v80, v54, v55 bitop3:0xfd
    v_and_b32 v80, 0x10001, v80
    v_cmp_ne_u32 vcc, 0, v80
    s_nop 0
    s_cbranch_vccz DONE_7
    s_sleep 2
    s_sub_u32 s12, s12, 1
    s_cbranch_scc0 POLL_6
DONE_7:
    v_mfma_f32_16x16x32_bf16 v[72:75], v[26:29], v[40:43], 0
    v_mfma_f32_16x16x32_bf16 v[76:79], v[24:27], v[40:43], 0
    v_mfma_f32_16x16x32_bf16 v[72:75], v[26:29], v[44:47], v[72:75]
    v_mfma_f32_16x16x32_bf16 v[76:79], v[24:27], v[44:47], v[76:79]
    v_mfma_f32_16x16x32_bf16 v[72:75], v[26:29], v[48:51], v[72:75]
    v_mfma_f32_16x16x32_bf16 v[76:79], v[24:27], v[48:51], v[76:79]
    v_mfma_f32_16x16x32_bf16 v[72:75], v[26:29], v[52:55], v[72:75]
    v_mfma_f32_16x16x32_bf16 v[76:79], v[24:27], v[52:55], v[76:79]
    s_nop 0
    s_nop 5
    v_add_f32_dpp v56, v72, v72 row_ror:8 row_mask:0xf bank_mask:0xf
    v_add_f32_dpp v57, v73, v73 row_ror:8 row_mask:0xf bank_mask:0xf
    v_add_f32_dpp v58, v74, v74 row_ror:8 row_mask:0xf bank_mask:0xf
    v_add_f32_dpp v59, v75, v75 row_ror:8 row_mask:0xf bank_mask:0xf
    v_add_f32_dpp v60, v76, v76 row_ror:8 row_mask:0xf bank_mask:0xf
    v_add_f32_dpp v61, v77, v77 row_ror:8 row_mask:0xf bank_mask:0xf
    v_add_f32_dpp v62, v78, v78 row_ror:8 row_mask:0xf bank_mask:0xf
    v_add_f32_dpp v63, v79, v79 row_ror:8 row_mask:0xf bank_mask:0xf
    v_cvt_pk_bf16_f32 v36, v56, v57
    v_cvt_pk_bf16_f32 v37, v58, v59
    v_cvt_pk_bf16_f32 v38, v60, v61
    v_cvt_pk_bf16_f32 v39, v62, v63
    v_and_or_b32 v36, v36, v32, s16
    v_and_or_b32 v37, v37, v32, s17
    v_and_or_b32 v38, v38, v32, s0
    v_and_or_b32 v39, v39, v32, s1
    buffer_store_dwordx4 v[36:39], v21, s[36:39], s67 offen sc1
WR_1:
    s_branch HELPER
COMPUTE:
    s_lshr_b32 s60, s4, 1
    s_and_b32 s68, s5, 3
    s_lshl2_add_u32 s60, s60, s68
    s_and_b32 s64, s4, 1
    s_bfe_u32 s65, s5, 0x20002
    s_lshl2_add_u32 s61, s64, s65
    s_lshl1_add_u32 s66, s64, s65
    s_lshr_b32 s63, s3, 1
    s_and_b32 s64, s3, 1
    s_lshr_b32 s67, s5, 4
    s_lshl_b32 s69, s64, s67
    s_movk_i32 s70, 128
    s_lshr_b32 s70, s70, s67
    s_cmp_ge_u32 s5, 16
    s_cselect_b32 s61, s66, s61
    s_mov_b32 s10, 0xffff0000
    s_mov_b32 s11, 0xffff0000
    s_load_dwordx16 s[16:31], s[0:1], 0
    s_load_dwordx2 s[32:33], s[0:1], 64
    v_and_b32 v2, 31, v1
    v_lshlrev_b32 v2, 7, v2
    s_lshl_b32 s65, s63, 13
    v_add_u32 v2, s65, v2
    v_lshrrev_b32 v3, 5, v1
    v_bfe_u32 v16, v1, 1, 3
    v_xor_b32_e64 v16, v16, v3
    v_lshl_add_u32 v240, v16, 4, v2
    v_xor_b32 v241, 32, v240
    v_xor_b32 v242, 64, v240
    v_xor_b32 v243, 96, v240
    v_bfe_u32 v16, v1, 2, 2
    v_lshl_add_u32 v17, v3, 3, v16
    v_xor_b32 v16, s69, v16
    v_lshlrev_b32 v16, 6, v16
    v_lshl_add_u32 v16, v17, 8, v16
    v_bfe_u32 v17, v1, 4, 1
    v_lshl_add_u32 v16, v17, 5, v16
    v_and_b32_e64 v17, 3, v1
    v_lshl_add_u32 v248, v17, 3, v16
    v_xor_b32_e64 v249, s70, v248
    v_add_u32 v244, 0x10000, v240
    v_add_u32 v252, 0x20000, v240
    v_add_u32 v245, 0x10000, v241
    v_add_u32 v253, 0x20000, v241
    v_add_u32 v246, 0x10000, v242
    v_add_u32 v254, 0x20000, v242
    v_add_u32 v247, 0x10000, v243
    v_add_u32 v255, 0x20000, v243
    v_add_u32 v250, 0x10000, v248
    v_add_u32 v251, 0x10000, v249
    v_add_u32 v146, 0x20000, v248
    v_add_u32 v147, 0x20000, v249
    s_waitcnt lgkmcnt(0)
    s_load_dwordx2 s[8:9], s[32:33], 0
    s_mov_b32 s36, s32
    s_mov_b32 s37, s33
    s_mov_b32 s38, 0x10000000
    s_mov_b32 s39, 0x20000
    s_mov_b32 s40, s28
    s_mov_b32 s41, s29
    s_mov_b32 s42, 0x400000
    s_mov_b32 s43, 0x20000
    s_mov_b32 s56, 0x3fb8aa3b
    s_mov_b32 s57, 0x3fb8aa3b
    s_mov_b32 s58, 0x358637bd
    v_lshlrev_b32 v2, 4, v1
    s_cmp_ge_u32 s5, 16
    s_cbranch_scc1 QCOMPUTE
    s_lshl1_add_u32 s59, s61, s64
    s_lshl_b32 s59, s59, 5
    s_lshl1_add_u32 s66, s60, s63
    s_add_u32 s59, s59, s66
    s_mul_i32 s59, s59, 1152
    s_add_u32 s59, s59, 0x80000
    v_mov_b32 v140, 0x3f803f80
    v_mov_b32 v141, 0x3f803f80
    v_mov_b32 v142, 0x3f803f80
    v_mov_b32 v143, 0x3f803f80
    buffer_store_dwordx4 v[140:143], v2, s[36:39], s59 offen sc1
    s_mov_b64 exec, 0xff
    buffer_store_dwordx4 v[140:143], v2, s[36:39], s59 offen offset:1024 sc1
    s_mov_b64 exec, -1
    v_lshrrev_b32 v3, 4, v1
    v_and_b32_e64 v145, 1, v1
    v_lshl_add_u32 v4, v3, 1, v145
    v_lshlrev_b32_e64 v144, 4, v4
    v_mov_b32 v145, 0xfffefffe
    s_mov_b32 s60, 0x00030003
    s_mov_b32 s61, 0x00030003
    v_lshlrev_b32 v2, 4, v1
    s_and_b32 s65, s5, 3
    s_lshl2_add_u32 s65, s4, s65
    s_lshl3_add_u32 s66, s65, s3
    s_lshl_b32 s67, s66, 13
    s_add_u32 s67, s67, 0x200000
    s_mul_i32 s70, s3, 2304
    s_mul_i32 s71, s4, 0x4800
    s_add_u32 s70, s70, s71
    s_add_u32 s70, s70, 0x10000
    s_add_u32 s71, s70, 1152
    v_lshrrev_b32 v8, 4, v1
    v_xor_b32 v8, 1, v8
    v_and_b32_e64 v9, 1, v1
    v_lshl_add_u32 v8, v8, 1, v9
    v_lshlrev_b32 v8, 4, v8
    s_lshl_b32 s63, s3, 12
    v_add_u32_e64 v13, s63, v2
    s_mov_b32 s10, 0xffff0000
    s_mov_b32 s11, 0xffff0000
    s_waitcnt lgkmcnt(0)
    s_add_u32 s8, s8, 0x1e3779b1
    s_addc_u32 s9, s9, 0x5ebca6b
    s_and_b32 s6, s8, 0xbfffbfff
    s_and_b32 s7, s9, 0xbfffbfff
    s_bitcmp1_b32 s8, 0
    s_cselect_b32 s16, 0x10001, 0
    s_xor_b32 s17, s16, 0x10000
    s_xor_b32 s0, s16, 0x10001
    s_xor_b32 s1, s16, 1
    s_barrier
    ds_read_b128 v[16:19], v240 offset:0
    ds_read_b64_tr_b16 v[20:21], v248 offset:16384
    ds_read_b64_tr_b16 v[22:23], v248 offset:17408
    ds_read_b128 v[24:27], v240 offset:4096
    ds_read_b64_tr_b16 v[28:29], v249 offset:16384
    ds_read_b64_tr_b16 v[30:31], v249 offset:17408
    ds_read_b128 v[32:35], v241 offset:0
    ds_read_b64_tr_b16 v[36:37], v248 offset:20480
    ds_read_b64_tr_b16 v[38:39], v248 offset:21504
    ds_read_b128 v[40:43], v241 offset:4096
    ds_read_b64_tr_b16 v[44:45], v249 offset:20480
    ds_read_b64_tr_b16 v[46:47], v249 offset:21504
    s_waitcnt lgkmcnt(9)
    v_mfma_f32_32x32x16_bf16 v[64:79], v[16:19], v[20:23], 0
    ds_read_b128 v[48:51], v242 offset:0
    ds_read_b64_tr_b16 v[52:53], v248 offset:24576
    s_waitcnt lgkmcnt(10)
    v_mfma_f32_32x32x16_bf16 v[80:95], v[24:27], v[20:23], 0
    ds_read_b64_tr_b16 v[54:55], v248 offset:25600
    ds_read_b128 v[56:59], v242 offset:4096
    s_nop 0
    s_waitcnt lgkmcnt(10)
    v_mfma_f32_32x32x16_bf16 v[96:111], v[16:19], v[28:31], 0
    ds_read_b64_tr_b16 v[60:61], v249 offset:24576
    ds_read_b64_tr_b16 v[62:63], v249 offset:25600
    v_mfma_f32_32x32x16_bf16 v[112:127], v[24:27], v[28:31], 0
    ds_read_b128 v[148:151], v243 offset:0
    ds_read_b64_tr_b16 v[152:153], v248 offset:28672
    s_waitcnt lgkmcnt(11)
    v_mfma_f32_32x32x16_bf16 v[64:79], v[32:35], v[36:39], v[64:79]
    ds_read_b64_tr_b16 v[154:155], v248 offset:29696
    ds_read_b128 v[156:159], v243 offset:4096
    s_waitcnt lgkmcnt(12)
    v_mfma_f32_32x32x16_bf16 v[80:95], v[40:43], v[36:39], v[80:95]
    ds_read_b64_tr_b16 v[160:161], v249 offset:28672
    ds_read_b64_tr_b16 v[162:163], v249 offset:29696
    s_waitcnt lgkmcnt(12)
    v_mfma_f32_32x32x16_bf16 v[96:111], v[32:35], v[44:47], v[96:111]
    s_barrier
    ds_read_b128 v[164:167], v240 offset:32768
    ds_read_b64_tr_b16 v[168:169], v248 offset:49152
    v_mfma_f32_32x32x16_bf16 v[112:127], v[40:43], v[44:47], v[112:127]
    s_waitcnt lgkmcnt(11)
    v_mfma_f32_32x32x16_bf16 v[64:79], v[48:51], v[52:55], v[64:79]
    ds_read_b64_tr_b16 v[170:171], v248 offset:50176
    ds_read_b128 v[172:175], v240 offset:36864
    s_waitcnt lgkmcnt(12)
    v_mfma_f32_32x32x16_bf16 v[80:95], v[56:59], v[52:55], v[80:95]
    ds_read_b64_tr_b16 v[176:177], v249 offset:49152
    ds_read_b64_tr_b16 v[178:179], v249 offset:50176
    s_waitcnt lgkmcnt(12)
    v_mfma_f32_32x32x16_bf16 v[96:111], v[48:51], v[60:63], v[96:111]
    ds_read_b128 v[220:223], v241 offset:32768
    ds_read_b64_tr_b16 v[224:225], v248 offset:53248
    v_mfma_f32_32x32x16_bf16 v[112:127], v[56:59], v[60:63], v[112:127]
    s_waitcnt lgkmcnt(11)
    v_mfma_f32_32x32x16_bf16 v[64:79], v[148:151], v[152:155], v[64:79]
    ds_read_b64_tr_b16 v[226:227], v248 offset:54272
    ds_read_b128 v[228:231], v241 offset:36864
    s_waitcnt lgkmcnt(12)
    v_mfma_f32_32x32x16_bf16 v[80:95], v[156:159], v[152:155], v[80:95]
    ds_read_b64_tr_b16 v[232:233], v249 offset:53248
    ds_read_b64_tr_b16 v[234:235], v249 offset:54272
    s_waitcnt lgkmcnt(12)
    v_mfma_f32_32x32x16_bf16 v[96:111], v[148:151], v[160:163], v[96:111]
    ds_read_b128 v[236:239], v242 offset:32768
    ds_read_b64_tr_b16 v[20:21], v248 offset:57344
    v_mfma_f32_32x32x16_bf16 v[112:127], v[156:159], v[160:163], v[112:127]
    s_waitcnt lgkmcnt(11)
    v_mfma_f32_32x32x16_bf16 v[64:79], v[164:167], v[168:171], v[64:79]
    ds_read_b64_tr_b16 v[22:23], v248 offset:58368
    ds_read_b128 v[16:19], v242 offset:36864
    s_waitcnt lgkmcnt(12)
    v_mfma_f32_32x32x16_bf16 v[80:95], v[172:175], v[168:171], v[80:95]
    ds_read_b64_tr_b16 v[24:25], v249 offset:57344
    ds_read_b64_tr_b16 v[26:27], v249 offset:58368
    s_waitcnt lgkmcnt(12)
    v_mfma_f32_32x32x16_bf16 v[96:111], v[164:167], v[176:179], v[96:111]
    ds_read_b128 v[28:31], v243 offset:32768
    ds_read_b64_tr_b16 v[36:37], v248 offset:61440
    v_mfma_f32_32x32x16_bf16 v[112:127], v[172:175], v[176:179], v[112:127]
    s_waitcnt lgkmcnt(11)
    v_mfma_f32_32x32x16_bf16 v[64:79], v[220:223], v[224:227], v[64:79]
    ds_read_b64_tr_b16 v[38:39], v248 offset:62464
    ds_read_b128 v[32:35], v243 offset:36864
    s_waitcnt lgkmcnt(12)
    v_mfma_f32_32x32x16_bf16 v[80:95], v[228:231], v[224:227], v[80:95]
    ds_read_b64_tr_b16 v[40:41], v249 offset:61440
    ds_read_b64_tr_b16 v[42:43], v249 offset:62464
    s_waitcnt lgkmcnt(12)
    v_mfma_f32_32x32x16_bf16 v[96:111], v[220:223], v[232:235], v[96:111]
    s_barrier
    ds_read_b128 v[44:47], v244 offset:0
    ds_read_b64_tr_b16 v[52:53], v250 offset:16384
    v_mfma_f32_32x32x16_bf16 v[112:127], v[228:231], v[232:235], v[112:127]
    s_waitcnt lgkmcnt(11)
    v_mfma_f32_32x32x16_bf16 v[64:79], v[236:239], v[20:23], v[64:79]
    ds_read_b64_tr_b16 v[54:55], v250 offset:17408
    ds_read_b128 v[48:51], v244 offset:4096
    s_waitcnt lgkmcnt(12)
    v_mfma_f32_32x32x16_bf16 v[80:95], v[16:19], v[20:23], v[80:95]
    ds_read_b64_tr_b16 v[56:57], v251 offset:16384
    ds_read_b64_tr_b16 v[58:59], v251 offset:17408
    s_waitcnt lgkmcnt(12)
    v_mfma_f32_32x32x16_bf16 v[96:111], v[236:239], v[24:27], v[96:111]
    ds_read_b128 v[60:63], v245 offset:0
    ds_read_b64_tr_b16 v[152:153], v250 offset:20480
    v_mfma_f32_32x32x16_bf16 v[112:127], v[16:19], v[24:27], v[112:127]
    s_waitcnt lgkmcnt(11)
    v_mfma_f32_32x32x16_bf16 v[64:79], v[28:31], v[36:39], v[64:79]
    ds_read_b64_tr_b16 v[154:155], v250 offset:21504
    ds_read_b128 v[148:151], v245 offset:4096
    s_waitcnt lgkmcnt(12)
    v_mfma_f32_32x32x16_bf16 v[80:95], v[32:35], v[36:39], v[80:95]
    ds_read_b64_tr_b16 v[156:157], v251 offset:20480
    ds_read_b64_tr_b16 v[158:159], v251 offset:21504
    s_waitcnt lgkmcnt(12)
    v_mfma_f32_32x32x16_bf16 v[96:111], v[28:31], v[40:43], v[96:111]
    ds_read_b128 v[160:163], v246 offset:0
    ds_read_b64_tr_b16 v[168:169], v250 offset:24576
    v_mfma_f32_32x32x16_bf16 v[112:127], v[32:35], v[40:43], v[112:127]
    s_waitcnt lgkmcnt(11)
    v_mfma_f32_32x32x16_bf16 v[64:79], v[44:47], v[52:55], v[64:79]
    ds_read_b64_tr_b16 v[170:171], v250 offset:25600
    ds_read_b128 v[164:167], v246 offset:4096
    s_waitcnt lgkmcnt(12)
    v_mfma_f32_32x32x16_bf16 v[80:95], v[48:51], v[52:55], v[80:95]
    ds_read_b64_tr_b16 v[172:173], v251 offset:24576
    ds_read_b64_tr_b16 v[174:175], v251 offset:25600
    s_waitcnt lgkmcnt(12)
    v_mfma_f32_32x32x16_bf16 v[96:111], v[44:47], v[56:59], v[96:111]
    ds_read_b128 v[176:179], v247 offset:0
    ds_read_b64_tr_b16 v[224:225], v250 offset:28672
    v_mfma_f32_32x32x16_bf16 v[112:127], v[48:51], v[56:59], v[112:127]
    s_waitcnt lgkmcnt(11)
    v_mfma_f32_32x32x16_bf16 v[64:79], v[60:63], v[152:155], v[64:79]
    ds_read_b64_tr_b16 v[226:227], v250 offset:29696
    ds_read_b128 v[220:223], v247 offset:4096
    s_waitcnt lgkmcnt(12)
    v_mfma_f32_32x32x16_bf16 v[80:95], v[148:151], v[152:155], v[80:95]
    ds_read_b64_tr_b16 v[228:229], v251 offset:28672
    ds_read_b64_tr_b16 v[230:231], v251 offset:29696
    s_waitcnt lgkmcnt(12)
    v_mfma_f32_32x32x16_bf16 v[96:111], v[60:63], v[156:159], v[96:111]
    s_barrier
    ds_read_b128 v[232:235], v244 offset:32768
    ds_read_b64_tr_b16 v[20:21], v250 offset:49152
    v_mfma_f32_32x32x16_bf16 v[112:127], v[148:151], v[156:159], v[112:127]
    s_waitcnt lgkmcnt(11)
    v_mfma_f32_32x32x16_bf16 v[64:79], v[160:163], v[168:171], v[64:79]
    ds_read_b64_tr_b16 v[22:23], v250 offset:50176
    ds_read_b128 v[236:239], v244 offset:36864
    s_waitcnt lgkmcnt(12)
    v_mfma_f32_32x32x16_bf16 v[80:95], v[164:167], v[168:171], v[80:95]
    ds_read_b64_tr_b16 v[16:17], v251 offset:49152
    ds_read_b64_tr_b16 v[18:19], v251 offset:50176
    s_waitcnt lgkmcnt(12)
    v_mfma_f32_32x32x16_bf16 v[96:111], v[160:163], v[172:175], v[96:111]
    ds_read_b128 v[24:27], v245 offset:32768
    ds_read_b64_tr_b16 v[36:37], v250 offset:53248
    v_mfma_f32_32x32x16_bf16 v[112:127], v[164:167], v[172:175], v[112:127]
    s_waitcnt lgkmcnt(11)
    v_mfma_f32_32x32x16_bf16 v[64:79], v[176:179], v[224:227], v[64:79]
    ds_read_b64_tr_b16 v[38:39], v250 offset:54272
    ds_read_b128 v[28:31], v245 offset:36864
    s_waitcnt lgkmcnt(12)
    v_mfma_f32_32x32x16_bf16 v[80:95], v[220:223], v[224:227], v[80:95]
    ds_read_b64_tr_b16 v[32:33], v251 offset:53248
    ds_read_b64_tr_b16 v[34:35], v251 offset:54272
    s_waitcnt lgkmcnt(12)
    v_mfma_f32_32x32x16_bf16 v[96:111], v[176:179], v[228:231], v[96:111]
    ds_read_b128 v[40:43], v246 offset:32768
    ds_read_b64_tr_b16 v[52:53], v250 offset:57344
    v_mfma_f32_32x32x16_bf16 v[112:127], v[220:223], v[228:231], v[112:127]
    s_waitcnt lgkmcnt(11)
    v_mfma_f32_32x32x16_bf16 v[64:79], v[232:235], v[20:23], v[64:79]
    ds_read_b64_tr_b16 v[54:55], v250 offset:58368
    ds_read_b128 v[44:47], v246 offset:36864
    s_waitcnt lgkmcnt(12)
    v_mfma_f32_32x32x16_bf16 v[80:95], v[236:239], v[20:23], v[80:95]
    ds_read_b64_tr_b16 v[48:49], v251 offset:57344
    ds_read_b64_tr_b16 v[50:51], v251 offset:58368
    s_waitcnt lgkmcnt(12)
    v_mfma_f32_32x32x16_bf16 v[96:111], v[232:235], v[16:19], v[96:111]
    ds_read_b128 v[56:59], v247 offset:32768
    ds_read_b64_tr_b16 v[152:153], v250 offset:61440
    v_mfma_f32_32x32x16_bf16 v[112:127], v[236:239], v[16:19], v[112:127]
    s_waitcnt lgkmcnt(11)
    v_mfma_f32_32x32x16_bf16 v[64:79], v[24:27], v[36:39], v[64:79]
    ds_read_b64_tr_b16 v[154:155], v250 offset:62464
    ds_read_b128 v[60:63], v247 offset:36864
    s_waitcnt lgkmcnt(12)
    v_mfma_f32_32x32x16_bf16 v[80:95], v[28:31], v[36:39], v[80:95]
    ds_read_b64_tr_b16 v[148:149], v251 offset:61440
    ds_read_b64_tr_b16 v[150:151], v251 offset:62464
    s_waitcnt lgkmcnt(12)
    v_mfma_f32_32x32x16_bf16 v[96:111], v[24:27], v[32:35], v[96:111]
    s_barrier
    ds_read_b128 v[156:159], v252 offset:0
    ds_read_b64_tr_b16 v[168:169], v146 offset:16384
    v_mfma_f32_32x32x16_bf16 v[112:127], v[28:31], v[32:35], v[112:127]
    s_waitcnt lgkmcnt(11)
    v_mfma_f32_32x32x16_bf16 v[64:79], v[40:43], v[52:55], v[64:79]
    ds_read_b64_tr_b16 v[170:171], v146 offset:17408
    ds_read_b128 v[160:163], v252 offset:4096
    s_waitcnt lgkmcnt(12)
    v_mfma_f32_32x32x16_bf16 v[80:95], v[44:47], v[52:55], v[80:95]
    ds_read_b64_tr_b16 v[164:165], v147 offset:16384
    ds_read_b64_tr_b16 v[166:167], v147 offset:17408
    s_waitcnt lgkmcnt(12)
    v_mfma_f32_32x32x16_bf16 v[96:111], v[40:43], v[48:51], v[96:111]
    ds_read_b128 v[172:175], v253 offset:0
    ds_read_b64_tr_b16 v[224:225], v146 offset:20480
    v_mfma_f32_32x32x16_bf16 v[112:127], v[44:47], v[48:51], v[112:127]
    s_waitcnt lgkmcnt(11)
    v_mfma_f32_32x32x16_bf16 v[64:79], v[56:59], v[152:155], v[64:79]
    ds_read_b64_tr_b16 v[226:227], v146 offset:21504
    ds_read_b128 v[176:179], v253 offset:4096
    s_waitcnt lgkmcnt(12)
    v_mfma_f32_32x32x16_bf16 v[80:95], v[60:63], v[152:155], v[80:95]
    ds_read_b64_tr_b16 v[220:221], v147 offset:20480
    ds_read_b64_tr_b16 v[222:223], v147 offset:21504
    s_waitcnt lgkmcnt(12)
    v_mfma_f32_32x32x16_bf16 v[96:111], v[56:59], v[148:151], v[96:111]
    ds_read_b128 v[228:231], v254 offset:0
    ds_read_b64_tr_b16 v[20:21], v146 offset:24576
    v_mfma_f32_32x32x16_bf16 v[112:127], v[60:63], v[148:151], v[112:127]
    s_waitcnt lgkmcnt(11)
    v_mfma_f32_32x32x16_bf16 v[64:79], v[156:159], v[168:171], v[64:79]
    ds_read_b64_tr_b16 v[22:23], v146 offset:25600
    ds_read_b128 v[232:235], v254 offset:4096
    s_waitcnt lgkmcnt(12)
    v_mfma_f32_32x32x16_bf16 v[80:95], v[160:163], v[168:171], v[80:95]
    ds_read_b64_tr_b16 v[236:237], v147 offset:24576
    ds_read_b64_tr_b16 v[238:239], v147 offset:25600
    s_waitcnt lgkmcnt(12)
    v_mfma_f32_32x32x16_bf16 v[96:111], v[156:159], v[164:167], v[96:111]
    ds_read_b128 v[16:19], v255 offset:0
    ds_read_b64_tr_b16 v[36:37], v146 offset:28672
    v_mfma_f32_32x32x16_bf16 v[112:127], v[160:163], v[164:167], v[112:127]
    s_waitcnt lgkmcnt(11)
    v_mfma_f32_32x32x16_bf16 v[64:79], v[172:175], v[224:227], v[64:79]
    ds_read_b64_tr_b16 v[38:39], v146 offset:29696
    ds_read_b128 v[24:27], v255 offset:4096
    s_waitcnt lgkmcnt(12)
    v_mfma_f32_32x32x16_bf16 v[80:95], v[176:179], v[224:227], v[80:95]
    ds_read_b64_tr_b16 v[28:29], v147 offset:28672
    ds_read_b64_tr_b16 v[30:31], v147 offset:29696
    s_waitcnt lgkmcnt(12)
    v_mfma_f32_32x32x16_bf16 v[96:111], v[172:175], v[220:223], v[96:111]
    s_barrier
    ds_read_b128 v[32:35], v240 offset:0
    ds_read_b64_tr_b16 v[52:53], v248 offset:16384
    v_mfma_f32_32x32x16_bf16 v[112:127], v[176:179], v[220:223], v[112:127]
    s_waitcnt lgkmcnt(11)
    v_mfma_f32_32x32x16_bf16 v[64:79], v[228:231], v[20:23], v[64:79]
    ds_read_b64_tr_b16 v[54:55], v248 offset:17408
    ds_read_b128 v[40:43], v240 offset:4096
    s_waitcnt lgkmcnt(12)
    v_mfma_f32_32x32x16_bf16 v[80:95], v[232:235], v[20:23], v[80:95]
    ds_read_b64_tr_b16 v[44:45], v249 offset:16384
    ds_read_b64_tr_b16 v[46:47], v249 offset:17408
    s_waitcnt lgkmcnt(12)
    v_mfma_f32_32x32x16_bf16 v[96:111], v[228:231], v[236:239], v[96:111]
    ds_read_b128 v[48:51], v241 offset:0
    ds_read_b64_tr_b16 v[152:153], v248 offset:20480
    v_mfma_f32_32x32x16_bf16 v[112:127], v[232:235], v[236:239], v[112:127]
    s_waitcnt lgkmcnt(11)
    v_mfma_f32_32x32x16_bf16 v[64:79], v[16:19], v[36:39], v[64:79]
    ds_read_b64_tr_b16 v[154:155], v248 offset:21504
    ds_read_b128 v[56:59], v241 offset:4096
    s_waitcnt lgkmcnt(12)
    v_mfma_f32_32x32x16_bf16 v[80:95], v[24:27], v[36:39], v[80:95]
    ds_read_b64_tr_b16 v[60:61], v249 offset:20480
    ds_read_b64_tr_b16 v[62:63], v249 offset:21504
    s_waitcnt lgkmcnt(12)
    v_mfma_f32_32x32x16_bf16 v[96:111], v[16:19], v[28:31], v[96:111]
    ds_read_b128 v[148:151], v242 offset:0
    ds_read_b64_tr_b16 v[168:169], v248 offset:24576
    v_mfma_f32_32x32x16_bf16 v[112:127], v[24:27], v[28:31], v[112:127]
    s_waitcnt lgkmcnt(11)
    v_mfma_f32_32x32x16_bf16 v[64:79], v[32:35], v[52:55], v[64:79]
    ds_read_b64_tr_b16 v[170:171], v248 offset:25600
    ds_read_b128 v[156:159], v242 offset:4096
    s_waitcnt lgkmcnt(12)
    v_mfma_f32_32x32x16_bf16 v[80:95], v[40:43], v[52:55], v[80:95]
    ds_read_b64_tr_b16 v[160:161], v249 offset:24576
    ds_read_b64_tr_b16 v[162:163], v249 offset:25600
    s_waitcnt lgkmcnt(12)
    v_mfma_f32_32x32x16_bf16 v[96:111], v[32:35], v[44:47], v[96:111]
    ds_read_b128 v[164:167], v243 offset:0
    ds_read_b64_tr_b16 v[224:225], v248 offset:28672
    v_mfma_f32_32x32x16_bf16 v[112:127], v[40:43], v[44:47], v[112:127]
    s_waitcnt lgkmcnt(11)
    v_mfma_f32_32x32x16_bf16 v[64:79], v[48:51], v[152:155], v[64:79]
    ds_read_b64_tr_b16 v[226:227], v248 offset:29696
    ds_read_b128 v[172:175], v243 offset:4096
    s_waitcnt lgkmcnt(12)
    v_mfma_f32_32x32x16_bf16 v[80:95], v[56:59], v[152:155], v[80:95]
    ds_read_b64_tr_b16 v[176:177], v249 offset:28672
    ds_read_b64_tr_b16 v[178:179], v249 offset:29696
    s_waitcnt lgkmcnt(12)
    v_mfma_f32_32x32x16_bf16 v[96:111], v[48:51], v[60:63], v[96:111]
    s_barrier
    ds_read_b128 v[220:223], v240 offset:32768
    ds_read_b64_tr_b16 v[20:21], v248 offset:49152
    v_mfma_f32_32x32x16_bf16 v[112:127], v[56:59], v[60:63], v[112:127]
    s_waitcnt lgkmcnt(11)
    v_mfma_f32_32x32x16_bf16 v[64:79], v[148:151], v[168:171], v[64:79]
    ds_read_b64_tr_b16 v[22:23], v248 offset:50176
    ds_read_b128 v[228:231], v240 offset:36864
    s_waitcnt lgkmcnt(12)
    v_mfma_f32_32x32x16_bf16 v[80:95], v[156:159], v[168:171], v[80:95]
    ds_read_b64_tr_b16 v[232:233], v249 offset:49152
    ds_read_b64_tr_b16 v[234:235], v249 offset:50176
    s_waitcnt lgkmcnt(12)
    v_mfma_f32_32x32x16_bf16 v[96:111], v[148:151], v[160:163], v[96:111]
    ds_read_b128 v[236:239], v241 offset:32768
    ds_read_b64_tr_b16 v[36:37], v248 offset:53248
    v_mfma_f32_32x32x16_bf16 v[112:127], v[156:159], v[160:163], v[112:127]
    s_waitcnt lgkmcnt(11)
    v_mfma_f32_32x32x16_bf16 v[64:79], v[164:167], v[224:227], v[64:79]
    ds_read_b64_tr_b16 v[38:39], v248 offset:54272
    ds_read_b128 v[16:19], v241 offset:36864
    s_waitcnt lgkmcnt(12)
    v_mfma_f32_32x32x16_bf16 v[80:95], v[172:175], v[224:227], v[80:95]
    ds_read_b64_tr_b16 v[24:25], v249 offset:53248
    ds_read_b64_tr_b16 v[26:27], v249 offset:54272
    s_waitcnt lgkmcnt(12)
    v_mfma_f32_32x32x16_bf16 v[96:111], v[164:167], v[176:179], v[96:111]
    ds_read_b128 v[28:31], v242 offset:32768
    ds_read_b64_tr_b16 v[52:53], v248 offset:57344
    v_mfma_f32_32x32x16_bf16 v[112:127], v[172:175], v[176:179], v[112:127]
    s_waitcnt lgkmcnt(11)
    v_mfma_f32_32x32x16_bf16 v[64:79], v[220:223], v[20:23], v[64:79]
    ds_read_b64_tr_b16 v[54:55], v248 offset:58368
    ds_read_b128 v[32:35], v242 offset:36864
    s_waitcnt lgkmcnt(12)
    v_mfma_f32_32x32x16_bf16 v[80:95], v[228:231], v[20:23], v[80:95]
    ds_read_b128 v[40:43], v243 offset:32768
    ds_read_b64_tr_b16 v[44:45], v248 offset:61440
    s_waitcnt lgkmcnt(12)
    v_mfma_f32_32x32x16_bf16 v[96:111], v[220:223], v[232:235], v[96:111]
    ds_read_b64_tr_b16 v[46:47], v248 offset:62464
    ds_read_b128 v[152:155], v243 offset:36864
    v_mfma_f32_32x32x16_bf16 v[112:127], v[228:231], v[232:235], v[112:127]
    s_waitcnt lgkmcnt(11)
    v_mfma_f32_32x32x16_bf16 v[64:79], v[236:239], v[36:39], v[64:79]
    s_waitcnt vmcnt(0)
    s_barrier
    ds_read_b128 v[48:51], v244 offset:0
    ds_read_b64_tr_b16 v[56:57], v250 offset:16384
    s_waitcnt lgkmcnt(12)
    v_mfma_f32_32x32x16_bf16 v[80:95], v[16:19], v[36:39], v[80:95]
    ds_read_b64_tr_b16 v[58:59], v250 offset:17408
    ds_read_b128 v[60:63], v244 offset:4096
    s_waitcnt lgkmcnt(12)
    v_mfma_f32_32x32x16_bf16 v[96:111], v[236:239], v[24:27], v[96:111]
    ds_read_b128 v[168:171], v245 offset:0
    ds_read_b64_tr_b16 v[148:149], v250 offset:20480
    v_mfma_f32_32x32x16_bf16 v[112:127], v[16:19], v[24:27], v[112:127]
    s_waitcnt lgkmcnt(11)
    v_mfma_f32_32x32x16_bf16 v[64:79], v[28:31], v[52:55], v[64:79]
    ds_read_b64_tr_b16 v[150:151], v250 offset:21504
    ds_read_b128 v[156:159], v245 offset:4096
    s_waitcnt lgkmcnt(12)
    v_mfma_f32_32x32x16_bf16 v[80:95], v[32:35], v[52:55], v[80:95]
    ds_read_b128 v[160:163], v246 offset:0
    ds_read_b64_tr_b16 v[224:225], v250 offset:24576
    s_waitcnt lgkmcnt(11)
    v_mfma_f32_32x32x16_bf16 v[64:79], v[40:43], v[44:47], v[64:79]
    ds_read_b64_tr_b16 v[226:227], v250 offset:25600
    ds_read_b128 v[164:167], v246 offset:4096
    s_waitcnt lgkmcnt(12)
    v_mfma_f32_32x32x16_bf16 v[80:95], v[152:155], v[44:47], v[80:95]
    ds_read_b128 v[172:175], v247 offset:0
    ds_read_b64_tr_b16 v[176:177], v250 offset:28672
    s_waitcnt lgkmcnt(11)
    v_mfma_f32_32x32x16_bf16 v[64:79], v[48:51], v[56:59], v[64:79]
    ds_read_b64_tr_b16 v[178:179], v250 offset:29696
    ds_read_b128 v[20:23], v247 offset:4096
    s_waitcnt lgkmcnt(12)
    v_mfma_f32_32x32x16_bf16 v[80:95], v[60:63], v[56:59], v[80:95]
    ds_read_b64_tr_b16 v[220:221], v249 offset:57344
    ds_read_b64_tr_b16 v[222:223], v249 offset:58368
    s_waitcnt lgkmcnt(11)
    v_mfma_f32_32x32x16_bf16 v[64:79], v[168:171], v[148:151], v[64:79]
    ds_read_b64_tr_b16 v[228:229], v249 offset:61440
    ds_read_b64_tr_b16 v[230:231], v249 offset:62464
    s_waitcnt lgkmcnt(12)
    v_mfma_f32_32x32x16_bf16 v[80:95], v[156:159], v[148:151], v[80:95]
    ds_read_b64_tr_b16 v[232:233], v251 offset:16384
    ds_read_b64_tr_b16 v[234:235], v251 offset:17408
    s_waitcnt lgkmcnt(11)
    v_mfma_f32_32x32x16_bf16 v[64:79], v[160:163], v[224:227], v[64:79]
    ds_read_b64_tr_b16 v[36:37], v251 offset:20480
    ds_read_b64_tr_b16 v[38:39], v251 offset:21504
    s_waitcnt lgkmcnt(12)
    v_mfma_f32_32x32x16_bf16 v[80:95], v[164:167], v[224:227], v[80:95]
    ds_read_b64_tr_b16 v[236:237], v251 offset:24576
    ds_read_b64_tr_b16 v[238:239], v251 offset:25600
    s_waitcnt lgkmcnt(11)
    v_mfma_f32_32x32x16_bf16 v[64:79], v[172:175], v[176:179], v[64:79]
    ds_read_b64_tr_b16 v[16:17], v251 offset:28672
    ds_read_b64_tr_b16 v[18:19], v251 offset:29696
    s_waitcnt lgkmcnt(12)
    v_mfma_f32_32x32x16_bf16 v[80:95], v[20:23], v[176:179], v[80:95]
    s_waitcnt lgkmcnt(10)
    v_mfma_f32_32x32x16_bf16 v[96:111], v[28:31], v[220:223], v[96:111]
WA_0:
    v_mfma_f32_32x32x16_bf16 v[112:127], v[32:35], v[220:223], v[112:127]
    s_nop 0
    s_nop 3
    v_mul_f32_e64 v212, v64, s56
    v_mul_f32_e64 v213, v65, s57
    v_mul_f32_e64 v214, v66, s56
    v_mul_f32_e64 v215, v67, s57
    v_mul_f32_e64 v216, v68, s56
    v_mul_f32_e64 v217, v69, s57
    s_waitcnt lgkmcnt(8)
    v_mfma_f32_32x32x16_bf16 v[96:111], v[40:43], v[228:231], v[96:111]
    v_mul_f32_e64 v218, v70, s56
    v_mul_f32_e64 v219, v71, s57
    v_exp_f32_e64 v212, v212 clamp
    v_max_f32 v64, s58, v64
    v_mfma_f32_32x32x16_bf16 v[112:127], v[152:155], v[228:231], v[112:127]
    v_exp_f32_e64 v213, v213 clamp
    v_max_f32_e64 v65, s58, v65
    v_exp_f32_e64 v214, v214 clamp
    v_max_f32 v66, s58, v66
    s_waitcnt lgkmcnt(6)
    v_mfma_f32_32x32x16_bf16 v[96:111], v[48:51], v[232:235], v[96:111]
    v_exp_f32_e64 v215, v215 clamp
    v_max_f32_e64 v67, s58, v67
    v_exp_f32_e64 v216, v216 clamp
    v_max_f32_e64 v68, s58, v68
    v_mfma_f32_32x32x16_bf16 v[112:127], v[60:63], v[232:235], v[112:127]
    v_exp_f32_e64 v217, v217 clamp
    v_max_f32_e64 v69, s58, v69
    v_exp_f32_e64 v218, v218 clamp
    v_max_f32 v70, s58, v70
    s_waitcnt lgkmcnt(4)
    v_mfma_f32_32x32x16_bf16 v[96:111], v[168:171], v[36:39], v[96:111]
    v_exp_f32_e64 v219, v219 clamp
    v_max_f32_e64 v71, s58, v71
    v_add_f32_e64 v212, v212, v64
    v_add_f32_e64 v213, v213, v65
    v_add_f32_e64 v214, v214, v66
    v_mfma_f32_32x32x16_bf16 v[112:127], v[156:159], v[36:39], v[112:127]
    v_add_f32_e64 v215, v215, v67
    v_add_f32_e64 v216, v216, v68
    v_add_f32_e64 v217, v217, v69
    v_add_f32_e64 v218, v218, v70
    v_add_f32_e64 v219, v219, v71
    v_cvt_pk_bf16_f32 v180, v212, v213
    s_nop 0
    s_waitcnt lgkmcnt(2)
    v_mfma_f32_32x32x16_bf16 v[96:111], v[160:163], v[236:239], v[96:111]
    v_cvt_pk_bf16_f32 v181, v214, v215
    v_cvt_pk_bf16_f32 v182, v216, v217
    v_cvt_pk_bf16_f32 v183, v218, v219
    v_mul_f32_e64 v212, v72, s56
    v_mul_f32_e64 v213, v73, s57
    v_mul_f32_e64 v214, v74, s56
    v_mfma_f32_32x32x16_bf16 v[112:127], v[164:167], v[236:239], v[112:127]
    v_mul_f32_e64 v215, v75, s57
    v_mul_f32_e64 v216, v76, s56
    v_mul_f32_e64 v217, v77, s57
    v_mul_f32_e64 v218, v78, s56
    v_mul_f32_e64 v219, v79, s57
    s_waitcnt lgkmcnt(0)
    v_mfma_f32_32x32x16_bf16 v[96:111], v[172:175], v[16:19], v[96:111]
    v_exp_f32_e64 v212, v212 clamp
    v_max_f32 v72, s58, v72
    v_exp_f32_e64 v213, v213 clamp
    v_max_f32_e64 v73, s58, v73
    v_mfma_f32_32x32x16_bf16 v[112:127], v[20:23], v[16:19], v[112:127]
    v_exp_f32_e64 v214, v214 clamp
    v_max_f32_e64 v74, s58, v74
    v_exp_f32_e64 v215, v215 clamp
    v_max_f32_e64 v75, s58, v75
    v_mfma_f32_32x32x16_bf16 v[164:179], v[180:183], v[140:143], 0
    v_exp_f32_e64 v216, v216 clamp
    v_max_f32_e64 v76, s58, v76
    v_exp_f32_e64 v217, v217 clamp
    v_max_f32_e64 v77, s58, v77
    v_exp_f32_e64 v218, v218 clamp
    v_max_f32_e64 v78, s58, v78
    v_exp_f32_e64 v219, v219 clamp
    v_max_f32_e64 v79, s58, v79
    v_pk_add_f32 v[212:213], v[212:213], v[72:73]
    v_pk_add_f32 v[214:215], v[214:215], v[74:75]
    v_pk_add_f32 v[216:217], v[216:217], v[76:77]
    v_pk_add_f32 v[218:219], v[218:219], v[78:79]
    v_cvt_pk_bf16_f32 v184, v212, v213
    v_cvt_pk_bf16_f32 v185, v214, v215
    v_cvt_pk_bf16_f32 v186, v216, v217
    v_cvt_pk_bf16_f32 v187, v218, v219
    v_pk_mul_f32 v[212:213], v[80:81], s[56:57]
    v_pk_mul_f32 v[214:215], v[82:83], s[56:57]
    v_pk_mul_f32 v[216:217], v[84:85], s[56:57]
    v_pk_mul_f32 v[218:219], v[86:87], s[56:57]
    v_cvt_pk_bf16_f32 v196, v96, v97
    v_cvt_pk_bf16_f32 v197, v98, v99
    v_cvt_pk_bf16_f32 v198, v100, v101
    v_cvt_pk_bf16_f32 v199, v102, v103
    s_nop 0
    s_nop 0
    v_mfma_f32_32x32x16_bf16 v[148:163], v[180:183], v[196:199], 0
    v_exp_f32_e64 v212, v212 clamp
    v_max_f32_e64 v80, s58, v80
    v_exp_f32_e64 v213, v213 clamp
    v_max_f32_e64 v81, s58, v81
    v_exp_f32_e64 v214, v214 clamp
    v_mfma_f32_32x32x16_bf16 v[164:179], v[184:187], v[140:143], v[164:179]
    v_max_f32_e64 v82, s58, v82
    v_exp_f32_e64 v215, v215 clamp
    v_max_f32_e64 v83, s58, v83
    v_exp_f32_e64 v216, v216 clamp
    v_max_f32_e64 v84, s58, v84
    v_cvt_pk_bf16_f32 v200, v104, v105
    v_cvt_pk_bf16_f32 v201, v106, v107
    v_cvt_pk_bf16_f32 v202, v108, v109
    v_cvt_pk_bf16_f32 v203, v110, v111
    s_nop 0
    s_nop 0
    v_mfma_f32_32x32x16_bf16 v[148:163], v[184:187], v[200:203], v[148:163]
    v_exp_f32_e64 v217, v217 clamp
    v_max_f32_e64 v85, s58, v85
    v_exp_f32_e64 v218, v218 clamp
    v_max_f32_e64 v86, s58, v86
    v_exp_f32_e64 v219, v219 clamp
    v_max_f32_e64 v87, s58, v87
    v_pk_add_f32 v[212:213], v[212:213], v[80:81]
    v_pk_add_f32 v[214:215], v[214:215], v[82:83]
    v_pk_add_f32 v[216:217], v[216:217], v[84:85]
    v_pk_add_f32 v[218:219], v[218:219], v[86:87]
    v_cvt_pk_bf16_f32 v188, v212, v213
    v_cvt_pk_bf16_f32 v189, v214, v215
    v_cvt_pk_bf16_f32 v190, v216, v217
    v_cvt_pk_bf16_f32 v191, v218, v219
    v_pk_mul_f32 v[212:213], v[88:89], s[56:57]
    v_pk_mul_f32 v[214:215], v[90:91], s[56:57]
    v_pk_mul_f32 v[216:217], v[92:93], s[56:57]
    v_pk_mul_f32 v[218:219], v[94:95], s[56:57]
    v_mfma_f32_32x32x16_bf16 v[164:179], v[188:191], v[140:143], v[164:179]
    v_exp_f32_e64 v212, v212 clamp
    v_max_f32_e64 v88, s58, v88
    v_exp_f32_e64 v213, v213 clamp
    v_max_f32_e64 v89, s58, v89
    v_exp_f32_e64 v214, v214 clamp
    v_cvt_pk_bf16_f32 v204, v112, v113
    v_cvt_pk_bf16_f32 v205, v114, v115
    v_cvt_pk_bf16_f32 v206, v116, v117
    v_cvt_pk_bf16_f32 v207, v118, v119
    s_nop 0
    s_nop 0
    v_mfma_f32_32x32x16_bf16 v[148:163], v[188:191], v[204:207], v[148:163]
    v_max_f32_e64 v90, s58, v90
    v_exp_f32_e64 v215, v215 clamp
    v_max_f32_e64 v91, s58, v91
    v_exp_f32_e64 v216, v216 clamp
    v_max_f32_e64 v92, s58, v92
    v_exp_f32_e64 v217, v217 clamp
    v_max_f32_e64 v93, s58, v93
    v_exp_f32_e64 v218, v218 clamp
    v_max_f32_e64 v94, s58, v94
    v_exp_f32_e64 v219, v219 clamp
    v_max_f32_e64 v95, s58, v95
    v_pk_add_f32 v[212:213], v[212:213], v[88:89]
    v_pk_add_f32 v[214:215], v[214:215], v[90:91]
    v_pk_add_f32 v[216:217], v[216:217], v[92:93]
    v_pk_add_f32 v[218:219], v[218:219], v[94:95]
    v_cvt_pk_bf16_f32 v192, v212, v213
    v_cvt_pk_bf16_f32 v193, v214, v215
    v_cvt_pk_bf16_f32 v194, v216, v217
    v_cvt_pk_bf16_f32 v195, v218, v219
    v_cvt_pk_bf16_f32 v208, v120, v121
    v_cvt_pk_bf16_f32 v209, v122, v123
    v_cvt_pk_bf16_f32 v210, v124, v125
    v_cvt_pk_bf16_f32 v211, v126, v127
    v_mfma_f32_32x32x16_bf16 v[164:179], v[192:195], v[140:143], v[164:179]
    s_nop 0
    v_mfma_f32_32x32x16_bf16 v[148:163], v[192:195], v[208:211], v[148:163]
    s_nop 9
    v_cvt_pk_bf16_f32 v136, v164, v165
    v_cvt_pk_bf16_f32 v137, v166, v167
    v_cvt_pk_bf16_f32 v138, v168, v169
    v_cvt_pk_bf16_f32 v139, v170, v171
    s_mov_b64 exec, s[10:11]
    v_cvt_pk_bf16_f32 v136, v172, v173
    v_cvt_pk_bf16_f32 v137, v174, v175
    v_cvt_pk_bf16_f32 v138, v176, v177
    v_cvt_pk_bf16_f32 v139, v178, v179
    s_mov_b64 exec, s[60:61]
    v_and_or_b32 v136, v136, v145, s16
    v_and_or_b32 v137, v137, v145, s17
    v_and_or_b32 v138, v138, v145, s0
    v_and_or_b32 v139, v139, v145, s1
    buffer_store_dwordx4 v[136:139], v144, s[36:39], s59 offen offset:1024 sc1
    s_mov_b64 exec, -1
    v_cvt_pk_bf16_f32 v128, v148, v149
    v_cvt_pk_bf16_f32 v129, v150, v151
    v_cvt_pk_bf16_f32 v130, v152, v153
    v_cvt_pk_bf16_f32 v131, v154, v155
    s_mov_b64 exec, s[10:11]
    v_cvt_pk_bf16_f32 v128, v156, v157
    v_cvt_pk_bf16_f32 v129, v158, v159
    v_cvt_pk_bf16_f32 v130, v160, v161
    v_cvt_pk_bf16_f32 v131, v162, v163
    s_mov_b64 exec, -1
    v_and_or_b32 v128, v128, v145, s16
    v_and_or_b32 v129, v129, v145, s17
    v_and_or_b32 v130, v130, v145, s0
    v_and_or_b32 v131, v131, v145, s1
    buffer_store_dwordx4 v[128:131], v2, s[36:39], s59 offen sc1
    s_barrier
KV_TAIL:
    s_waitcnt vmcnt(0)
    s_add_u32 s68, s67, 0x1000
    s_mov_b32 s62, s67
    s_mov_b32 s58, 0x358637bd
    buffer_load_dwordx4 v[16:19], v2, s[36:39], s62 offen offset:0 sc1
    buffer_load_dwordx4 v[20:23], v2, s[36:39], s62 offen offset:1024 sc1
    buffer_load_dwordx4 v[24:27], v2, s[36:39], s62 offen offset:2048 sc1
    buffer_load_dwordx4 v[28:31], v2, s[36:39], s62 offen offset:3072 sc1
    s_waitcnt lgkmcnt(0)
    s_barrier
    buffer_load_dwordx4 v[32:35], v2, s[36:39], s68 offen offset:0 sc1
    buffer_load_dwordx4 v[36:39], v2, s[36:39], s68 offen offset:1024 sc1
    buffer_load_dwordx4 v[40:43], v2, s[36:39], s68 offen offset:2048 sc1
    buffer_load_dwordx4 v[44:47], v2, s[36:39], s68 offen offset:3072 sc1
    s_cmp_lt_u32 s3, 4
    s_cbranch_scc1 NOWO_9
    ds_read_b64_tr_b16 v[224:225], v15 offset:0
    ds_read_b64_tr_b16 v[226:227], v15 offset:2048
    ds_read_b64_tr_b16 v[228:229], v15 offset:4096
    ds_read_b64_tr_b16 v[230:231], v15 offset:6144
    ds_read_b64_tr_b16 v[232:233], v15 offset:8192
    ds_read_b64_tr_b16 v[234:235], v15 offset:10240
    ds_read_b64_tr_b16 v[236:237], v15 offset:12288
    ds_read_b64_tr_b16 v[238:239], v15 offset:14336
    ds_read_b64_tr_b16 v[240:241], v15 offset:16384
    ds_read_b64_tr_b16 v[242:243], v15 offset:18432
    ds_read_b64_tr_b16 v[244:245], v15 offset:20480
    ds_read_b64_tr_b16 v[246:247], v15 offset:22528
    ds_read_b64_tr_b16 v[248:249], v15 offset:24576
    ds_read_b64_tr_b16 v[250:251], v15 offset:26624
    ds_read_b64_tr_b16 v[252:253], v15 offset:28672
    ds_read_b64_tr_b16 v[254:255], v15 offset:30720
NOWO_9:
    s_mov_b32 s12, 0x40000
    s_nop 0
    s_branch CHK_12
POLL_10:
    buffer_load_dwordx4 v[16:19], v2, s[36:39], s62 offen offset:0 sc1
    buffer_load_dwordx4 v[20:23], v2, s[36:39], s62 offen offset:1024 sc1
    buffer_load_dwordx4 v[24:27], v2, s[36:39], s62 offen offset:2048 sc1
    buffer_load_dwordx4 v[28:31], v2, s[36:39], s62 offen offset:3072 sc1
    buffer_load_dwordx4 v[32:35], v2, s[36:39], s68 offen offset:0 sc1
    buffer_load_dwordx4 v[36:39], v2, s[36:39], s68 offen offset:1024 sc1
    buffer_load_dwordx4 v[40:43], v2, s[36:39], s68 offen offset:2048 sc1
    buffer_load_dwordx4 v[44:47], v2, s[36:39], s68 offen offset:3072 sc1
CHK_12:
    s_waitcnt vmcnt(0)
    v_xor_b32 v16, s16, v16
    v_xor_b32_e64 v17, s1, v17
    v_bitop3_b32 v12, v16, v16, v17 bitop3:0xfd
    v_xor_b32 v18, s0, v18
    v_xor_b32 v19, s17, v19
    v_bitop3_b32 v12, v12, v18, v19 bitop3:0xfd
    v_xor_b32 v20, s16, v20
    v_xor_b32 v21, s1, v21
    v_bitop3_b32 v12, v12, v20, v21 bitop3:0xfd
    v_xor_b32 v22, s0, v22
    v_xor_b32 v23, s17, v23
    v_bitop3_b32 v12, v12, v22, v23 bitop3:0xfd
    v_xor_b32 v24, s16, v24
    v_xor_b32 v25, s1, v25
    v_bitop3_b32 v12, v12, v24, v25 bitop3:0xfd
    v_xor_b32 v26, s0, v26
    v_xor_b32 v27, s17, v27
    v_bitop3_b32 v12, v12, v26, v27 bitop3:0xfd
    v_xor_b32 v28, s16, v28
    v_xor_b32 v29, s1, v29
    v_bitop3_b32 v12, v12, v28, v29 bitop3:0xfd
    v_xor_b32 v30, s0, v30
    v_xor_b32 v31, s17, v31
    v_bitop3_b32 v12, v12, v30, v31 bitop3:0xfd
    v_xor_b32 v32, s16, v32
    v_xor_b32 v33, s1, v33
    v_bitop3_b32 v12, v12, v32, v33 bitop3:0xfd
    v_xor_b32 v34, s0, v34
    v_xor_b32 v35, s17, v35
    v_bitop3_b32 v12, v12, v34, v35 bitop3:0xfd
    v_xor_b32 v36, s16, v36
    v_xor_b32 v37, s1, v37
    v_bitop3_b32 v12, v12, v36, v37 bitop3:0xfd
    v_xor_b32 v38, s0, v38
    v_xor_b32 v39, s17, v39
    v_bitop3_b32 v12, v12, v38, v39 bitop3:0xfd
    v_xor_b32 v40, s16, v40
    v_xor_b32 v41, s1, v41
    v_bitop3_b32 v12, v12, v40, v41 bitop3:0xfd
    v_xor_b32 v42, s0, v42
    v_xor_b32 v43, s17, v43
    v_bitop3_b32 v12, v12, v42, v43 bitop3:0xfd
    v_xor_b32 v44, s16, v44
    v_xor_b32 v45, s1, v45
    v_bitop3_b32 v12, v12, v44, v45 bitop3:0xfd
    v_xor_b32 v46, s0, v46
    v_xor_b32 v47, s17, v47
    v_bitop3_b32 v12, v12, v46, v47 bitop3:0xfd
    v_and_b32 v12, 0x10001, v12
    v_cmp_ne_u32 vcc, 0, v12
    s_nop 0
    s_cbranch_vccz DONE_11
    s_sleep 2
    s_sub_u32 s12, s12, 1
    s_cbranch_scc0 POLL_10
DONE_11:
    s_lshl_b32 s63, s5, 13
    s_and_b32 s64, s63, 0x6000
    s_add_u32 s64, s64, 0
    v_add_u32 v13, 0, v13
    v_add_u32 v4, s64, v2
    v_xor_b32 v5, 0x2000, v4
    v_xor_b32 v6, 0x4000, v4
    v_xor_b32 v7, 0x6000, v4
    s_lshl_b32 s69, s3, 12
    s_add_u32 s69, s69, 0x14000
    v_and_b32 v10, 31, v1
    v_bfe_u32 v14, v1, 1, 2
    v_lshrrev_b32 v15, 5, v1
    v_lshlrev_b32 v15, 1, v15
    v_xor_b32 v14, v14, v15
    v_lshlrev_b32 v14, 4, v14
    v_lshl_add_u32 v10, v10, 6, v14
    v_add_u32 v10, s69, v10
    v_xor_b32 v14, 16, v10
    v_bfe_u32 v15, v1, 3, 2
    v_lshlrev_b32 v15, 4, v15
    v_xor_b32 v15, v15, v2
    v_add_u32 v15, s69, v15
    v_lshrrev_b32 v3, 2, v1
    v_and_b32 v11, 3, v1
    v_lshlrev_b32 v11, 4, v11
    v_lshl_add_u32 v3, v3, 11, v11
    s_lshl_b32 s65, s65, 17
    s_and_b32 s64, s3, 3
    s_lshl2_add_u32 s69, s14, s64
    s_lshl_b32 s69, s69, 6
    s_add_u32 s64, s65, s69
    s_add_u32 s65, s64, 0x8000
    s_add_u32 s66, s64, 0x10000
    s_add_u32 s67, s64, 0x18000
    s_barrier
    s_mov_b32 s12, 0x40000
POLL_13:
    buffer_load_dwordx4 v[48:51], v2, s[36:39], s70 offen offset:0 sc1
    buffer_load_dwordx4 v[52:55], v8, s[36:39], s70 offen offset:1024 sc1
    buffer_load_dwordx4 v[56:59], v2, s[36:39], s70 offen offset:1152 sc1
    buffer_load_dwordx4 v[60:63], v8, s[36:39], s70 offen offset:2176 sc1
    s_waitcnt vmcnt(0)
    v_xor_b32 v48, s16, v48
    v_xor_b32_e64 v49, s1, v49
    v_bitop3_b32 v12, v48, v48, v49 bitop3:0xfd
    v_xor_b32 v50, s0, v50
    v_xor_b32 v51, s17, v51
    v_bitop3_b32 v12, v12, v50, v51 bitop3:0xfd
    v_xor_b32 v52, s16, v52
    v_xor_b32 v53, s1, v53
    v_bitop3_b32 v12, v12, v52, v53 bitop3:0xfd
    v_xor_b32 v54, s0, v54
    v_xor_b32 v55, s17, v55
    v_bitop3_b32 v12, v12, v54, v55 bitop3:0xfd
    v_xor_b32 v56, s16, v56
    v_xor_b32 v57, s1, v57
    v_bitop3_b32 v12, v12, v56, v57 bitop3:0xfd
    v_xor_b32 v58, s0, v58
    v_xor_b32 v59, s17, v59
    v_bitop3_b32 v12, v12, v58, v59 bitop3:0xfd
    v_xor_b32 v60, s16, v60
    v_xor_b32 v61, s1, v61
    v_bitop3_b32 v12, v12, v60, v61 bitop3:0xfd
    v_xor_b32 v62, s0, v62
    v_xor_b32 v63, s17, v63
    v_bitop3_b32 v12, v12, v62, v63 bitop3:0xfd
    v_and_b32 v12, 0x10001, v12
    v_cmp_ne_u32 vcc, 0, v12
    s_nop 0
    s_cbranch_vccz DONE_14
    s_sleep 2
    s_sub_u32 s12, s12, 1
    s_cbranch_scc0 POLL_13
DONE_14:
    v_cndmask_b32 v80, v48, v52, s[10:11]
    v_cndmask_b32 v81, v49, v53, s[10:11]
    v_cndmask_b32 v82, v50, v54, s[10:11]
    v_cndmask_b32 v83, v51, v55, s[10:11]
    v_cndmask_b32 v84, v52, v48, s[10:11]
    v_cndmask_b32 v85, v53, v49, s[10:11]
    v_cndmask_b32 v86, v54, v50, s[10:11]
    v_cndmask_b32 v87, v55, v51, s[10:11]
    v_mfma_f32_32x32x16_bf16 v[96:111], v[80:83], v[16:19], 0
    v_cndmask_b32 v88, v56, v60, s[10:11]
    v_cndmask_b32 v89, v57, v61, s[10:11]
    v_cndmask_b32 v90, v58, v62, s[10:11]
    v_cndmask_b32 v91, v59, v63, s[10:11]
    v_mfma_f32_32x32x16_bf16 v[112:127], v[84:87], v[24:27], 0
    v_cndmask_b32 v92, v60, v56, s[10:11]
    v_cndmask_b32 v93, v61, v57, s[10:11]
    v_cndmask_b32 v94, v62, v58, s[10:11]
    v_cndmask_b32 v95, v63, v59, s[10:11]
    v_mfma_f32_32x32x16_bf16 v[48:63], v[88:91], v[32:35], 0
    s_nop 0
    v_mfma_f32_32x32x16_bf16 v[64:79], v[92:95], v[40:43], 0
    v_add_f32 v104, s58, v104
    v_rcp_f32 v104, v104
    s_nop 2
    v_add_f32 v112, s58, v112
    v_rcp_f32 v112, v112
    v_mul_f32_e64 v96, v96, v104
    v_mul_f32_e64 v97, v97, v104
    v_mul_f32_e64 v98, v98, v104
    v_mul_f32_e64 v99, v99, v104
    v_mul_f32_e64 v100, v100, v104
    v_mul_f32_e64 v101, v101, v104
    v_mul_f32_e64 v102, v102, v104
    v_mul_f32_e64 v103, v103, v104
    v_cvt_pk_bf16_f32 v108, v96, v97
    v_cvt_pk_bf16_f32 v109, v98, v99
    v_cvt_pk_bf16_f32 v110, v100, v101
    v_cvt_pk_bf16_f32 v111, v102, v103
    ds_write_b128 v13, v[108:111] offset:0
    v_add_f32 v56, s58, v56
    v_rcp_f32 v56, v56
    v_mul_f32_e64 v120, v120, v112
    v_mul_f32_e64 v121, v121, v112
    v_mul_f32_e64 v122, v122, v112
    v_mul_f32_e64 v123, v123, v112
    v_mul_f32_e64 v124, v124, v112
    v_mul_f32_e64 v125, v125, v112
    v_mul_f32_e64 v126, v126, v112
    v_mul_f32_e64 v127, v127, v112
    v_cvt_pk_bf16_f32 v116, v120, v121
    v_cvt_pk_bf16_f32 v117, v122, v123
    v_cvt_pk_bf16_f32 v118, v124, v125
    v_cvt_pk_bf16_f32 v119, v126, v127
    ds_write_b128 v13, v[116:119] offset:1024
    v_add_f32 v64, s58, v64
    v_rcp_f32 v64, v64
    v_mul_f32_e64 v48, v48, v56
    v_mul_f32_e64 v49, v49, v56
    v_mul_f32_e64 v50, v50, v56
    v_mul_f32_e64 v51, v51, v56
    v_mul_f32_e64 v52, v52, v56
    v_mul_f32_e64 v53, v53, v56
    v_mul_f32_e64 v54, v54, v56
    v_mul_f32_e64 v55, v55, v56
    v_cvt_pk_bf16_f32 v60, v48, v49
    v_cvt_pk_bf16_f32 v61, v50, v51
    v_cvt_pk_bf16_f32 v62, v52, v53
    v_cvt_pk_bf16_f32 v63, v54, v55
    ds_write_b128 v13, v[60:63] offset:2048
    v_mul_f32_e64 v72, v72, v64
    v_mul_f32_e64 v73, v73, v64
    v_mul_f32_e64 v74, v74, v64
    v_mul_f32_e64 v75, v75, v64
    v_mul_f32_e64 v76, v76, v64
    v_mul_f32_e64 v77, v77, v64
    v_mul_f32_e64 v78, v78, v64
    v_mul_f32_e64 v79, v79, v64
    v_cvt_pk_bf16_f32 v68, v72, v73
    v_cvt_pk_bf16_f32 v69, v74, v75
    v_cvt_pk_bf16_f32 v70, v76, v77
    v_cvt_pk_bf16_f32 v71, v78, v79
    ds_write_b128 v13, v[68:71] offset:3072
    v_mfma_f32_32x32x16_bf16 v[48:63], v[80:83], v[20:23], 0
    v_mfma_f32_32x32x16_bf16 v[64:79], v[84:87], v[28:31], 0
    s_waitcnt lgkmcnt(0)
    s_barrier
    s_cmp_ge_u32 s3, 4
    s_cbranch_scc1 OUT_GEMM
    v_mfma_f32_32x32x16_bf16 v[112:127], v[88:91], v[36:39], 0
    v_mfma_f32_32x32x16_bf16 v[96:111], v[92:95], v[44:47], 0
    s_nop 4
    v_add_f32 v56, s58, v56
    v_rcp_f32 v56, v56
    v_add_f32 v64, s58, v64
    v_rcp_f32_e64 v64, v64
    v_mul_f32_e64 v48, v48, v56
    v_mul_f32_e64 v49, v49, v56
    v_mul_f32_e64 v50, v50, v56
    v_mul_f32_e64 v51, v51, v56
    v_mul_f32_e64 v52, v52, v56
    v_mul_f32_e64 v53, v53, v56
    v_mul_f32_e64 v54, v54, v56
    v_mul_f32_e64 v55, v55, v56
    v_cvt_pk_bf16_f32 v60, v48, v49
    v_cvt_pk_bf16_f32 v61, v50, v51
    v_cvt_pk_bf16_f32 v62, v52, v53
    v_cvt_pk_bf16_f32 v63, v54, v55
    ds_write_b128 v13, v[60:63] offset:32768
    v_add_f32 v120, s58, v120
    v_rcp_f32 v120, v120
    v_mul_f32_e64 v72, v72, v64
    v_mul_f32_e64 v73, v73, v64
    v_mul_f32_e64 v74, v74, v64
    v_mul_f32_e64 v75, v75, v64
    v_mul_f32_e64 v76, v76, v64
    v_mul_f32_e64 v77, v77, v64
    v_mul_f32_e64 v78, v78, v64
    v_mul_f32_e64 v79, v79, v64
    v_cvt_pk_bf16_f32 v68, v72, v73
    v_cvt_pk_bf16_f32 v69, v74, v75
    v_cvt_pk_bf16_f32 v70, v76, v77
    v_cvt_pk_bf16_f32 v71, v78, v79
    ds_write_b128 v13, v[68:71] offset:33792
    s_or_b32 s56, s4, s3
    s_or_b32 s56, s56, s5
    s_cbranch_scc1 NOEP_16
    buffer_load_dwordx2 v[6:7], off, s[36:39], 0 offset:2048 sc1
NOEP_16:
    v_add_f32 v96, s58, v96
    v_rcp_f32_e64 v96, v96
    v_mul_f32_e64 v112, v112, v120
    v_mul_f32_e64 v113, v113, v120
    v_mul_f32_e64 v114, v114, v120
    v_mul_f32_e64 v115, v115, v120
    v_mul_f32_e64 v116, v116, v120
    v_mul_f32_e64 v117, v117, v120
    v_mul_f32_e64 v118, v118, v120
    v_mul_f32_e64 v119, v119, v120
    v_cvt_pk_bf16_f32 v124, v112, v113
    v_cvt_pk_bf16_f32 v125, v114, v115
    v_cvt_pk_bf16_f32 v126, v116, v117
    v_cvt_pk_bf16_f32 v127, v118, v119
    ds_write_b128 v13, v[124:127] offset:34816
    v_mul_f32_e64 v104, v104, v96
    v_mul_f32_e64 v105, v105, v96
    v_mul_f32_e64 v106, v106, v96
    v_mul_f32_e64 v107, v107, v96
    v_mul_f32_e64 v108, v108, v96
    v_mul_f32_e64 v109, v109, v96
    v_mul_f32_e64 v110, v110, v96
    v_mul_f32_e64 v111, v111, v96
    v_cvt_pk_bf16_f32 v100, v104, v105
    v_cvt_pk_bf16_f32 v101, v106, v107
    v_cvt_pk_bf16_f32 v102, v108, v109
    v_cvt_pk_bf16_f32 v103, v110, v111
    ds_write_b128 v13, v[100:103] offset:35840
    s_waitcnt lgkmcnt(0)
    s_barrier
    s_cmp_lg_u32 s56, 0
    s_cbranch_scc1 NOEP_17
    s_mov_b32 s12, 0x40000
    s_branch CHK_20
POLL_18:
    buffer_load_dwordx2 v[6:7], off, s[36:39], 0 offset:2048 sc1
CHK_20:
    s_waitcnt vmcnt(0)
    v_xor_b32_e64 v12, s6, v6
    v_bitop3_b32 v12, v12, v7, s7 bitop3:0xf6
    v_cmp_ne_u32 vcc, 0, v12
    s_nop 0
    s_cbranch_vccz DONE_19
    s_sleep 2
    s_sub_u32 s12, s12, 1
    s_cbranch_scc0 POLL_18
DONE_19:
    v_mov_b32 v6, s8
    v_mov_b32 v7, s9
    s_mov_b64 exec, 1
    buffer_store_dwordx2 v[6:7], off, s[36:39], 0 offset:0 sc1
    s_mov_b64 exec, -1
NOEP_17:
    s_endpgm
OUT_GEMM:
    s_setprio 1
    ds_read_b128 v[16:19], v4 offset:0
    ds_read_b128 v[24:27], v4 offset:1024
    ds_read_b128 v[32:35], v4 offset:2048
    ds_read_b128 v[40:43], v4 offset:3072
    ds_read_b128 v[20:23], v4 offset:4096
    ds_read_b128 v[28:31], v4 offset:5120
    s_waitcnt lgkmcnt(5)
    v_mfma_f32_32x32x16_bf16 v[96:111], v[128:131], v[16:19], 0
    ds_read_b128 v[16:19], v4 offset:6144
    v_add_f32 v56, s58, v56
    v_rcp_f32_e64 v56, v56
    v_mfma_f32_32x32x16_bf16 v[112:127], v[88:91], v[36:39], 0
    v_mul_f32_e64 v48, v48, v56
    v_mul_f32_e64 v49, v49, v56
    v_mul_f32_e64 v50, v50, v56
    v_mul_f32_e64 v51, v51, v56
    s_waitcnt lgkmcnt(5)
    v_mfma_f32_32x32x16_bf16 v[96:111], v[132:135], v[24:27], v[96:111]
    ds_read_b128 v[24:27], v4 offset:7168
    v_mul_f32_e64 v52, v52, v56
    v_mul_f32_e64 v53, v53, v56
    v_mul_f32_e64 v54, v54, v56
    s_waitcnt lgkmcnt(5)
    v_mfma_f32_32x32x16_bf16 v[96:111], v[136:139], v[32:35], v[96:111]
    ds_read_b128 v[32:35], v5 offset:0
    v_mul_f32_e64 v55, v55, v56
    v_cvt_pk_bf16_f32 v60, v48, v49
    v_cvt_pk_bf16_f32 v61, v50, v51
    s_waitcnt lgkmcnt(5)
    v_mfma_f32_32x32x16_bf16 v[96:111], v[140:143], v[40:43], v[96:111]
    ds_read_b128 v[40:43], v5 offset:1024
    v_cvt_pk_bf16_f32 v62, v52, v53
    v_cvt_pk_bf16_f32 v63, v54, v55
    ds_write_b128 v13, v[60:63] offset:32768
    s_waitcnt lgkmcnt(6)
    v_mfma_f32_32x32x16_bf16 v[96:111], v[144:147], v[20:23], v[96:111]
    ds_read_b128 v[20:23], v5 offset:2048
    v_add_f32 v64, s58, v64
    v_rcp_f32 v64, v64
    s_waitcnt lgkmcnt(6)
    v_mfma_f32_32x32x16_bf16 v[96:111], v[148:151], v[28:31], v[96:111]
    ds_read_b128 v[28:31], v5 offset:3072
    v_mul_f32_e64 v72, v72, v64
    v_mul_f32_e64 v73, v73, v64
    v_mul_f32_e64 v74, v74, v64
    s_waitcnt lgkmcnt(6)
    v_mfma_f32_32x32x16_bf16 v[96:111], v[152:155], v[16:19], v[96:111]
    ds_read_b128 v[16:19], v5 offset:4096
    v_mul_f32_e64 v75, v75, v64
    v_mul_f32_e64 v76, v76, v64
    v_mul_f32_e64 v77, v77, v64
    s_waitcnt lgkmcnt(6)
    v_mfma_f32_32x32x16_bf16 v[96:111], v[156:159], v[24:27], v[96:111]
    ds_read_b128 v[24:27], v5 offset:5120
    v_mul_f32_e64 v78, v78, v64
    v_mul_f32_e64 v79, v79, v64
    v_cvt_pk_bf16_f32 v68, v72, v73
    s_waitcnt lgkmcnt(6)
    v_mfma_f32_32x32x16_bf16 v[96:111], v[160:163], v[32:35], v[96:111]
    ds_read_b128 v[32:35], v5 offset:6144
    v_cvt_pk_bf16_f32 v69, v74, v75
    v_cvt_pk_bf16_f32 v70, v76, v77
    v_cvt_pk_bf16_f32 v71, v78, v79
    v_mfma_f32_32x32x16_bf16 v[48:63], v[92:95], v[44:47], 0
    ds_write_b128 v13, v[68:71] offset:33792
    v_add_f32 v120, s58, v120
    v_rcp_f32 v120, v120
    s_waitcnt lgkmcnt(7)
    v_mfma_f32_32x32x16_bf16 v[96:111], v[164:167], v[40:43], v[96:111]
    ds_read_b128 v[40:43], v5 offset:7168
    v_mul_f32_e64 v112, v112, v120
    v_mul_f32_e64 v113, v113, v120
    v_mul_f32_e64 v114, v114, v120
    s_waitcnt lgkmcnt(6)
    v_mfma_f32_32x32x16_bf16 v[96:111], v[168:171], v[20:23], v[96:111]
    ds_read_b128 v[20:23], v6 offset:0
    v_mul_f32_e64 v115, v115, v120
    v_mul_f32_e64 v116, v116, v120
    v_mul_f32_e64 v117, v117, v120
    s_waitcnt lgkmcnt(6)
    v_mfma_f32_32x32x16_bf16 v[96:111], v[172:175], v[28:31], v[96:111]
    ds_read_b128 v[28:31], v6 offset:1024
    v_mul_f32_e64 v118, v118, v120
    v_mul_f32_e64 v119, v119, v120
    v_cvt_pk_bf16_f32 v124, v112, v113
    s_waitcnt lgkmcnt(6)
    v_mfma_f32_32x32x16_bf16 v[96:111], v[176:179], v[16:19], v[96:111]
    ds_read_b128 v[16:19], v6 offset:2048
    v_cvt_pk_bf16_f32 v125, v114, v115
    v_cvt_pk_bf16_f32 v126, v116, v117
    v_cvt_pk_bf16_f32 v127, v118, v119
    s_waitcnt lgkmcnt(6)
    v_mfma_f32_32x32x16_bf16 v[96:111], v[180:183], v[24:27], v[96:111]
    ds_read_b128 v[24:27], v6 offset:3072
    ds_write_b128 v13, v[124:127] offset:34816
    v_add_f32 v48, s58, v48
    s_waitcnt lgkmcnt(7)
    v_mfma_f32_32x32x16_bf16 v[96:111], v[184:187], v[32:35], v[96:111]
    ds_read_b128 v[32:35], v6 offset:4096
    v_rcp_f32 v48, v48
    s_nop 0
    v_mul_f32_e64 v56, v56, v48
    s_waitcnt lgkmcnt(6)
    v_mfma_f32_32x32x16_bf16 v[96:111], v[188:191], v[40:43], v[96:111]
    ds_read_b128 v[40:43], v6 offset:5120
    v_mul_f32_e64 v57, v57, v48
    v_mul_f32_e64 v58, v58, v48
    v_mul_f32_e64 v59, v59, v48
    s_waitcnt lgkmcnt(6)
    v_mfma_f32_32x32x16_bf16 v[96:111], v[192:195], v[20:23], v[96:111]
    ds_read_b128 v[20:23], v6 offset:6144
    v_mul_f32_e64 v60, v60, v48
    v_mul_f32_e64 v61, v61, v48
    v_mul_f32_e64 v62, v62, v48
    s_waitcnt lgkmcnt(6)
    v_mfma_f32_32x32x16_bf16 v[96:111], v[196:199], v[28:31], v[96:111]
    ds_read_b128 v[28:31], v6 offset:7168
    v_mul_f32_e64 v63, v63, v48
    v_cvt_pk_bf16_f32 v52, v56, v57
    v_cvt_pk_bf16_f32 v53, v58, v59
    s_waitcnt lgkmcnt(6)
    v_mfma_f32_32x32x16_bf16 v[96:111], v[200:203], v[16:19], v[96:111]
    ds_read_b128 v[16:19], v7 offset:0
    v_cvt_pk_bf16_f32 v54, v60, v61
    v_cvt_pk_bf16_f32 v55, v62, v63
    ds_write_b128 v13, v[52:55] offset:35840
    s_waitcnt lgkmcnt(7)
    v_mfma_f32_32x32x16_bf16 v[96:111], v[204:207], v[24:27], v[96:111]
    ds_read_b128 v[24:27], v7 offset:1024
    s_waitcnt lgkmcnt(6)
    v_mfma_f32_32x32x16_bf16 v[96:111], v[208:211], v[32:35], v[96:111]
    ds_read_b128 v[32:35], v7 offset:2048
    s_waitcnt lgkmcnt(6)
    v_mfma_f32_32x32x16_bf16 v[96:111], v[212:215], v[40:43], v[96:111]
    ds_read_b128 v[40:43], v7 offset:3072
    s_waitcnt lgkmcnt(6)
    v_mfma_f32_32x32x16_bf16 v[96:111], v[216:219], v[20:23], v[96:111]
    ds_read_b128 v[20:23], v7 offset:4096
    s_waitcnt lgkmcnt(6)
    v_mfma_f32_32x32x16_bf16 v[96:111], v[220:223], v[28:31], v[96:111]
    ds_read_b128 v[28:31], v7 offset:5120
    s_waitcnt lgkmcnt(6)
    v_mfma_f32_32x32x16_bf16 v[96:111], v[224:227], v[16:19], v[96:111]
    ds_read_b128 v[16:19], v7 offset:6144
    s_waitcnt lgkmcnt(5)
    v_mfma_f32_32x32x16_bf16 v[96:111], v[228:231], v[24:27], v[96:111]
    ds_read_b128 v[24:27], v7 offset:7168
    s_waitcnt lgkmcnt(5)
    v_mfma_f32_32x32x16_bf16 v[96:111], v[232:235], v[32:35], v[96:111]
    s_barrier
    ds_read_b128 v[32:35], v4 offset:32768
    s_waitcnt lgkmcnt(5)
    v_mfma_f32_32x32x16_bf16 v[96:111], v[236:239], v[40:43], v[96:111]
    ds_read_b128 v[40:43], v4 offset:33792
    s_waitcnt lgkmcnt(5)
    v_mfma_f32_32x32x16_bf16 v[96:111], v[240:243], v[20:23], v[96:111]
    ds_read_b128 v[20:23], v4 offset:34816
    s_waitcnt lgkmcnt(5)
    v_mfma_f32_32x32x16_bf16 v[96:111], v[244:247], v[28:31], v[96:111]
    ds_read_b128 v[28:31], v4 offset:35840
    s_waitcnt lgkmcnt(5)
    v_mfma_f32_32x32x16_bf16 v[96:111], v[248:251], v[16:19], v[96:111]
    ds_read_b128 v[16:19], v4 offset:36864
    s_waitcnt lgkmcnt(5)
    v_mfma_f32_32x32x16_bf16 v[96:111], v[252:255], v[24:27], v[96:111]
    ds_read_b128 v[24:27], v4 offset:37888
    s_waitcnt lgkmcnt(5)
    v_mfma_f32_32x32x16_bf16 v[80:95], v[128:131], v[32:35], 0
    ds_read_b128 v[32:35], v4 offset:38912
    s_waitcnt lgkmcnt(5)
    v_mfma_f32_32x32x16_bf16 v[80:95], v[132:135], v[40:43], v[80:95]
    ds_read_b128 v[40:43], v4 offset:39936
    s_waitcnt lgkmcnt(5)
    v_mfma_f32_32x32x16_bf16 v[80:95], v[136:139], v[20:23], v[80:95]
    ds_read_b128 v[20:23], v5 offset:32768
    s_nop 0
    s_nop 0
    v_cvt_pk_bf16_f32 v48, v96, v97
    v_cvt_pk_bf16_f32 v49, v98, v99
    v_cvt_pk_bf16_f32 v50, v100, v101
    s_waitcnt lgkmcnt(5)
    v_mfma_f32_32x32x16_bf16 v[80:95], v[140:143], v[28:31], v[80:95]
    ds_read_b128 v[28:31], v5 offset:33792
    v_cvt_pk_bf16_f32 v51, v102, v103
    v_cvt_pk_bf16_f32 v52, v104, v105
    v_cvt_pk_bf16_f32 v53, v106, v107
    s_waitcnt lgkmcnt(5)
    v_mfma_f32_32x32x16_bf16 v[80:95], v[144:147], v[16:19], v[80:95]
    ds_read_b128 v[16:19], v5 offset:34816
    v_cvt_pk_bf16_f32 v54, v108, v109
    v_cvt_pk_bf16_f32 v55, v110, v111
    ds_write_b128 v10, v[48:51] offset:0
    s_waitcnt lgkmcnt(6)
    v_mfma_f32_32x32x16_bf16 v[80:95], v[148:151], v[24:27], v[80:95]
    ds_read_b128 v[24:27], v5 offset:35840
    ds_write_b128 v14, v[52:55] offset:0
    ds_read_b128 v[56:59], v15 offset:0
    ds_read_b128 v[60:63], v15 offset:1024
    s_waitcnt lgkmcnt(9)
    v_mfma_f32_32x32x16_bf16 v[80:95], v[152:155], v[32:35], v[80:95]
    ds_read_b128 v[32:35], v5 offset:36864
    s_waitcnt lgkmcnt(9)
    v_mfma_f32_32x32x16_bf16 v[80:95], v[156:159], v[40:43], v[80:95]
    ds_read_b128 v[40:43], v5 offset:37888
    s_waitcnt lgkmcnt(9)
    v_mfma_f32_32x32x16_bf16 v[80:95], v[160:163], v[20:23], v[80:95]
    ds_read_b128 v[20:23], v5 offset:38912
    s_waitcnt lgkmcnt(9)
    v_mfma_f32_32x32x16_bf16 v[80:95], v[164:167], v[28:31], v[80:95]
    ds_read_b128 v[28:31], v5 offset:39936
    s_waitcnt lgkmcnt(9)
    v_mfma_f32_32x32x16_bf16 v[80:95], v[168:171], v[16:19], v[80:95]
    ds_read_b128 v[16:19], v6 offset:32768
    s_waitcnt lgkmcnt(8)
    v_mfma_f32_32x32x16_bf16 v[80:95], v[172:175], v[24:27], v[80:95]
    ds_read_b128 v[24:27], v6 offset:33792
    s_waitcnt lgkmcnt(5)
    v_mfma_f32_32x32x16_bf16 v[80:95], v[176:179], v[32:35], v[80:95]
    ds_read_b128 v[32:35], v6 offset:34816
    buffer_store_dwordx4 v[56:59], v3, s[40:43], s64 offen sc1
    s_waitcnt lgkmcnt(5)
    v_mfma_f32_32x32x16_bf16 v[80:95], v[180:183], v[40:43], v[80:95]
    ds_read_b128 v[40:43], v6 offset:35840
    buffer_store_dwordx4 v[60:63], v3, s[40:43], s65 offen sc1
    s_waitcnt lgkmcnt(5)
    v_mfma_f32_32x32x16_bf16 v[80:95], v[184:187], v[20:23], v[80:95]
    ds_read_b128 v[20:23], v6 offset:36864
    s_waitcnt lgkmcnt(5)
    v_mfma_f32_32x32x16_bf16 v[80:95], v[188:191], v[28:31], v[80:95]
    ds_read_b128 v[28:31], v6 offset:37888
    s_waitcnt lgkmcnt(5)
    v_mfma_f32_32x32x16_bf16 v[80:95], v[192:195], v[16:19], v[80:95]
    ds_read_b128 v[16:19], v6 offset:38912
    s_waitcnt lgkmcnt(5)
    v_mfma_f32_32x32x16_bf16 v[80:95], v[196:199], v[24:27], v[80:95]
    ds_read_b128 v[24:27], v6 offset:39936
    s_waitcnt lgkmcnt(5)
    v_mfma_f32_32x32x16_bf16 v[80:95], v[200:203], v[32:35], v[80:95]
    ds_read_b128 v[32:35], v7 offset:32768
    s_waitcnt lgkmcnt(5)
    v_mfma_f32_32x32x16_bf16 v[80:95], v[204:207], v[40:43], v[80:95]
    ds_read_b128 v[40:43], v7 offset:33792
    s_waitcnt lgkmcnt(5)
    v_mfma_f32_32x32x16_bf16 v[80:95], v[208:211], v[20:23], v[80:95]
    ds_read_b128 v[20:23], v7 offset:34816
    s_waitcnt lgkmcnt(5)
    v_mfma_f32_32x32x16_bf16 v[80:95], v[212:215], v[28:31], v[80:95]
    ds_read_b128 v[28:31], v7 offset:35840
    s_waitcnt lgkmcnt(5)
    v_mfma_f32_32x32x16_bf16 v[80:95], v[216:219], v[16:19], v[80:95]
    ds_read_b128 v[16:19], v7 offset:36864
    s_waitcnt lgkmcnt(5)
    v_mfma_f32_32x32x16_bf16 v[80:95], v[220:223], v[24:27], v[80:95]
    ds_read_b128 v[24:27], v7 offset:37888
    s_waitcnt lgkmcnt(5)
    v_mfma_f32_32x32x16_bf16 v[80:95], v[224:227], v[32:35], v[80:95]
    ds_read_b128 v[32:35], v7 offset:38912
    s_waitcnt lgkmcnt(5)
    v_mfma_f32_32x32x16_bf16 v[80:95], v[228:231], v[40:43], v[80:95]
    ds_read_b128 v[40:43], v7 offset:39936
    s_waitcnt lgkmcnt(5)
    v_mfma_f32_32x32x16_bf16 v[80:95], v[232:235], v[20:23], v[80:95]
    s_waitcnt lgkmcnt(4)
    v_mfma_f32_32x32x16_bf16 v[80:95], v[236:239], v[28:31], v[80:95]
    s_waitcnt lgkmcnt(3)
    v_mfma_f32_32x32x16_bf16 v[80:95], v[240:243], v[16:19], v[80:95]
    s_waitcnt lgkmcnt(2)
    v_mfma_f32_32x32x16_bf16 v[80:95], v[244:247], v[24:27], v[80:95]
    s_waitcnt lgkmcnt(1)
    v_mfma_f32_32x32x16_bf16 v[80:95], v[248:251], v[32:35], v[80:95]
    s_waitcnt lgkmcnt(0)
    v_mfma_f32_32x32x16_bf16 v[80:95], v[252:255], v[40:43], v[80:95]
    s_nop 11
    v_cvt_pk_bf16_f32 v64, v80, v81
    v_cvt_pk_bf16_f32 v65, v82, v83
    v_cvt_pk_bf16_f32 v66, v84, v85
    v_cvt_pk_bf16_f32 v67, v86, v87
    v_cvt_pk_bf16_f32 v68, v88, v89
    v_cvt_pk_bf16_f32 v69, v90, v91
    v_cvt_pk_bf16_f32 v70, v92, v93
    v_cvt_pk_bf16_f32 v71, v94, v95
    ds_write_b128 v10, v[64:67] offset:2048
    ds_write_b128 v14, v[68:71] offset:2048
    ds_read_b128 v[72:75], v15 offset:2048
    ds_read_b128 v[76:79], v15 offset:3072
    s_waitcnt lgkmcnt(1)
    buffer_store_dwordx4 v[72:75], v3, s[40:43], s66 offen sc1
    s_waitcnt lgkmcnt(0)
    buffer_store_dwordx4 v[76:79], v3, s[40:43], s67 offen sc1
    s_endpgm
WA_1:
    s_endpgm
QCOMPUTE:
    s_lshl1_add_u32 s66, s60, s63
    s_lshl2_add_u32 s66, s66, s61
    s_lshl1_add_u32 s66, s66, s64
    s_lshl_b32 s65, s66, 13
    s_add_u32 s65, s65, 0x200000
    s_add_u32 s67, s65, 0x1000
    v_mov_b32 v4, 0xfffefffe
    s_lshl3_add_u32 s60, s4, s5
    s_sub_u32 s60, s60, 16
    v_and_b32 v8, 7, v1
    v_lshlrev_b32 v8, 6, v8
    s_add_u32 s62, s60, 512
    v_add_u32 v8, s62, v8
    v_cvt_f32_u32 v8, v8
    v_mul_f32 v8, 0x3a000000, v8
    s_lshr_b32 s62, s3, 1
    s_and_b32 s15, s3, 1
    s_lshl2_add_u32 s14, s62, s15
    s_lshl_b32 s14, s14, 1
    v_lshrrev_b32_e64 v9, 5, v1
    v_lshl_add_u32 v9, v9, 2, s14
    v_cvt_f32_u32_e64 v9, v9
    v_bfe_u32 v10, v1, 3, 1
    v_cvt_f32_u32_e64 v10, v10
    v_mul_f32 v10, 0xbe800000, v10
    v_fma_f32 v9, v9, v8, v10
    v_lshlrev_b32_e64 v10, 27, v1
    v_and_b32 v10, 0x80000000, v10
    v_or_b32 v10, 0x3e000000, v10
    v_add_f32 v11, v9, v10
    v_sub_f32 v10, v8, v10
    v_add_f32 v10, v9, v10
    v_cos_f32 v8, v11
    v_sin_f32 v11, v11
    v_cos_f32 v9, v10
    v_sin_f32 v10, v10
    s_lshl_b32 s62, s62, 10
    s_lshl3_add_u32 s62, s15, s62
    s_add_u32 s62, s62, 155648
    v_add_u32 v14, s62, v2
    v_cvt_pk_bf16_f32 v12, v8, -v11
    v_cvt_pk_bf16_f32 v13, v9, -v10
    s_waitcnt lgkmcnt(0)
    s_add_u32 s8, s8, 0x1e3779b1
    s_addc_u32 s9, s9, 0x5ebca6b
    s_and_b32 s6, s8, 0xbfffbfff
    s_and_b32 s7, s9, 0xbfffbfff
    s_bitcmp1_b32 s8, 0
    s_cselect_b32 s16, 0x10001, 0
    s_xor_b32 s17, s16, 0x10000
    s_xor_b32 s0, s16, 0x10001
    s_xor_b32 s1, s16, 1
    s_barrier
    ds_read_b128 v[16:19], v240 offset:0
    ds_read_b64_tr_b16 v[20:21], v248 offset:16384
    ds_read_b64_tr_b16 v[22:23], v248 offset:17408
    ds_read_b128 v[24:27], v240 offset:4096
    ds_read_b64_tr_b16 v[28:29], v249 offset:16384
    ds_read_b64_tr_b16 v[30:31], v249 offset:17408
    ds_read_b128 v[32:35], v241 offset:0
    ds_read_b64_tr_b16 v[36:37], v248 offset:20480
    ds_read_b64_tr_b16 v[38:39], v248 offset:21504
    ds_read_b128 v[40:43], v241 offset:4096
    ds_read_b64_tr_b16 v[44:45], v249 offset:20480
    ds_read_b64_tr_b16 v[46:47], v249 offset:21504
    s_waitcnt lgkmcnt(9)
    v_mfma_f32_32x32x16_bf16 v[64:79], v[20:23], v[16:19], 0
    ds_read_b128 v[48:51], v242 offset:0
    ds_read_b64_tr_b16 v[52:53], v248 offset:24576
    s_waitcnt lgkmcnt(10)
    v_mfma_f32_32x32x16_bf16 v[80:95], v[20:23], v[24:27], 0
    ds_read_b64_tr_b16 v[54:55], v248 offset:25600
    ds_read_b128 v[56:59], v242 offset:4096
    s_nop 0
    s_waitcnt lgkmcnt(10)
    v_mfma_f32_32x32x16_bf16 v[96:111], v[28:31], v[16:19], 0
    ds_read_b64_tr_b16 v[60:61], v249 offset:24576
    ds_read_b64_tr_b16 v[62:63], v249 offset:25600
    v_mfma_f32_32x32x16_bf16 v[112:127], v[28:31], v[24:27], 0
    ds_read_b128 v[160:163], v243 offset:0
    ds_read_b64_tr_b16 v[164:165], v248 offset:28672
    s_waitcnt lgkmcnt(11)
    v_mfma_f32_32x32x16_bf16 v[64:79], v[36:39], v[32:35], v[64:79]
    ds_read_b64_tr_b16 v[166:167], v248 offset:29696
    ds_read_b128 v[168:171], v243 offset:4096
    s_waitcnt lgkmcnt(12)
    v_mfma_f32_32x32x16_bf16 v[80:95], v[36:39], v[40:43], v[80:95]
    ds_read_b64_tr_b16 v[172:173], v249 offset:28672
    ds_read_b64_tr_b16 v[174:175], v249 offset:29696
    s_waitcnt lgkmcnt(12)
    v_mfma_f32_32x32x16_bf16 v[96:111], v[44:47], v[32:35], v[96:111]
    s_barrier
    ds_read_b128 v[176:179], v240 offset:32768
    ds_read_b64_tr_b16 v[180:181], v248 offset:49152
    v_mfma_f32_32x32x16_bf16 v[112:127], v[44:47], v[40:43], v[112:127]
    s_waitcnt lgkmcnt(11)
    v_mfma_f32_32x32x16_bf16 v[64:79], v[52:55], v[48:51], v[64:79]
    ds_read_b64_tr_b16 v[182:183], v248 offset:50176
    ds_read_b128 v[184:187], v240 offset:36864
    s_waitcnt lgkmcnt(12)
    v_mfma_f32_32x32x16_bf16 v[80:95], v[52:55], v[56:59], v[80:95]
    ds_read_b64_tr_b16 v[188:189], v249 offset:49152
    ds_read_b64_tr_b16 v[190:191], v249 offset:50176
    s_waitcnt lgkmcnt(12)
    v_mfma_f32_32x32x16_bf16 v[96:111], v[60:63], v[48:51], v[96:111]
    ds_read_b128 v[192:195], v241 offset:32768
    ds_read_b64_tr_b16 v[196:197], v248 offset:53248
    v_mfma_f32_32x32x16_bf16 v[112:127], v[60:63], v[56:59], v[112:127]
    s_waitcnt lgkmcnt(11)
    v_mfma_f32_32x32x16_bf16 v[64:79], v[164:167], v[160:163], v[64:79]
    ds_read_b64_tr_b16 v[198:199], v248 offset:54272
    ds_read_b128 v[200:203], v241 offset:36864
    s_waitcnt lgkmcnt(12)
    v_mfma_f32_32x32x16_bf16 v[80:95], v[164:167], v[168:171], v[80:95]
    ds_read_b64_tr_b16 v[204:205], v249 offset:53248
    ds_read_b64_tr_b16 v[206:207], v249 offset:54272
    s_waitcnt lgkmcnt(12)
    v_mfma_f32_32x32x16_bf16 v[96:111], v[172:175], v[160:163], v[96:111]
    ds_read_b128 v[208:211], v242 offset:32768
    ds_read_b64_tr_b16 v[220:221], v248 offset:57344
    v_mfma_f32_32x32x16_bf16 v[112:127], v[172:175], v[168:171], v[112:127]
    s_waitcnt lgkmcnt(11)
    v_mfma_f32_32x32x16_bf16 v[64:79], v[180:183], v[176:179], v[64:79]
    ds_read_b64_tr_b16 v[222:223], v248 offset:58368
    ds_read_b128 v[224:227], v242 offset:36864
    s_waitcnt lgkmcnt(12)
    v_mfma_f32_32x32x16_bf16 v[80:95], v[180:183], v[184:187], v[80:95]
    ds_read_b64_tr_b16 v[228:229], v249 offset:57344
    ds_read_b64_tr_b16 v[230:231], v249 offset:58368
    s_waitcnt lgkmcnt(12)
    v_mfma_f32_32x32x16_bf16 v[96:111], v[188:191], v[176:179], v[96:111]
    ds_read_b128 v[232:235], v243 offset:32768
    ds_read_b64_tr_b16 v[236:237], v248 offset:61440
    v_mfma_f32_32x32x16_bf16 v[112:127], v[188:191], v[184:187], v[112:127]
    s_waitcnt lgkmcnt(11)
    v_mfma_f32_32x32x16_bf16 v[64:79], v[196:199], v[192:195], v[64:79]
    ds_read_b64_tr_b16 v[238:239], v248 offset:62464
    ds_read_b128 v[20:23], v243 offset:36864
    s_waitcnt lgkmcnt(12)
    v_mfma_f32_32x32x16_bf16 v[80:95], v[196:199], v[200:203], v[80:95]
    ds_read_b64_tr_b16 v[16:17], v249 offset:61440
    ds_read_b64_tr_b16 v[18:19], v249 offset:62464
    s_waitcnt lgkmcnt(12)
    v_mfma_f32_32x32x16_bf16 v[96:111], v[204:207], v[192:195], v[96:111]
    s_barrier
    ds_read_b128 v[24:27], v244 offset:0
    ds_read_b64_tr_b16 v[28:29], v250 offset:16384
    v_mfma_f32_32x32x16_bf16 v[112:127], v[204:207], v[200:203], v[112:127]
    s_waitcnt lgkmcnt(11)
    v_mfma_f32_32x32x16_bf16 v[64:79], v[220:223], v[208:211], v[64:79]
    ds_read_b64_tr_b16 v[30:31], v250 offset:17408
    ds_read_b128 v[36:39], v244 offset:4096
    s_waitcnt lgkmcnt(12)
    v_mfma_f32_32x32x16_bf16 v[80:95], v[220:223], v[224:227], v[80:95]
    ds_read_b64_tr_b16 v[32:33], v251 offset:16384
    ds_read_b64_tr_b16 v[34:35], v251 offset:17408
    s_waitcnt lgkmcnt(12)
    v_mfma_f32_32x32x16_bf16 v[96:111], v[228:231], v[208:211], v[96:111]
    ds_read_b128 v[40:43], v245 offset:0
    ds_read_b64_tr_b16 v[44:45], v250 offset:20480
    v_mfma_f32_32x32x16_bf16 v[112:127], v[228:231], v[224:227], v[112:127]
    s_waitcnt lgkmcnt(11)
    v_mfma_f32_32x32x16_bf16 v[64:79], v[236:239], v[232:235], v[64:79]
    ds_read_b64_tr_b16 v[46:47], v250 offset:21504
    ds_read_b128 v[52:55], v245 offset:4096
    s_waitcnt lgkmcnt(12)
    v_mfma_f32_32x32x16_bf16 v[80:95], v[236:239], v[20:23], v[80:95]
    ds_read_b64_tr_b16 v[48:49], v251 offset:20480
    ds_read_b64_tr_b16 v[50:51], v251 offset:21504
    s_waitcnt lgkmcnt(12)
    v_mfma_f32_32x32x16_bf16 v[96:111], v[16:19], v[232:235], v[96:111]
    ds_read_b128 v[56:59], v246 offset:0
    ds_read_b64_tr_b16 v[60:61], v250 offset:24576
    v_mfma_f32_32x32x16_bf16 v[112:127], v[16:19], v[20:23], v[112:127]
    s_waitcnt lgkmcnt(11)
    v_mfma_f32_32x32x16_bf16 v[64:79], v[28:31], v[24:27], v[64:79]
    ds_read_b64_tr_b16 v[62:63], v250 offset:25600
    ds_read_b128 v[164:167], v246 offset:4096
    s_waitcnt lgkmcnt(12)
    v_mfma_f32_32x32x16_bf16 v[80:95], v[28:31], v[36:39], v[80:95]
    ds_read_b64_tr_b16 v[160:161], v251 offset:24576
    ds_read_b64_tr_b16 v[162:163], v251 offset:25600
    s_waitcnt lgkmcnt(12)
    v_mfma_f32_32x32x16_bf16 v[96:111], v[32:35], v[24:27], v[96:111]
    ds_read_b128 v[168:171], v247 offset:0
    ds_read_b64_tr_b16 v[172:173], v250 offset:28672
    v_mfma_f32_32x32x16_bf16 v[112:127], v[32:35], v[36:39], v[112:127]
    s_waitcnt lgkmcnt(11)
    v_mfma_f32_32x32x16_bf16 v[64:79], v[44:47], v[40:43], v[64:79]
    ds_read_b64_tr_b16 v[174:175], v250 offset:29696
    ds_read_b128 v[180:183], v247 offset:4096
    s_waitcnt lgkmcnt(12)
    v_mfma_f32_32x32x16_bf16 v[80:95], v[44:47], v[52:55], v[80:95]
    ds_read_b64_tr_b16 v[176:177], v251 offset:28672
    ds_read_b64_tr_b16 v[178:179], v251 offset:29696
    s_waitcnt lgkmcnt(12)
    v_mfma_f32_32x32x16_bf16 v[96:111], v[48:51], v[40:43], v[96:111]
    s_barrier
    ds_read_b128 v[184:187], v244 offset:32768
    ds_read_b64_tr_b16 v[188:189], v250 offset:49152
    v_mfma_f32_32x32x16_bf16 v[112:127], v[48:51], v[52:55], v[112:127]
    s_waitcnt lgkmcnt(11)
    v_mfma_f32_32x32x16_bf16 v[64:79], v[60:63], v[56:59], v[64:79]
    ds_read_b64_tr_b16 v[190:191], v250 offset:50176
    ds_read_b128 v[196:199], v244 offset:36864
    s_waitcnt lgkmcnt(12)
    v_mfma_f32_32x32x16_bf16 v[80:95], v[60:63], v[164:167], v[80:95]
    ds_read_b64_tr_b16 v[192:193], v251 offset:49152
    ds_read_b64_tr_b16 v[194:195], v251 offset:50176
    s_waitcnt lgkmcnt(12)
    v_mfma_f32_32x32x16_bf16 v[96:111], v[160:163], v[56:59], v[96:111]
    ds_read_b128 v[200:203], v245 offset:32768
    ds_read_b64_tr_b16 v[204:205], v250 offset:53248
    v_mfma_f32_32x32x16_bf16 v[112:127], v[160:163], v[164:167], v[112:127]
    s_waitcnt lgkmcnt(11)
    v_mfma_f32_32x32x16_bf16 v[64:79], v[172:175], v[168:171], v[64:79]
    ds_read_b64_tr_b16 v[206:207], v250 offset:54272
    ds_read_b128 v[220:223], v245 offset:36864
    s_waitcnt lgkmcnt(12)
    v_mfma_f32_32x32x16_bf16 v[80:95], v[172:175], v[180:183], v[80:95]
    ds_read_b64_tr_b16 v[208:209], v251 offset:53248
    ds_read_b64_tr_b16 v[210:211], v251 offset:54272
    s_waitcnt lgkmcnt(12)
    v_mfma_f32_32x32x16_bf16 v[96:111], v[176:179], v[168:171], v[96:111]
    ds_read_b128 v[224:227], v246 offset:32768
    ds_read_b64_tr_b16 v[228:229], v250 offset:57344
    v_mfma_f32_32x32x16_bf16 v[112:127], v[176:179], v[180:183], v[112:127]
    s_waitcnt lgkmcnt(11)
    v_mfma_f32_32x32x16_bf16 v[64:79], v[188:191], v[184:187], v[64:79]
    ds_read_b64_tr_b16 v[230:231], v250 offset:58368
    ds_read_b128 v[236:239], v246 offset:36864
    s_waitcnt lgkmcnt(12)
    v_mfma_f32_32x32x16_bf16 v[80:95], v[188:191], v[196:199], v[80:95]
    ds_read_b64_tr_b16 v[232:233], v251 offset:57344
    ds_read_b64_tr_b16 v[234:235], v251 offset:58368
    s_waitcnt lgkmcnt(12)
    v_mfma_f32_32x32x16_bf16 v[96:111], v[192:195], v[184:187], v[96:111]
    ds_read_b128 v[20:23], v247 offset:32768
    ds_read_b64_tr_b16 v[16:17], v250 offset:61440
    v_mfma_f32_32x32x16_bf16 v[112:127], v[192:195], v[196:199], v[112:127]
    s_waitcnt lgkmcnt(11)
    v_mfma_f32_32x32x16_bf16 v[64:79], v[204:207], v[200:203], v[64:79]
    ds_read_b64_tr_b16 v[18:19], v250 offset:62464
    ds_read_b128 v[28:31], v247 offset:36864
    s_waitcnt lgkmcnt(12)
    v_mfma_f32_32x32x16_bf16 v[80:95], v[204:207], v[220:223], v[80:95]
    ds_read_b64_tr_b16 v[24:25], v251 offset:61440
    ds_read_b64_tr_b16 v[26:27], v251 offset:62464
    s_waitcnt lgkmcnt(12)
    v_mfma_f32_32x32x16_bf16 v[96:111], v[208:211], v[200:203], v[96:111]
    s_barrier
    ds_read_b128 v[36:39], v252 offset:0
    ds_read_b64_tr_b16 v[32:33], v146 offset:16384
    v_mfma_f32_32x32x16_bf16 v[112:127], v[208:211], v[220:223], v[112:127]
    s_waitcnt lgkmcnt(11)
    v_mfma_f32_32x32x16_bf16 v[64:79], v[228:231], v[224:227], v[64:79]
    ds_read_b64_tr_b16 v[34:35], v146 offset:17408
    ds_read_b128 v[44:47], v252 offset:4096
    s_waitcnt lgkmcnt(12)
    v_mfma_f32_32x32x16_bf16 v[80:95], v[228:231], v[236:239], v[80:95]
    ds_read_b64_tr_b16 v[40:41], v147 offset:16384
    ds_read_b64_tr_b16 v[42:43], v147 offset:17408
    s_waitcnt lgkmcnt(12)
    v_mfma_f32_32x32x16_bf16 v[96:111], v[232:235], v[224:227], v[96:111]
    ds_read_b128 v[52:55], v253 offset:0
    ds_read_b64_tr_b16 v[48:49], v146 offset:20480
    v_mfma_f32_32x32x16_bf16 v[112:127], v[232:235], v[236:239], v[112:127]
    s_waitcnt lgkmcnt(11)
    v_mfma_f32_32x32x16_bf16 v[64:79], v[16:19], v[20:23], v[64:79]
    ds_read_b64_tr_b16 v[50:51], v146 offset:21504
    ds_read_b128 v[60:63], v253 offset:4096
    s_waitcnt lgkmcnt(12)
    v_mfma_f32_32x32x16_bf16 v[80:95], v[16:19], v[28:31], v[80:95]
    ds_read_b64_tr_b16 v[56:57], v147 offset:20480
    ds_read_b64_tr_b16 v[58:59], v147 offset:21504
    s_waitcnt lgkmcnt(12)
    v_mfma_f32_32x32x16_bf16 v[96:111], v[24:27], v[20:23], v[96:111]
    ds_read_b128 v[164:167], v254 offset:0
    ds_read_b64_tr_b16 v[160:161], v146 offset:24576
    v_mfma_f32_32x32x16_bf16 v[112:127], v[24:27], v[28:31], v[112:127]
    s_waitcnt lgkmcnt(11)
    v_mfma_f32_32x32x16_bf16 v[64:79], v[32:35], v[36:39], v[64:79]
    ds_read_b64_tr_b16 v[162:163], v146 offset:25600
    ds_read_b128 v[172:175], v254 offset:4096
    s_waitcnt lgkmcnt(12)
    v_mfma_f32_32x32x16_bf16 v[80:95], v[32:35], v[44:47], v[80:95]
    ds_read_b64_tr_b16 v[168:169], v147 offset:24576
    ds_read_b64_tr_b16 v[170:171], v147 offset:25600
    s_waitcnt lgkmcnt(12)
    v_mfma_f32_32x32x16_bf16 v[96:111], v[40:43], v[36:39], v[96:111]
    ds_read_b128 v[180:183], v255 offset:0
    ds_read_b64_tr_b16 v[176:177], v146 offset:28672
    v_mfma_f32_32x32x16_bf16 v[112:127], v[40:43], v[44:47], v[112:127]
    s_waitcnt lgkmcnt(11)
    v_mfma_f32_32x32x16_bf16 v[64:79], v[48:51], v[52:55], v[64:79]
    ds_read_b64_tr_b16 v[178:179], v146 offset:29696
    ds_read_b128 v[188:191], v255 offset:4096
    s_waitcnt lgkmcnt(12)
    v_mfma_f32_32x32x16_bf16 v[80:95], v[48:51], v[60:63], v[80:95]
    ds_read_b64_tr_b16 v[184:185], v147 offset:28672
    ds_read_b64_tr_b16 v[186:187], v147 offset:29696
    s_waitcnt lgkmcnt(12)
    v_mfma_f32_32x32x16_bf16 v[96:111], v[56:59], v[52:55], v[96:111]
    s_barrier
    ds_read_b128 v[196:199], v240 offset:0
    ds_read_b64_tr_b16 v[192:193], v248 offset:16384
    v_mfma_f32_32x32x16_bf16 v[112:127], v[56:59], v[60:63], v[112:127]
    s_waitcnt lgkmcnt(11)
    v_mfma_f32_32x32x16_bf16 v[64:79], v[160:163], v[164:167], v[64:79]
    ds_read_b64_tr_b16 v[194:195], v248 offset:17408
    ds_read_b128 v[204:207], v240 offset:4096
    s_waitcnt lgkmcnt(12)
    v_mfma_f32_32x32x16_bf16 v[80:95], v[160:163], v[172:175], v[80:95]
    ds_read_b64_tr_b16 v[200:201], v249 offset:16384
    ds_read_b64_tr_b16 v[202:203], v249 offset:17408
    s_waitcnt lgkmcnt(12)
    v_mfma_f32_32x32x16_bf16 v[96:111], v[168:171], v[164:167], v[96:111]
    ds_read_b128 v[220:223], v241 offset:0
    ds_read_b64_tr_b16 v[208:209], v248 offset:20480
    v_mfma_f32_32x32x16_bf16 v[112:127], v[168:171], v[172:175], v[112:127]
    s_waitcnt lgkmcnt(11)
    v_mfma_f32_32x32x16_bf16 v[64:79], v[176:179], v[180:183], v[64:79]
    ds_read_b64_tr_b16 v[210:211], v248 offset:21504
    ds_read_b128 v[228:231], v241 offset:4096
    s_waitcnt lgkmcnt(12)
    v_mfma_f32_32x32x16_bf16 v[80:95], v[176:179], v[188:191], v[80:95]
    ds_read_b64_tr_b16 v[224:225], v249 offset:20480
    ds_read_b64_tr_b16 v[226:227], v249 offset:21504
    s_waitcnt lgkmcnt(12)
    v_mfma_f32_32x32x16_bf16 v[96:111], v[184:187], v[180:183], v[96:111]
    ds_read_b128 v[236:239], v242 offset:0
    ds_read_b64_tr_b16 v[232:233], v248 offset:24576
    v_mfma_f32_32x32x16_bf16 v[112:127], v[184:187], v[188:191], v[112:127]
    s_waitcnt lgkmcnt(11)
    v_mfma_f32_32x32x16_bf16 v[64:79], v[192:195], v[196:199], v[64:79]
    ds_read_b64_tr_b16 v[234:235], v248 offset:25600
    ds_read_b128 v[16:19], v242 offset:4096
    s_waitcnt lgkmcnt(12)
    v_mfma_f32_32x32x16_bf16 v[80:95], v[192:195], v[204:207], v[80:95]
    ds_read_b64_tr_b16 v[20:21], v249 offset:24576
    ds_read_b64_tr_b16 v[22:23], v249 offset:25600
    s_waitcnt lgkmcnt(12)
    v_mfma_f32_32x32x16_bf16 v[96:111], v[200:203], v[196:199], v[96:111]
    ds_read_b128 v[28:31], v243 offset:0
    ds_read_b64_tr_b16 v[24:25], v248 offset:28672
    v_mfma_f32_32x32x16_bf16 v[112:127], v[200:203], v[204:207], v[112:127]
    s_waitcnt lgkmcnt(11)
    v_mfma_f32_32x32x16_bf16 v[64:79], v[208:211], v[220:223], v[64:79]
    ds_read_b64_tr_b16 v[26:27], v248 offset:29696
    ds_read_b128 v[32:35], v243 offset:4096
    s_waitcnt lgkmcnt(12)
    v_mfma_f32_32x32x16_bf16 v[80:95], v[208:211], v[228:231], v[80:95]
    ds_read_b64_tr_b16 v[36:37], v249 offset:28672
    ds_read_b64_tr_b16 v[38:39], v249 offset:29696
    s_waitcnt lgkmcnt(12)
    v_mfma_f32_32x32x16_bf16 v[96:111], v[224:227], v[220:223], v[96:111]
    s_barrier
    ds_read_b128 v[44:47], v240 offset:32768
    ds_read_b64_tr_b16 v[40:41], v248 offset:49152
    v_mfma_f32_32x32x16_bf16 v[112:127], v[224:227], v[228:231], v[112:127]
    s_waitcnt lgkmcnt(11)
    v_mfma_f32_32x32x16_bf16 v[64:79], v[232:235], v[236:239], v[64:79]
    ds_read_b64_tr_b16 v[42:43], v248 offset:50176
    ds_read_b128 v[48:51], v240 offset:36864
    s_waitcnt lgkmcnt(12)
    v_mfma_f32_32x32x16_bf16 v[80:95], v[232:235], v[16:19], v[80:95]
    ds_read_b128 v[52:55], v241 offset:32768
    ds_read_b64_tr_b16 v[60:61], v248 offset:53248
    s_waitcnt lgkmcnt(12)
    v_mfma_f32_32x32x16_bf16 v[96:111], v[20:23], v[236:239], v[96:111]
    ds_read_b64_tr_b16 v[62:63], v248 offset:54272
    ds_read_b128 v[56:59], v241 offset:36864
    v_mfma_f32_32x32x16_bf16 v[112:127], v[20:23], v[16:19], v[112:127]
    s_waitcnt lgkmcnt(11)
    v_mfma_f32_32x32x16_bf16 v[64:79], v[24:27], v[28:31], v[64:79]
    ds_read_b128 v[160:163], v242 offset:32768
    ds_read_b64_tr_b16 v[164:165], v248 offset:57344
    s_waitcnt lgkmcnt(12)
    v_mfma_f32_32x32x16_bf16 v[80:95], v[24:27], v[32:35], v[80:95]
    ds_read_b64_tr_b16 v[166:167], v248 offset:58368
    ds_read_b128 v[172:175], v242 offset:36864
    s_waitcnt lgkmcnt(12)
    v_mfma_f32_32x32x16_bf16 v[96:111], v[36:39], v[28:31], v[96:111]
    ds_read_b128 v[168:171], v243 offset:32768
    ds_read_b64_tr_b16 v[176:177], v248 offset:61440
    v_mfma_f32_32x32x16_bf16 v[112:127], v[36:39], v[32:35], v[112:127]
    s_waitcnt lgkmcnt(11)
    v_mfma_f32_32x32x16_bf16 v[64:79], v[40:43], v[44:47], v[64:79]
    ds_read_b64_tr_b16 v[178:179], v248 offset:62464
    ds_read_b128 v[180:183], v243 offset:36864
    s_waitcnt lgkmcnt(12)
    v_mfma_f32_32x32x16_bf16 v[80:95], v[40:43], v[48:51], v[80:95]
    s_barrier
    ds_read_b128 v[188:191], v244 offset:0
    ds_read_b64_tr_b16 v[184:185], v250 offset:16384
    s_waitcnt lgkmcnt(11)
    v_mfma_f32_32x32x16_bf16 v[64:79], v[60:63], v[52:55], v[64:79]
    ds_read_b64_tr_b16 v[186:187], v250 offset:17408
    ds_read_b128 v[192:195], v244 offset:4096
    s_waitcnt lgkmcnt(12)
    v_mfma_f32_32x32x16_bf16 v[80:95], v[60:63], v[56:59], v[80:95]
    ds_read_b128 v[196:199], v245 offset:0
    ds_read_b64_tr_b16 v[204:205], v250 offset:20480
    s_waitcnt lgkmcnt(11)
    v_mfma_f32_32x32x16_bf16 v[64:79], v[164:167], v[160:163], v[64:79]
    s_waitcnt vmcnt(0)
    ds_read_b64_tr_b16 v[206:207], v250 offset:21504
    ds_read_b128 v[200:203], v245 offset:4096
    s_waitcnt lgkmcnt(12)
    v_mfma_f32_32x32x16_bf16 v[80:95], v[164:167], v[172:175], v[80:95]
    ds_read_b128 v[208:211], v246 offset:0
    ds_read_b64_tr_b16 v[220:221], v250 offset:24576
    s_waitcnt lgkmcnt(11)
    v_mfma_f32_32x32x16_bf16 v[64:79], v[176:179], v[168:171], v[64:79]
    ds_read_b64_tr_b16 v[222:223], v250 offset:25600
    ds_read_b128 v[228:231], v246 offset:4096
    s_waitcnt lgkmcnt(12)
    v_mfma_f32_32x32x16_bf16 v[80:95], v[176:179], v[180:183], v[80:95]
    ds_read_b128 v[224:227], v247 offset:0
    ds_read_b64_tr_b16 v[232:233], v250 offset:28672
    s_waitcnt lgkmcnt(11)
    v_mfma_f32_32x32x16_bf16 v[64:79], v[184:187], v[188:191], v[64:79]
    ds_read_b64_tr_b16 v[234:235], v250 offset:29696
    ds_read_b128 v[236:239], v247 offset:4096
    s_waitcnt lgkmcnt(12)
    v_mfma_f32_32x32x16_bf16 v[80:95], v[184:187], v[192:195], v[80:95]
    ds_read_b64_tr_b16 v[16:17], v249 offset:49152
    ds_read_b64_tr_b16 v[18:19], v249 offset:50176
    s_waitcnt lgkmcnt(11)
    v_mfma_f32_32x32x16_bf16 v[64:79], v[204:207], v[196:199], v[64:79]
    ds_read_b64_tr_b16 v[20:21], v249 offset:53248
    ds_read_b64_tr_b16 v[22:23], v249 offset:54272
    s_waitcnt lgkmcnt(12)
    v_mfma_f32_32x32x16_bf16 v[80:95], v[204:207], v[200:203], v[80:95]
    ds_read_b64_tr_b16 v[24:25], v249 offset:57344
    ds_read_b64_tr_b16 v[26:27], v249 offset:58368
    s_waitcnt lgkmcnt(11)
    v_mfma_f32_32x32x16_bf16 v[64:79], v[220:223], v[208:211], v[64:79]
    ds_read_b64_tr_b16 v[28:29], v249 offset:61440
    ds_read_b64_tr_b16 v[30:31], v249 offset:62464
    s_waitcnt lgkmcnt(12)
    v_mfma_f32_32x32x16_bf16 v[80:95], v[220:223], v[228:231], v[80:95]
    ds_read_b64_tr_b16 v[32:33], v251 offset:16384
    ds_read_b64_tr_b16 v[34:35], v251 offset:17408
    s_waitcnt lgkmcnt(11)
    v_mfma_f32_32x32x16_bf16 v[64:79], v[232:235], v[224:227], v[64:79]
    ds_read_b64_tr_b16 v[36:37], v251 offset:20480
    ds_read_b64_tr_b16 v[38:39], v251 offset:21504
    s_waitcnt lgkmcnt(12)
    v_mfma_f32_32x32x16_bf16 v[80:95], v[232:235], v[236:239], v[80:95]
    ds_read_b64_tr_b16 v[40:41], v251 offset:24576
    ds_read_b64_tr_b16 v[42:43], v251 offset:25600
    s_waitcnt lgkmcnt(12)
    v_mfma_f32_32x32x16_bf16 v[96:111], v[16:19], v[44:47], v[96:111]
WQ_0:
    ds_read_b64_tr_b16 v[60:61], v251 offset:28672
    ds_read_b64_tr_b16 v[62:63], v251 offset:29696
    v_mfma_f32_32x32x16_bf16 v[112:127], v[16:19], v[48:51], v[112:127]
    s_nop 0
    s_nop 0
    v_mul_f32_e64 v212, v64, s56
    v_mul_f32_e64 v213, v65, s57
    v_mul_f32_e64 v214, v66, s56
    v_mul_f32_e64 v215, v67, s57
    v_mul_f32_e64 v216, v68, s56
    v_mul_f32_e64 v217, v69, s57
    s_waitcnt lgkmcnt(12)
    v_mfma_f32_32x32x16_bf16 v[96:111], v[20:23], v[52:55], v[96:111]
    v_mul_f32_e64 v218, v70, s56
    v_mul_f32_e64 v219, v71, s57
    v_exp_f32_e64 v212, v212 clamp
    v_max_f32 v64, s58, v64
    v_mfma_f32_32x32x16_bf16 v[112:127], v[20:23], v[56:59], v[112:127]
    v_exp_f32_e64 v213, v213 clamp
    v_max_f32_e64 v65, s58, v65
    v_exp_f32_e64 v214, v214 clamp
    v_max_f32 v66, s58, v66
    s_waitcnt lgkmcnt(10)
    v_mfma_f32_32x32x16_bf16 v[96:111], v[24:27], v[160:163], v[96:111]
    v_exp_f32_e64 v215, v215 clamp
    v_max_f32_e64 v67, s58, v67
    v_exp_f32_e64 v216, v216 clamp
    v_max_f32_e64 v68, s58, v68
    v_mfma_f32_32x32x16_bf16 v[112:127], v[24:27], v[172:175], v[112:127]
    v_exp_f32_e64 v217, v217 clamp
    v_max_f32_e64 v69, s58, v69
    v_exp_f32_e64 v218, v218 clamp
    v_max_f32 v70, s58, v70
    s_waitcnt lgkmcnt(8)
    v_mfma_f32_32x32x16_bf16 v[96:111], v[28:31], v[168:171], v[96:111]
    v_exp_f32_e64 v219, v219 clamp
    v_max_f32_e64 v71, s58, v71
    v_add_f32_e64 v212, v212, v64
    v_add_f32_e64 v213, v213, v65
    v_add_f32_e64 v214, v214, v66
    v_mfma_f32_32x32x16_bf16 v[112:127], v[28:31], v[180:183], v[112:127]
    v_add_f32_e64 v215, v215, v67
    v_add_f32_e64 v216, v216, v68
    v_add_f32_e64 v217, v217, v69
    v_add_f32_e64 v218, v218, v70
    v_add_f32_e64 v219, v219, v71
    v_cvt_pk_bf16_f32 v128, v212, v213
    s_nop 0
    s_waitcnt lgkmcnt(6)
    v_mfma_f32_32x32x16_bf16 v[96:111], v[32:35], v[188:191], v[96:111]
    v_cvt_pk_bf16_f32 v129, v214, v215
    v_cvt_pk_bf16_f32 v130, v216, v217
    v_cvt_pk_bf16_f32 v131, v218, v219
    v_and_or_b32 v128, v128, v4, s16
    v_and_or_b32 v129, v129, v4, s17
    v_and_or_b32 v130, v130, v4, s0
    v_mfma_f32_32x32x16_bf16 v[112:127], v[32:35], v[192:195], v[112:127]
    v_and_or_b32 v131, v131, v4, s1
    buffer_store_dwordx4 v[128:131], v2, s[36:39], s65 offen offset:0 sc1
    v_mul_f32_e64 v212, v72, s56
    v_mul_f32_e64 v213, v73, s57
    v_mul_f32_e64 v214, v74, s56
    v_mul_f32_e64 v215, v75, s57
    s_nop 0
    s_waitcnt lgkmcnt(4)
    v_mfma_f32_32x32x16_bf16 v[96:111], v[36:39], v[196:199], v[96:111]
    v_mul_f32_e64 v216, v76, s56
    v_mul_f32_e64 v217, v77, s57
    v_mul_f32_e64 v218, v78, s56
    v_mul_f32_e64 v219, v79, s57
    v_exp_f32_e64 v212, v212 clamp
    v_mfma_f32_32x32x16_bf16 v[112:127], v[36:39], v[200:203], v[112:127]
    v_max_f32_e64 v72, s58, v72
    v_exp_f32_e64 v213, v213 clamp
    v_max_f32_e64 v73, s58, v73
    v_exp_f32_e64 v214, v214 clamp
    s_waitcnt lgkmcnt(2)
    v_mfma_f32_32x32x16_bf16 v[96:111], v[40:43], v[208:211], v[96:111]
    v_max_f32 v74, s58, v74
    v_exp_f32_e64 v215, v215 clamp
    v_max_f32_e64 v75, s58, v75
    v_exp_f32_e64 v216, v216 clamp
    v_mfma_f32_32x32x16_bf16 v[112:127], v[40:43], v[228:231], v[112:127]
    v_max_f32_e64 v76, s58, v76
    v_exp_f32_e64 v217, v217 clamp
    v_max_f32_e64 v77, s58, v77
    v_exp_f32_e64 v218, v218 clamp
    s_waitcnt lgkmcnt(0)
    v_mfma_f32_32x32x16_bf16 v[96:111], v[60:63], v[224:227], v[96:111]
    v_max_f32 v78, s58, v78
    v_exp_f32_e64 v219, v219 clamp
    v_max_f32_e64 v79, s58, v79
    v_add_f32_e64 v212, v212, v72
    v_add_f32_e64 v213, v213, v73
    v_mfma_f32_32x32x16_bf16 v[112:127], v[60:63], v[236:239], v[112:127]
    v_add_f32_e64 v214, v214, v74
    v_add_f32_e64 v215, v215, v75
    v_add_f32_e64 v216, v216, v76
    v_add_f32_e64 v217, v217, v77
    v_add_f32_e64 v218, v218, v78
    v_add_f32_e64 v219, v219, v79
    ds_write_b64 v14, v[12:13]
    v_cvt_pk_bf16_f32 v132, v212, v213
    v_cvt_pk_bf16_f32 v133, v214, v215
    v_cvt_pk_bf16_f32 v134, v216, v217
    v_cvt_pk_bf16_f32 v135, v218, v219
    v_and_or_b32 v132, v132, v4, s16
    v_and_or_b32 v133, v133, v4, s17
    v_and_or_b32 v134, v134, v4, s0
    v_and_or_b32 v135, v135, v4, s1
    buffer_store_dwordx4 v[132:135], v2, s[36:39], s65 offen offset:2048 sc1
    v_pk_mul_f32 v[212:213], v[80:81], s[56:57]
    v_pk_mul_f32 v[214:215], v[82:83], s[56:57]
    v_pk_mul_f32 v[216:217], v[84:85], s[56:57]
    v_pk_mul_f32 v[218:219], v[86:87], s[56:57]
    v_exp_f32_e64 v212, v212 clamp
    v_max_f32_e64 v80, s58, v80
    v_exp_f32_e64 v213, v213 clamp
    v_max_f32_e64 v81, s58, v81
    v_exp_f32_e64 v214, v214 clamp
    v_max_f32_e64 v82, s58, v82
    v_exp_f32_e64 v215, v215 clamp
    v_max_f32_e64 v83, s58, v83
    v_exp_f32_e64 v216, v216 clamp
    v_max_f32_e64 v84, s58, v84
    v_exp_f32_e64 v217, v217 clamp
    v_max_f32_e64 v85, s58, v85
    v_exp_f32_e64 v218, v218 clamp
    v_max_f32_e64 v86, s58, v86
    v_exp_f32_e64 v219, v219 clamp
    v_max_f32_e64 v87, s58, v87
    v_pk_add_f32 v[212:213], v[212:213], v[80:81]
    v_pk_add_f32 v[214:215], v[214:215], v[82:83]
    v_pk_add_f32 v[216:217], v[216:217], v[84:85]
    v_pk_add_f32 v[218:219], v[218:219], v[86:87]
    v_cvt_pk_bf16_f32 v136, v212, v213
    v_cvt_pk_bf16_f32 v137, v214, v215
    v_cvt_pk_bf16_f32 v138, v216, v217
    v_cvt_pk_bf16_f32 v139, v218, v219
    v_and_or_b32 v136, v136, v4, s16
    v_and_or_b32 v137, v137, v4, s17
    v_and_or_b32 v138, v138, v4, s0
    v_and_or_b32 v139, v139, v4, s1
    buffer_store_dwordx4 v[136:139], v2, s[36:39], s65 offen offset:1024 sc1
    v_pk_mul_f32 v[212:213], v[88:89], s[56:57]
    v_pk_mul_f32 v[214:215], v[90:91], s[56:57]
    v_pk_mul_f32 v[216:217], v[92:93], s[56:57]
    v_pk_mul_f32 v[218:219], v[94:95], s[56:57]
    v_exp_f32_e64 v212, v212 clamp
    v_max_f32_e64 v88, s58, v88
    v_exp_f32_e64 v213, v213 clamp
    v_max_f32_e64 v89, s58, v89
    v_exp_f32_e64 v214, v214 clamp
    v_max_f32_e64 v90, s58, v90
    v_exp_f32_e64 v215, v215 clamp
    v_max_f32_e64 v91, s58, v91
    v_exp_f32_e64 v216, v216 clamp
    v_max_f32_e64 v92, s58, v92
    v_exp_f32_e64 v217, v217 clamp
    v_max_f32_e64 v93, s58, v93
    v_exp_f32_e64 v218, v218 clamp
    v_max_f32_e64 v94, s58, v94
    v_exp_f32_e64 v219, v219 clamp
    v_max_f32_e64 v95, s58, v95
    v_pk_add_f32 v[212:213], v[212:213], v[88:89]
    v_pk_add_f32 v[214:215], v[214:215], v[90:91]
    v_pk_add_f32 v[216:217], v[216:217], v[92:93]
    v_pk_add_f32 v[218:219], v[218:219], v[94:95]
    v_cvt_pk_bf16_f32 v140, v212, v213
    v_cvt_pk_bf16_f32 v141, v214, v215
    v_cvt_pk_bf16_f32 v142, v216, v217
    v_cvt_pk_bf16_f32 v143, v218, v219
    v_and_or_b32 v140, v140, v4, s16
    v_and_or_b32 v141, v141, v4, s17
    v_and_or_b32 v142, v142, v4, s0
    v_and_or_b32 v143, v143, v4, s1
    buffer_store_dwordx4 v[140:143], v2, s[36:39], s65 offen offset:3072 sc1
    v_pk_mul_f32 v[212:213], v[96:97], s[56:57]
    v_pk_mul_f32 v[214:215], v[98:99], s[56:57]
    v_pk_mul_f32 v[216:217], v[100:101], s[56:57]
    v_pk_mul_f32 v[218:219], v[102:103], s[56:57]
    v_exp_f32_e64 v212, v212 clamp
    v_max_f32_e64 v96, s58, v96
    v_exp_f32_e64 v213, v213 clamp
    v_max_f32_e64 v97, s58, v97
    v_exp_f32_e64 v214, v214 clamp
    v_max_f32_e64 v98, s58, v98
    v_exp_f32_e64 v215, v215 clamp
    v_max_f32_e64 v99, s58, v99
    v_exp_f32_e64 v216, v216 clamp
    v_max_f32_e64 v100, s58, v100
    v_exp_f32_e64 v217, v217 clamp
    v_max_f32_e64 v101, s58, v101
    v_exp_f32_e64 v218, v218 clamp
    v_max_f32_e64 v102, s58, v102
    v_exp_f32_e64 v219, v219 clamp
    v_max_f32_e64 v103, s58, v103
    v_pk_add_f32 v[212:213], v[212:213], v[96:97]
    v_pk_add_f32 v[214:215], v[214:215], v[98:99]
    v_pk_add_f32 v[216:217], v[216:217], v[100:101]
    v_pk_add_f32 v[218:219], v[218:219], v[102:103]
    v_cvt_pk_bf16_f32 v144, v212, v213
    v_cvt_pk_bf16_f32 v145, v214, v215
    v_cvt_pk_bf16_f32 v146, v216, v217
    v_cvt_pk_bf16_f32 v147, v218, v219
    v_and_or_b32 v144, v144, v4, s16
    v_and_or_b32 v145, v145, v4, s17
    v_and_or_b32 v146, v146, v4, s0
    v_and_or_b32 v147, v147, v4, s1
    buffer_store_dwordx4 v[144:147], v2, s[36:39], s67 offen offset:0 sc1
    v_pk_mul_f32 v[212:213], v[104:105], s[56:57]
    v_pk_mul_f32 v[214:215], v[106:107], s[56:57]
    v_pk_mul_f32 v[216:217], v[108:109], s[56:57]
    v_pk_mul_f32 v[218:219], v[110:111], s[56:57]
    v_exp_f32_e64 v212, v212 clamp
    v_max_f32_e64 v104, s58, v104
    v_exp_f32_e64 v213, v213 clamp
    v_max_f32_e64 v105, s58, v105
    v_exp_f32_e64 v214, v214 clamp
    v_max_f32_e64 v106, s58, v106
    v_exp_f32_e64 v215, v215 clamp
    v_max_f32_e64 v107, s58, v107
    v_exp_f32_e64 v216, v216 clamp
    v_max_f32_e64 v108, s58, v108
    v_exp_f32_e64 v217, v217 clamp
    v_max_f32_e64 v109, s58, v109
    v_exp_f32_e64 v218, v218 clamp
    v_max_f32_e64 v110, s58, v110
    v_exp_f32_e64 v219, v219 clamp
    v_max_f32_e64 v111, s58, v111
    v_pk_add_f32 v[212:213], v[212:213], v[104:105]
    v_pk_add_f32 v[214:215], v[214:215], v[106:107]
    v_pk_add_f32 v[216:217], v[216:217], v[108:109]
    v_pk_add_f32 v[218:219], v[218:219], v[110:111]
    v_cvt_pk_bf16_f32 v148, v212, v213
    v_cvt_pk_bf16_f32 v149, v214, v215
    v_cvt_pk_bf16_f32 v150, v216, v217
    v_cvt_pk_bf16_f32 v151, v218, v219
    v_and_or_b32 v148, v148, v4, s16
    v_and_or_b32 v149, v149, v4, s17
    v_and_or_b32 v150, v150, v4, s0
    v_and_or_b32 v151, v151, v4, s1
    buffer_store_dwordx4 v[148:151], v2, s[36:39], s67 offen offset:2048 sc1
    v_pk_mul_f32 v[212:213], v[112:113], s[56:57]
    v_pk_mul_f32 v[214:215], v[114:115], s[56:57]
    v_pk_mul_f32 v[216:217], v[116:117], s[56:57]
    v_pk_mul_f32 v[218:219], v[118:119], s[56:57]
    v_exp_f32_e64 v212, v212 clamp
    v_max_f32_e64 v112, s58, v112
    v_exp_f32_e64 v213, v213 clamp
    v_max_f32_e64 v113, s58, v113
    v_exp_f32_e64 v214, v214 clamp
    v_max_f32_e64 v114, s58, v114
    v_exp_f32_e64 v215, v215 clamp
    v_max_f32_e64 v115, s58, v115
    v_exp_f32_e64 v216, v216 clamp
    v_max_f32_e64 v116, s58, v116
    v_exp_f32_e64 v217, v217 clamp
    v_max_f32_e64 v117, s58, v117
    v_exp_f32_e64 v218, v218 clamp
    v_max_f32_e64 v118, s58, v118
    v_exp_f32_e64 v219, v219 clamp
    v_max_f32_e64 v119, s58, v119
    v_pk_add_f32 v[212:213], v[212:213], v[112:113]
    v_pk_add_f32 v[214:215], v[214:215], v[114:115]
    v_pk_add_f32 v[216:217], v[216:217], v[116:117]
    v_pk_add_f32 v[218:219], v[218:219], v[118:119]
    v_cvt_pk_bf16_f32 v152, v212, v213
    v_cvt_pk_bf16_f32 v153, v214, v215
    v_cvt_pk_bf16_f32 v154, v216, v217
    v_cvt_pk_bf16_f32 v155, v218, v219
    v_and_or_b32 v152, v152, v4, s16
    v_and_or_b32 v153, v153, v4, s17
    v_and_or_b32 v154, v154, v4, s0
    v_and_or_b32 v155, v155, v4, s1
    buffer_store_dwordx4 v[152:155], v2, s[36:39], s67 offen offset:1024 sc1
    v_pk_mul_f32 v[212:213], v[120:121], s[56:57]
    v_pk_mul_f32 v[214:215], v[122:123], s[56:57]
    v_pk_mul_f32 v[216:217], v[124:125], s[56:57]
    v_pk_mul_f32 v[218:219], v[126:127], s[56:57]
    v_exp_f32_e64 v212, v212 clamp
    v_max_f32_e64 v120, s58, v120
    v_exp_f32_e64 v213, v213 clamp
    v_max_f32_e64 v121, s58, v121
    v_exp_f32_e64 v214, v214 clamp
    v_max_f32_e64 v122, s58, v122
    v_exp_f32_e64 v215, v215 clamp
    v_max_f32_e64 v123, s58, v123
    v_exp_f32_e64 v216, v216 clamp
    v_max_f32_e64 v124, s58, v124
    v_exp_f32_e64 v217, v217 clamp
    v_max_f32_e64 v125, s58, v125
    v_exp_f32_e64 v218, v218 clamp
    v_max_f32_e64 v126, s58, v126
    v_exp_f32_e64 v219, v219 clamp
    v_max_f32_e64 v127, s58, v127
    v_pk_add_f32 v[212:213], v[212:213], v[120:121]
    v_pk_add_f32 v[214:215], v[214:215], v[122:123]
    v_pk_add_f32 v[216:217], v[216:217], v[124:125]
    v_pk_add_f32 v[218:219], v[218:219], v[126:127]
    v_cvt_pk_bf16_f32 v156, v212, v213
    v_cvt_pk_bf16_f32 v157, v214, v215
    v_cvt_pk_bf16_f32 v158, v216, v217
    v_cvt_pk_bf16_f32 v159, v218, v219
    v_and_or_b32 v156, v156, v4, s16
    v_and_or_b32 v157, v157, v4, s17
    v_and_or_b32 v158, v158, v4, s0
    v_and_or_b32 v159, v159, v4, s1
    buffer_store_dwordx4 v[156:159], v2, s[36:39], s67 offen offset:3072 sc1
WQ_1:
    s_waitcnt vmcnt(2) lgkmcnt(0)
    s_barrier
HELPER:
    s_lshl_b32 s62, s60, 7
    s_add_u32 s62, s62, 0x1000
    s_movk_i32 s34, 512
    s_xor_b32 s16, s16, 1
    s_xor_b32 s17, s17, 1
    s_xor_b32 s0, s0, 1
    s_xor_b32 s1, s1, 1
    s_branch B3_ENTRY
ROLE_B:
    s_load_dwordx16 s[16:31], s[0:1], 0
    s_load_dwordx2 s[32:33], s[0:1], 64
    s_waitcnt lgkmcnt(0)
    s_load_dwordx2 s[8:9], s[32:33], 0
    s_mov_b32 s36, s32
    s_mov_b32 s37, s33
    s_mov_b32 s38, 0x10000000
    s_mov_b32 s39, 0x20000
    v_lshrrev_b32 v4, 5, v1
    v_and_b32 v5, 31, v1
    v_lshlrev_b32_e64 v6, 4, v5
    v_lshl_add_u32 v3, s3, 3, v4
    v_xor_b32_e64 v3, s60, v3
    v_lshl_add_u32 v3, v3, 9, v6
    v_lshl_add_u32 v11, v4, 3, s3
    v_xor_b32_e64 v8, s60, v11
    v_lshl_add_u32 v11, v11, 15, v6
    v_lshl_add_u32 v11, v8, 9, v11
    s_lshl_b32 s66, s60, 15
    s_add_u32 s66, s66, 0x400000
    s_mov_b32 s13, 0x400000
    v_mov_b32 v14, 0xfffefffe
    s_lshl_b32 s67, s4, 10
    s_add_u32 s67, s67, 0x60000
    v_and_b32 v12, 15, v1
    v_lshrrev_b32 v13, 4, v1
    s_xor_b32 s71, s61, 7
    s_xor_b32 s62, s3, 3
    s_or_b32 s71, s71, s62
    s_bitcmp1_b32 s61, 0
    s_cselect_b64 s[48:49], s[26:27], s[24:25]
    s_cselect_b64 s[52:53], s[24:25], s[26:27]
    s_cselect_b32 s34, 0x8000, 0
    s_mov_b32 s50, 0x101000
    s_mov_b32 s51, 0x20000
    s_mov_b32 s54, 0x101000
    s_mov_b32 s55, 0x20000
    s_add_u32 s34, s34, s70
    s_add_u32 s34, s34, 65536
    s_xor_b32 s35, s34, 0x8000
    s_mov_b32 s40, s28
    s_mov_b32 s41, s29
    s_mov_b32 s42, 0x400000
    s_mov_b32 s43, 0x20000
    v_cvt_f32_u32 v16, v5
    s_bfe_u32 s62, s3, 0x10001
    s_and_b32 s63, s3, 1
    s_lshl2_add_u32 s62, s62, s63
    s_lshl_b32 s62, s62, 7
    s_add_u32 s62, s62, s60
    v_lshl_add_u32 v17, v4, 8, s62
    v_cvt_f32_u32 v17, v17
    v_mul_f32 v17, v17, v16
    s_lshr_b32 s62, s3, 2
    v_xor_b32 v18, s62, v1
    v_lshlrev_b32_e64 v18, 31, v18
    v_or_b32 v18, 0x3e000000, v18
    v_fmamk_f32 v17, v17, 0x3a000000, v18
    v_fmamk_f32 v18, v16, 0x3d000000, v17
    s_lshl_b32 s62, s62, 31
    v_cos_f32 v20, v17
    v_sin_f32 v21, v17
    v_cos_f32 v22, v18
    v_sin_f32 v23, v18
    s_lshr_b32 s64, s3, 1
    s_lshl_b32 s64, s64, 10
    s_lshl3_add_u32 s64, s63, s64
    s_add_u32 s64, s64, 155648
    v_add_u32_e64 v15, s64, v2
    v_cvt_pk_bf16_f32 v24, v20, v21
    v_cvt_pk_bf16_f32 v25, v22, v23
    v_cvt_pk_bf16_f32 v26, -v21, v20
    v_cvt_pk_bf16_f32 v27, -v23, v22
    v_xor_b32 v24, s62, v24
    v_xor_b32 v25, s62, v25
    v_xor_b32 v26, s62, v26
    v_xor_b32 v27, s62, v27
    ds_write_b64 v15, v[24:25]
    ds_write_b64 v15, v[26:27] offset:4096
    v_and_b32 v136, 7, v1
    v_lshlrev_b32 v136, 6, v136
    s_add_u32 s62, s60, 0
    v_add_u32 v136, s62, v136
    v_cvt_f32_u32_e64 v136, v136
    v_mul_f32 v136, 0x3a000000, v136
    s_lshr_b32 s62, s3, 1
    s_and_b32 s15, s3, 1
    s_lshl2_add_u32 s14, s62, s15
    s_lshl_b32 s14, s14, 1
    v_lshrrev_b32_e64 v137, 5, v1
    v_lshl_add_u32 v137, v137, 2, s14
    v_cvt_f32_u32_e64 v137, v137
    v_bfe_u32 v138, v1, 3, 1
    v_cvt_f32_u32_e64 v138, v138
    v_mul_f32 v138, 0xbe800000, v138
    v_fma_f32 v137, v137, v136, v138
    v_lshlrev_b32_e64 v138, 27, v1
    v_and_b32 v138, 0x80000000, v138
    v_or_b32 v138, 0x3e000000, v138
    v_add_f32 v139, v137, v138
    v_sub_f32 v138, v136, v138
    v_add_f32 v138, v137, v138
    v_cos_f32 v136, v139
    v_sin_f32 v139, v139
    v_cos_f32 v137, v138
    v_sin_f32 v138, v138
    s_lshl_b32 s62, s62, 10
    s_lshl3_add_u32 s62, s15, s62
    s_add_u32 s62, s62, 155648
    v_add_u32 v142, s62, v2
    v_cvt_pk_bf16_f32 v140, v136, -v139
    v_cvt_pk_bf16_f32 v141, v137, -v138
    s_lshl_b32 s14, s60, 9
    s_add_u32 s14, s14, 0x600000
    s_and_b32 s63, s3, 1
    v_bfe_u32 v16, v1, 3, 2
    s_lshl_b32 s62, s4, 2
    v_add_u32 v17, s62, v16
    v_lshl_add_u32 v17, v4, 5, v17
    v_mul_u32_u24 v17, 514, v17
    v_and_b32 v17, -16, v17
    v_sub_u32 v16, v1, v16
    v_and_b32 v18, 7, v16
    v_xor_b32 v19, 4, v18
    v_cmp_gt_u32 s[68:69], 5, v18
    v_cmp_gt_u32 s[58:59], 5, v19
    v_lshl_add_u32 v128, v18, 4, v17
    v_lshl_add_u32 v129, v19, 4, v17
    v_lshl_add_u32 v7, v1, 3, s70
    s_lshr_b32 s62, s3, 1
    s_lshl_b32 s62, s62, 13
    s_lshl3_add_u32 s62, s63, s62
    s_add_u32 s62, s62, 32768
    v_lshlrev_b32 v8, 11, v13
    v_lshl_add_u32 v8, v12, 4, v8
    v_add_u32_e64 v8, s62, v8
    v_lshl_add_u32 v10, s3, 5, v5
    v_lshlrev_b32_e64 v130, 13, v4
    v_add_u32 v130, 32768, v130
    v_lshl_add_u32 v9, v10, 4, v130
    v_sub_u32_e64 v10, 0, v10
    v_and_b32 v10, 0x1ff, v10
    v_lshl_add_u32 v10, v10, 4, v130
    v_add_u32 v131, 131072, v2
    s_mul_i32 s62, s3, 131584
    s_lshl_b32 s63, s61, 6
    s_add_u32 s62, s62, s63
    s_add_u32 s63, s62, 31872
    s_add_u32 s64, s62, 63744
    s_add_u32 s65, s62, 95616
    s_waitcnt lgkmcnt(0)
    s_add_u32 s8, s8, 0x1e3779b1
    s_addc_u32 s9, s9, 0x5ebca6b
    s_and_b32 s6, s8, 0xbfffbfff
    s_and_b32 s7, s9, 0xbfffbfff
    s_bitcmp1_b32 s8, 0
    s_cselect_b32 s16, 0x10001, 0
    s_xor_b32 s17, s16, 0x10000
    s_xor_b32 s0, s16, 0x10001
    s_xor_b32 s1, s16, 1
    s_waitcnt vmcnt(4)
    s_nop 0
    s_barrier
    ds_read_b128 v[16:19], v131 offset:0
    ds_read_b128 v[20:23], v131 offset:1024
    ds_read_b128 v[24:27], v131 offset:2048
    ds_read_b128 v[28:31], v131 offset:3072
    ds_read_b128 v[32:35], v131 offset:4096
    ds_read_b128 v[36:39], v131 offset:5120
    s_nop 0
    s_waitcnt vmcnt(0)
WB_0:
    ds_read_b64_tr_b16 v[144:145], v7 offset:0
    ds_read_b64_tr_b16 v[146:147], v7 offset:512
    ds_read_b64_tr_b16 v[148:149], v7 offset:1024
    ds_read_b64_tr_b16 v[150:151], v7 offset:1536
    ds_read_b64_tr_b16 v[152:153], v7 offset:2048
    ds_read_b64_tr_b16 v[154:155], v7 offset:2560
    ds_read_b64_tr_b16 v[156:157], v7 offset:3072
    ds_read_b64_tr_b16 v[158:159], v7 offset:3584
    ds_read_b128 v[40:43], v131 offset:6144
    ds_read_b128 v[44:47], v131 offset:7168
    ds_read_b128 v[48:51], v131 offset:8192
    ds_read_b128 v[52:55], v131 offset:9216
    ds_read_b128 v[56:59], v131 offset:10240
    ds_read_b128 v[60:63], v131 offset:11264
    s_mov_b32 s22, 0x80000
    s_mov_b32 s23, 0x20000
    s_lshl3_add_u32 s15, s60, s3
    s_lshl_b32 s15, s15, 10
    buffer_load_dwordx4 v[116:119], v2, s[20:23], s15 offen
    s_mov_b64 exec, s[68:69]
    s_mov_b32 m0, s34
    s_nop 0
    buffer_load_dwordx4 v128, s[48:51], s62 offen offset:0  lds
    s_mov_b64 exec, -1
    s_nop 0
    s_waitcnt lgkmcnt(10)
    v_mfma_f32_16x16x32_bf16 v[160:163], v[144:147], v[16:19], 0
    v_mfma_f32_16x16x32_bf16 v[168:171], v[148:151], v[16:19], 0
    v_mfma_f32_16x16x32_bf16 v[160:163], v[148:151], v[24:27], v[160:163]
    v_mfma_f32_16x16x32_bf16 v[168:171], v[144:147], v[32:35], v[168:171]
    v_mfma_f32_16x16x32_bf16 v[164:167], v[144:147], v[20:23], 0
    v_mfma_f32_16x16x32_bf16 v[172:175], v[148:151], v[20:23], 0
    v_mfma_f32_16x16x32_bf16 v[164:167], v[148:151], v[28:31], v[164:167]
    v_mfma_f32_16x16x32_bf16 v[172:175], v[144:147], v[36:39], v[172:175]
    s_nop 0
    s_waitcnt lgkmcnt(6)
    v_mfma_f32_16x16x32_bf16 v[176:179], v[152:155], v[16:19], 0
    v_mfma_f32_16x16x32_bf16 v[184:187], v[156:159], v[16:19], 0
    v_mfma_f32_16x16x32_bf16 v[176:179], v[156:159], v[24:27], v[176:179]
    v_mfma_f32_16x16x32_bf16 v[184:187], v[152:155], v[32:35], v[184:187]
    v_mfma_f32_16x16x32_bf16 v[180:183], v[152:155], v[20:23], 0
    v_mfma_f32_16x16x32_bf16 v[188:191], v[156:159], v[20:23], 0
    v_mfma_f32_16x16x32_bf16 v[180:183], v[156:159], v[28:31], v[180:183]
    v_mfma_f32_16x16x32_bf16 v[188:191], v[152:155], v[36:39], v[188:191]
    s_mov_b64 exec, s[68:69]
    s_mov_b32 m0, s34
    s_nop 0
    buffer_load_dwordx4 v128, s[48:51], s63 offen offset:1024  lds
    s_mov_b64 exec, -1
    s_nop 0
    s_waitcnt lgkmcnt(0)
    ds_read_b128 v[64:67], v131 offset:24576
    ds_read_b128 v[68:71], v131 offset:25600
    ds_read_b128 v[72:75], v131 offset:26624
    ds_read_b128 v[76:79], v131 offset:27648
    ds_read_b128 v[80:83], v131 offset:28672
    ds_read_b128 v[84:87], v131 offset:29696
    ds_read_b128 v[88:91], v131 offset:30720
    ds_read_b128 v[92:95], v131 offset:31744
    v_pk_mul_f32 v[208:209], v[168:169], v[44:45]
    v_pk_mul_f32 v[210:211], v[160:161], v[44:45]
    v_pk_mul_f32 v[212:213], v[170:171], v[46:47]
    v_pk_mul_f32 v[214:215], v[162:163], v[46:47]
    v_pk_mul_f32 v[216:217], v[172:173], v[52:53]
    v_pk_mul_f32 v[218:219], v[164:165], v[52:53]
    v_pk_mul_f32 v[220:221], v[174:175], v[54:55]
    v_pk_mul_f32 v[222:223], v[166:167], v[54:55]
    v_pk_fma_f32 v[160:161], v[160:161], v[40:41], v[208:209]
    v_pk_fma_f32 v[168:169], v[168:169], v[40:41], v[210:211] neg_lo:[0,0,1] neg_hi:[0,0,1]
    v_pk_fma_f32 v[162:163], v[162:163], v[42:43], v[212:213]
    v_pk_fma_f32 v[170:171], v[170:171], v[42:43], v[214:215] neg_lo:[0,0,1] neg_hi:[0,0,1]
    v_pk_fma_f32 v[164:165], v[164:165], v[48:49], v[216:217]
    v_pk_fma_f32 v[172:173], v[172:173], v[48:49], v[218:219] neg_lo:[0,0,1] neg_hi:[0,0,1]
    v_pk_fma_f32 v[166:167], v[166:167], v[50:51], v[220:221]
    v_pk_fma_f32 v[174:175], v[174:175], v[50:51], v[222:223] neg_lo:[0,0,1] neg_hi:[0,0,1]
    v_cvt_pk_bf16_f32 v192, v160, v161
    v_cvt_pk_bf16_f32 v193, v162, v163
    v_cvt_pk_bf16_f32 v194, v168, v169
    v_cvt_pk_bf16_f32 v195, v170, v171
    v_cvt_pk_bf16_f32 v196, v164, v165
    v_cvt_pk_bf16_f32 v197, v166, v167
    v_cvt_pk_bf16_f32 v198, v172, v173
    v_cvt_pk_bf16_f32 v199, v174, v175
    v_mfma_f32_16x16x32_bf16 v[160:163], v[56:59], v[192:195], 0
    v_mfma_f32_16x16x32_bf16 v[168:171], v[60:63], v[192:195], 0
    v_mfma_f32_16x16x32_bf16 v[164:167], v[56:59], v[196:199], 0
    v_mfma_f32_16x16x32_bf16 v[172:175], v[60:63], v[196:199], 0
    s_mov_b64 exec, s[58:59]
    s_mov_b32 m0, s34
    s_nop 0
    buffer_load_dwordx4 v129, s[48:51], s64 offen offset:2048  lds
    s_mov_b64 exec, -1
    v_pk_mul_f32 v[224:225], v[184:185], v[44:45]
    v_pk_mul_f32 v[226:227], v[176:177], v[44:45]
    v_pk_mul_f32 v[228:229], v[186:187], v[46:47]
    v_pk_mul_f32 v[230:231], v[178:179], v[46:47]
    v_pk_mul_f32 v[232:233], v[188:189], v[52:53]
    v_pk_mul_f32 v[234:235], v[180:181], v[52:53]
    v_pk_mul_f32 v[236:237], v[190:191], v[54:55]
    v_pk_mul_f32 v[238:239], v[182:183], v[54:55]
    v_pk_fma_f32 v[176:177], v[176:177], v[40:41], v[224:225]
    v_pk_fma_f32 v[184:185], v[184:185], v[40:41], v[226:227] neg_lo:[0,0,1] neg_hi:[0,0,1]
    v_pk_fma_f32 v[178:179], v[178:179], v[42:43], v[228:229]
    v_pk_fma_f32 v[186:187], v[186:187], v[42:43], v[230:231] neg_lo:[0,0,1] neg_hi:[0,0,1]
    v_pk_fma_f32 v[180:181], v[180:181], v[48:49], v[232:233]
    v_pk_fma_f32 v[188:189], v[188:189], v[48:49], v[234:235] neg_lo:[0,0,1] neg_hi:[0,0,1]
    v_pk_fma_f32 v[182:183], v[182:183], v[50:51], v[236:237]
    v_pk_fma_f32 v[190:191], v[190:191], v[50:51], v[238:239] neg_lo:[0,0,1] neg_hi:[0,0,1]
    v_cvt_pk_bf16_f32 v200, v176, v177
    v_cvt_pk_bf16_f32 v201, v178, v179
    v_cvt_pk_bf16_f32 v202, v184, v185
    v_cvt_pk_bf16_f32 v203, v186, v187
    v_cvt_pk_bf16_f32 v204, v180, v181
    v_cvt_pk_bf16_f32 v205, v182, v183
    v_cvt_pk_bf16_f32 v206, v188, v189
    v_cvt_pk_bf16_f32 v207, v190, v191
    v_mfma_f32_16x16x32_bf16 v[176:179], v[56:59], v[200:203], 0
    v_mfma_f32_16x16x32_bf16 v[184:187], v[60:63], v[200:203], 0
    v_mfma_f32_16x16x32_bf16 v[180:183], v[56:59], v[204:207], 0
    v_mfma_f32_16x16x32_bf16 v[188:191], v[60:63], v[204:207], 0
    s_mov_b64 exec, s[58:59]
    s_mov_b32 m0, s34
    s_nop 0
    buffer_load_dwordx4 v129, s[48:51], s65 offen offset:3072  lds
    s_mov_b64 exec, -1
    v_cvt_pk_bf16_f32 v240, v160, v168
    v_cvt_pk_bf16_f32 v242, v161, v169
    v_cvt_pk_bf16_f32 v244, v162, v170
    v_cvt_pk_bf16_f32 v246, v163, v171
    v_cvt_pk_bf16_f32 v248, v164, v172
    v_cvt_pk_bf16_f32 v250, v165, v173
    v_cvt_pk_bf16_f32 v252, v166, v174
    v_cvt_pk_bf16_f32 v254, v167, v175
    v_cvt_pk_bf16_f32 v241, v176, v184
    ds_write_b64 v8, v[240:241] offset:0
    v_cvt_pk_bf16_f32 v243, v177, v185
    ds_write_b64 v8, v[242:243] offset:512
    v_cvt_pk_bf16_f32 v245, v178, v186
    ds_write_b64 v8, v[244:245] offset:1024
    v_cvt_pk_bf16_f32 v247, v179, v187
    ds_write_b64 v8, v[246:247] offset:1536
    v_cvt_pk_bf16_f32 v249, v180, v188
    ds_write_b64 v8, v[248:249] offset:256
    v_cvt_pk_bf16_f32 v251, v181, v189
    ds_write_b64 v8, v[250:251] offset:768
    v_cvt_pk_bf16_f32 v253, v182, v190
    ds_write_b64 v8, v[252:253] offset:1280
    v_cvt_pk_bf16_f32 v255, v183, v191
    ds_write_b64 v8, v[254:255] offset:1792
    s_waitcnt lgkmcnt(0)
    s_barrier
    ds_read_b128 v[144:147], v9 offset:0
    ds_read_b128 v[148:151], v9 offset:16384
    ds_read_b128 v[152:155], v10 offset:0
    ds_read_b128 v[156:159], v10 offset:16384
    s_waitcnt lgkmcnt(3)
    v_mfma_f32_32x32x16_bf16 v[160:175], v[64:67], v[144:147], 0
    v_mfma_f32_32x32x16_bf16 v[176:191], v[80:83], v[144:147], 0
    s_waitcnt lgkmcnt(2)
    v_mfma_f32_32x32x16_bf16 v[160:175], v[68:71], v[148:151], v[160:175]
    v_mfma_f32_32x32x16_bf16 v[176:191], v[84:87], v[148:151], v[176:191]
    s_waitcnt lgkmcnt(1)
    v_mfma_f32_32x32x16_bf16 v[160:175], v[72:75], v[152:155], v[160:175]
    v_mfma_f32_32x32x16_bf16 v[176:191], v[88:91], v[152:155], v[176:191]
    s_waitcnt lgkmcnt(0)
    v_mfma_f32_32x32x16_bf16 v[160:175], v[76:79], v[156:159], v[160:175]
    v_mfma_f32_32x32x16_bf16 v[176:191], v[92:95], v[156:159], v[176:191]
    ds_write_b64 v142, v[140:141]
    ds_read_b128 v[208:211], v130 offset:4096
    ds_read_b128 v[212:215], v130 offset:20480
    v_lshlrev_b32_e64 v16, 1, v6
    v_lshl_add_u32 v16, v4, 4, v16
    s_nop 0
    s_nop 4
    v_cvt_pk_bf16_f32 v192, v160, v161
    v_cvt_pk_bf16_f32 v194, v176, v177
    v_cvt_pk_bf16_f32 v193, v162, v163
    v_cvt_pk_bf16_f32 v195, v178, v179
    v_and_or_b32 v192, v192, v14, s16
    v_and_or_b32 v193, v193, v14, s17
    v_and_or_b32 v194, v194, v14, s0
    v_and_or_b32 v195, v195, v14, s1
    buffer_store_dwordx4 v[192:195], v11, s[36:39], s13 offen sc1
    v_xor_b32 v11, 0x82000, v11
    v_cvt_pk_bf16_f32 v196, v164, v165
    v_cvt_pk_bf16_f32 v198, v180, v181
    v_cvt_pk_bf16_f32 v197, v166, v167
    v_cvt_pk_bf16_f32 v199, v182, v183
    v_and_or_b32 v196, v196, v14, s16
    v_and_or_b32 v197, v197, v14, s17
    v_and_or_b32 v198, v198, v14, s0
    v_and_or_b32 v199, v199, v14, s1
    buffer_store_dwordx4 v[196:199], v11, s[36:39], s13 offen sc1
    v_xor_b32 v11, 0x186000, v11
    v_cvt_pk_bf16_f32 v200, v168, v169
    v_cvt_pk_bf16_f32 v202, v184, v185
    v_cvt_pk_bf16_f32 v201, v170, v171
    v_cvt_pk_bf16_f32 v203, v186, v187
    v_and_or_b32 v200, v200, v14, s16
    v_and_or_b32 v201, v201, v14, s17
    v_and_or_b32 v202, v202, v14, s0
    v_and_or_b32 v203, v203, v14, s1
    buffer_store_dwordx4 v[200:203], v11, s[36:39], s13 offen sc1
    v_xor_b32 v11, 0x82000, v11
    v_cvt_pk_bf16_f32 v204, v172, v173
    v_cvt_pk_bf16_f32 v206, v188, v189
    v_cvt_pk_bf16_f32 v205, v174, v175
    v_cvt_pk_bf16_f32 v207, v190, v191
    v_and_or_b32 v204, v204, v14, s16
    v_and_or_b32 v205, v205, v14, s17
    v_and_or_b32 v206, v206, v14, s0
    v_and_or_b32 v207, v207, v14, s1
    buffer_store_dwordx4 v[204:207], v11, s[36:39], s13 offen sc1
    s_waitcnt lgkmcnt(0)
    s_cmp_lg_u32 s3, 0
    s_nop 0
    s_cbranch_scc1 NOX_21
    v_mfma_f32_32x32x16_bf16 v[224:239], v[64:67], v[208:211], 0
    v_mfma_f32_32x32x16_bf16 v[240:255], v[80:83], v[208:211], 0
    v_mfma_f32_32x32x16_bf16 v[224:239], v[68:71], v[212:215], v[224:239]
    v_mfma_f32_32x32x16_bf16 v[240:255], v[84:87], v[212:215], v[240:255]
    v_mfma_f32_32x32x16_bf16 v[224:239], v[72:75], v[208:211], v[224:239]
    v_mfma_f32_32x32x16_bf16 v[240:255], v[88:91], v[208:211], v[240:255]
    v_mfma_f32_32x32x16_bf16 v[224:239], v[76:79], v[212:215], v[224:239]
    v_mfma_f32_32x32x16_bf16 v[240:255], v[92:95], v[212:215], v[240:255]
    s_mov_b32 exec_lo, 1
    s_mov_b32 exec_hi, 1
    s_nop 0
    s_nop 7
    v_cvt_pk_bf16_f32 v216, v224, v225
    v_cvt_pk_bf16_f32 v218, v240, v241
    v_cvt_pk_bf16_f32 v217, v226, v227
    v_cvt_pk_bf16_f32 v219, v242, v243
    s_mov_b32 exec_lo, 2
    s_mov_b32 exec_hi, 2
    v_cvt_pk_bf16_f32 v216, v228, v229
    v_cvt_pk_bf16_f32 v218, v244, v245
    v_cvt_pk_bf16_f32 v217, v230, v231
    v_cvt_pk_bf16_f32 v219, v246, v247
    s_mov_b32 exec_lo, 4
    s_mov_b32 exec_hi, 4
    v_cvt_pk_bf16_f32 v216, v232, v233
    v_cvt_pk_bf16_f32 v218, v248, v249
    v_cvt_pk_bf16_f32 v217, v234, v235
    v_cvt_pk_bf16_f32 v219, v250, v251
    s_mov_b32 exec_lo, 8
    s_mov_b32 exec_hi, 8
    v_cvt_pk_bf16_f32 v216, v236, v237
    v_cvt_pk_bf16_f32 v218, v252, v253
    v_cvt_pk_bf16_f32 v217, v238, v239
    v_cvt_pk_bf16_f32 v219, v254, v255
    s_mov_b32 exec_lo, 15
    s_mov_b32 exec_hi, 15
    v_and_or_b32 v216, v216, v14, s16
    v_and_or_b32 v217, v217, v14, s17
    v_and_or_b32 v218, v218, v14, s0
    v_and_or_b32 v219, v219, v14, s1
    buffer_store_dwordx4 v[216:219], v16, s[36:39], s14 offen sc1
    s_mov_b64 exec, -1
NOX_21:
    s_barrier
    s_mov_b64 exec, s[68:69]
    s_mov_b32 m0, s35
    s_nop 0
    buffer_load_dwordx4 v128, s[52:55], s62 offen offset:0 nt lds
    s_mov_b64 exec, -1
    s_mov_b64 exec, s[68:69]
    s_mov_b32 m0, s35
    s_nop 0
    buffer_load_dwordx4 v128, s[52:55], s63 offen offset:1024 nt lds
    s_mov_b64 exec, -1
    s_mov_b64 exec, s[58:59]
    s_mov_b32 m0, s35
    s_nop 0
    buffer_load_dwordx4 v129, s[52:55], s64 offen offset:2048 nt lds
    s_mov_b64 exec, -1
    s_mov_b64 exec, s[58:59]
    s_mov_b32 m0, s35
    s_nop 0
    buffer_load_dwordx4 v129, s[52:55], s65 offen offset:3072 nt lds
    s_mov_b64 exec, -1
    ds_read_b128 v[16:19], v131 offset:16384
    ds_read_b128 v[20:23], v131 offset:17408
    ds_read_b128 v[24:27], v131 offset:18432
    ds_read_b128 v[28:31], v131 offset:19456
    ds_read_b128 v[176:179], v131 offset:20480
    ds_read_b128 v[180:183], v131 offset:21504
    ds_read_b128 v[184:187], v131 offset:22528
    ds_read_b128 v[188:191], v131 offset:23552
    v_lshrrev_b32 v11, 2, v1
    v_xor_b32 v11, v11, v4
    v_lshlrev_b32 v129, 9, v11
    v_and_b32 v11, 3, v1
    v_lshl_add_u32 v129, v11, 4, v129
    s_lshl_b32 s62, s4, 4
    v_xor_b32 v129, s62, v129
    v_bfe_u32 v6, v1, 2, 3
    v_lshlrev_b32_e64 v6, 12, v6
    v_lshl_add_u32 v6, v11, 4, v6
    s_and_b32 s62, s3, 1
    v_xor_b32 v11, s62, v4
    v_lshl_add_u32 v6, v11, 6, v6
    s_lshl_b32 s62, s3, 9
    s_add_u32 s62, s62, 32768
    v_add_u32 v6, s62, v6
    v_xor_b32 v11, 0x400, v3
    v_xor_b32 v134, 0x800, v3
    v_xor_b32 v135, 0xc00, v3
    s_add_u32 s70, s70, 32768
    v_and_b32_e64 v132, 1, v13
    v_lshl_add_u32 v132, v13, 3, v132
    v_bfe_u32 v133, v1, 3, 1
    v_lshl_add_u32 v132, v133, 1, v132
    v_lshlrev_b32 v132, 6, v132
    v_and_b32 v133, 3, v1
    v_lshl_add_u32 v132, v133, 4, v132
    v_bfe_u32 v133, v1, 2, 1
    v_lshl_add_u32 v132, v133, 3, v132
    v_add_u32 v132, s70, v132
    v_xor_b32 v133, 64, v132
    v_lshrrev_b32_e64 v96, 2, v12
    v_lshl_add_u32 v96, s3, 2, v96
    v_and_b32 v98, 3, v12
    s_lshl_b32 s15, s4, 2
    v_add_u32 v97, s15, v98
    v_and_b32 v97, 7, v97
    v_add_lshl_u32 v97, v97, v96, 1
    v_lshl_add_u32 v97, v98, 4, v97
    v_lshl_add_u32 v97, v13, 6, v97
    v_and_b32 v97, 0x7f, v97
    v_lshl_add_u32 v97, v98, 7, v97
    v_lshl_add_u32 v97, v13, 11, v97
    v_add_u32 v128, 65536, v97
    v_lshl_add_u32 v15, s3, 2, v13
    v_and_b32 v5, 7, v12
    v_xor_b32 v15, v15, v5
    v_lshlrev_b32_e64 v15, 4, v15
    v_lshl_add_u32 v15, v12, 10, v15
    s_and_b32 s63, s3, 1
    s_lshl_b32 s64, s63, 6
    v_xor_b32 v7, s64, v2
    s_lshl_b32 s64, s3, 12
    v_add_u32 v7, s64, v7
    v_xor_b32 v136, 16, v7
    v_xor_b32 v137, 32, v7
    v_xor_b32 v138, 48, v7
    s_mov_b32 s64, 0x80008000
    s_waitcnt lgkmcnt(0)
    v_mov_b32 v32, v16
    v_xor_b32 v33, s64, v17
    v_mov_b32 v34, v18
    v_xor_b32 v35, s64, v19
    v_mov_b32 v36, v20
    v_xor_b32 v37, s64, v21
    v_mov_b32 v38, v22
    v_xor_b32 v39, s64, v23
    v_mov_b32 v40, v24
    v_xor_b32 v41, s64, v25
    v_mov_b32 v42, v26
    v_xor_b32 v43, s64, v27
    v_mov_b32 v44, v28
    v_xor_b32 v45, s64, v29
    v_mov_b32 v46, v30
    v_xor_b32 v47, s64, v31
    s_waitcnt vmcnt(0)
    s_nop 0
    s_barrier
    ds_read_u16_d16_hi v144, v128 offset:0
    ds_read_u16_d16_hi v145, v128 offset:512
    ds_read_u16_d16_hi v146, v128 offset:1024
    ds_read_u16_d16_hi v147, v128 offset:1536
    ds_read_u16_d16_hi v148, v128 offset:8192
    ds_read_u16_d16_hi v149, v128 offset:8704
    ds_read_u16_d16_hi v150, v128 offset:9216
    ds_read_u16_d16_hi v151, v128 offset:9728
    ds_read_u16_d16_hi v152, v128 offset:16384
    ds_read_u16_d16_hi v153, v128 offset:16896
    ds_read_u16_d16_hi v154, v128 offset:17408
    ds_read_u16_d16_hi v155, v128 offset:17920
    ds_read_u16_d16_hi v156, v128 offset:24576
    ds_read_u16_d16_hi v157, v128 offset:25088
    ds_read_u16_d16_hi v158, v128 offset:25600
    ds_read_u16_d16_hi v159, v128 offset:26112
    ds_read_u16_d16_hi v160, v128 offset:32768
    ds_read_u16_d16_hi v161, v128 offset:33280
    ds_read_u16_d16_hi v162, v128 offset:33792
    ds_read_u16_d16_hi v163, v128 offset:34304
    ds_read_u16_d16_hi v164, v128 offset:40960
    ds_read_u16_d16_hi v165, v128 offset:41472
    ds_read_u16_d16_hi v166, v128 offset:41984
    ds_read_u16_d16_hi v167, v128 offset:42496
    ds_read_u16_d16_hi v168, v128 offset:49152
    ds_read_u16_d16_hi v169, v128 offset:49664
    ds_read_u16_d16_hi v170, v128 offset:50176
    ds_read_u16_d16_hi v171, v128 offset:50688
    ds_read_u16_d16_hi v172, v128 offset:57344
    ds_read_u16_d16_hi v173, v128 offset:57856
    ds_read_u16_d16_hi v174, v128 offset:58368
    ds_read_u16_d16_hi v175, v128 offset:58880
    s_nop 0
    s_waitcnt lgkmcnt(0)
    v_pk_add_f32 v[48:49], v[144:145], v[152:153]
    v_pk_add_f32 v[56:57], v[160:161], v[168:169]
    v_pk_add_f32 v[144:145], v[144:145], v[152:153] neg_lo:[0,1] neg_hi:[0,1]
    v_pk_add_f32 v[160:161], v[160:161], v[168:169] neg_lo:[0,1] neg_hi:[0,1]
    v_pk_add_f32 v[50:51], v[146:147], v[154:155]
    v_pk_add_f32 v[58:59], v[162:163], v[170:171]
    v_pk_add_f32 v[146:147], v[146:147], v[154:155] neg_lo:[0,1] neg_hi:[0,1]
    v_pk_add_f32 v[162:163], v[162:163], v[170:171] neg_lo:[0,1] neg_hi:[0,1]
    v_pk_add_f32 v[52:53], v[148:149], v[156:157]
    v_pk_add_f32 v[60:61], v[164:165], v[172:173]
    v_pk_add_f32 v[148:149], v[148:149], v[156:157] neg_lo:[0,1] neg_hi:[0,1]
    v_pk_add_f32 v[164:165], v[164:165], v[172:173] neg_lo:[0,1] neg_hi:[0,1]
    v_pk_add_f32 v[54:55], v[150:151], v[158:159]
    v_pk_add_f32 v[62:63], v[166:167], v[174:175]
    v_pk_add_f32 v[150:151], v[150:151], v[158:159] neg_lo:[0,1] neg_hi:[0,1]
    v_pk_add_f32 v[166:167], v[166:167], v[174:175] neg_lo:[0,1] neg_hi:[0,1]
    v_pk_mul_f32 v[152:153], v[160:161], v[184:185]
    v_pk_mul_f32 v[168:169], v[144:145], v[184:185]
    v_pk_fma_f32 v[64:65], v[144:145], v[176:177], v[152:153]
    v_pk_fma_f32 v[72:73], v[160:161], v[176:177], v[168:169] neg_lo:[0,0,1] neg_hi:[0,0,1]
    v_pk_fma_f32 v[80:81], v[144:145], v[176:177], v[152:153] neg_lo:[0,0,1] neg_hi:[0,0,1]
    v_pk_fma_f32 v[88:89], v[160:161], v[176:177], v[168:169]
    v_pk_mul_f32 v[154:155], v[162:163], v[186:187]
    v_pk_mul_f32 v[170:171], v[146:147], v[186:187]
    v_pk_fma_f32 v[66:67], v[146:147], v[178:179], v[154:155]
    v_pk_fma_f32 v[74:75], v[162:163], v[178:179], v[170:171] neg_lo:[0,0,1] neg_hi:[0,0,1]
    v_pk_fma_f32 v[82:83], v[146:147], v[178:179], v[154:155] neg_lo:[0,0,1] neg_hi:[0,0,1]
    v_pk_fma_f32 v[90:91], v[162:163], v[178:179], v[170:171]
    v_pk_mul_f32 v[156:157], v[164:165], v[188:189]
    v_pk_mul_f32 v[172:173], v[148:149], v[188:189]
    v_pk_fma_f32 v[68:69], v[148:149], v[180:181], v[156:157]
    v_pk_fma_f32 v[76:77], v[164:165], v[180:181], v[172:173] neg_lo:[0,0,1] neg_hi:[0,0,1]
    v_pk_fma_f32 v[84:85], v[148:149], v[180:181], v[156:157] neg_lo:[0,0,1] neg_hi:[0,0,1]
    v_pk_fma_f32 v[92:93], v[164:165], v[180:181], v[172:173]
    v_pk_mul_f32 v[158:159], v[166:167], v[190:191]
    v_pk_mul_f32 v[174:175], v[150:151], v[190:191]
    v_pk_fma_f32 v[70:71], v[150:151], v[182:183], v[158:159]
    v_pk_fma_f32 v[78:79], v[166:167], v[182:183], v[174:175] neg_lo:[0,0,1] neg_hi:[0,0,1]
    v_pk_fma_f32 v[86:87], v[150:151], v[182:183], v[158:159] neg_lo:[0,0,1] neg_hi:[0,0,1]
    v_pk_fma_f32 v[94:95], v[166:167], v[182:183], v[174:175]
    s_cmp_lg_u32 s71, 0
    s_cbranch_scc1 NOSP_22
    s_mov_b32 s56, 0x600000
    s_mov_b32 s57, 0x602000
    s_mov_b32 s58, 0x604000
    s_mov_b32 s59, 0x606000
    buffer_load_dwordx4 v[112:115], v129, s[36:39], s56 offen sc1
    buffer_load_dwordx4 v[116:119], v129, s[36:39], s57 offen sc1
    buffer_load_dwordx4 v[120:123], v129, s[36:39], s58 offen sc1
    buffer_load_dwordx4 v[124:127], v129, s[36:39], s59 offen sc1
NOSP_22:
    buffer_load_dwordx4 v[96:99], v3, s[36:39], s66 offen sc1
    buffer_load_dwordx4 v[100:103], v11, s[36:39], s66 offen sc1
    buffer_load_dwordx4 v[104:107], v134, s[36:39], s66 offen sc1
    buffer_load_dwordx4 v[108:111], v135, s[36:39], s66 offen sc1
    s_cmp_lg_u32 s71, 0
    s_cbranch_scc1 NOSP_23
    v_mov_b32 v192, 32
    v_and_b32 v194, 3, v12
    s_lshl_b32 s15, s4, 2
    v_add_u32 v193, s15, v194
    v_and_b32_e64 v193, 7, v193
    v_add_lshl_u32 v193, v193, v192, 1
    v_lshl_add_u32 v193, v194, 4, v193
    v_lshl_add_u32 v193, v13, 6, v193
    v_and_b32 v193, 0x7f, v193
    v_lshl_add_u32 v193, v194, 7, v193
    v_lshl_add_u32 v193, v13, 11, v193
    v_add_u32 v128, 65536, v193
    ds_read_u16_d16_hi v144, v128 offset:0
    ds_read_u16_d16_hi v145, v128 offset:512
    ds_read_u16_d16_hi v146, v128 offset:1024
    ds_read_u16_d16_hi v147, v128 offset:1536
    ds_read_u16_d16_hi v148, v128 offset:8192
    ds_read_u16_d16_hi v149, v128 offset:8704
    ds_read_u16_d16_hi v150, v128 offset:9216
    ds_read_u16_d16_hi v151, v128 offset:9728
    ds_read_u16_d16_hi v152, v128 offset:16384
    ds_read_u16_d16_hi v153, v128 offset:16896
    ds_read_u16_d16_hi v154, v128 offset:17408
    ds_read_u16_d16_hi v155, v128 offset:17920
    ds_read_u16_d16_hi v156, v128 offset:24576
    ds_read_u16_d16_hi v157, v128 offset:25088
    ds_read_u16_d16_hi v158, v128 offset:25600
    ds_read_u16_d16_hi v159, v128 offset:26112
    ds_read_u16_d16_hi v160, v128 offset:32768
    ds_read_u16_d16_hi v161, v128 offset:33280
    ds_read_u16_d16_hi v162, v128 offset:33792
    ds_read_u16_d16_hi v163, v128 offset:34304
    ds_read_u16_d16_hi v164, v128 offset:40960
    ds_read_u16_d16_hi v165, v128 offset:41472
    ds_read_u16_d16_hi v166, v128 offset:41984
    ds_read_u16_d16_hi v167, v128 offset:42496
    ds_read_u16_d16_hi v168, v128 offset:49152
    ds_read_u16_d16_hi v169, v128 offset:49664
    ds_read_u16_d16_hi v170, v128 offset:50176
    ds_read_u16_d16_hi v171, v128 offset:50688
    ds_read_u16_d16_hi v172, v128 offset:57344
    ds_read_u16_d16_hi v173, v128 offset:57856
    ds_read_u16_d16_hi v174, v128 offset:58368
    ds_read_u16_d16_hi v175, v128 offset:58880
    v_lshlrev_b32_e64 v192, 29, v1
    v_and_b32 v192, 0x80000000, v192
    v_and_b32 v193, 3, v1
    v_lshlrev_b32 v193, 4, v193
    v_xor_b32 v128, v132, v193
    v_and_b32 v193, 1, v1
    v_lshlrev_b32 v193, 6, v193
    v_xor_b32 v128, v128, v193
    v_subrev_u32_e64 v128, s70, v128
    v_add_u32 v128, 159744, v128
    v_add_u32 v5, 159744, v2
    v_xor_b32 v184, v192, v184
    v_xor_b32 v185, v192, v185
    v_xor_b32 v186, v192, v186
    v_xor_b32 v187, v192, v187
    v_xor_b32 v188, v192, v188
    v_xor_b32 v189, v192, v189
    v_xor_b32 v190, v192, v190
    v_xor_b32 v191, v192, v191
    s_nop 0
    s_waitcnt lgkmcnt(0)
    v_pk_add_f32 v[208:209], v[144:145], v[152:153]
    v_pk_add_f32 v[216:217], v[160:161], v[168:169]
    v_pk_add_f32 v[144:145], v[144:145], v[152:153] neg_lo:[0,1] neg_hi:[0,1]
    v_pk_add_f32 v[160:161], v[160:161], v[168:169] neg_lo:[0,1] neg_hi:[0,1]
    v_pk_add_f32 v[210:211], v[146:147], v[154:155]
    v_pk_add_f32 v[218:219], v[162:163], v[170:171]
    v_pk_add_f32 v[146:147], v[146:147], v[154:155] neg_lo:[0,1] neg_hi:[0,1]
    v_pk_add_f32 v[162:163], v[162:163], v[170:171] neg_lo:[0,1] neg_hi:[0,1]
    v_pk_add_f32 v[212:213], v[148:149], v[156:157]
    v_pk_add_f32 v[220:221], v[164:165], v[172:173]
    v_pk_add_f32 v[148:149], v[148:149], v[156:157] neg_lo:[0,1] neg_hi:[0,1]
    v_pk_add_f32 v[164:165], v[164:165], v[172:173] neg_lo:[0,1] neg_hi:[0,1]
    v_pk_add_f32 v[214:215], v[150:151], v[158:159]
    v_pk_add_f32 v[222:223], v[166:167], v[174:175]
    v_pk_add_f32 v[150:151], v[150:151], v[158:159] neg_lo:[0,1] neg_hi:[0,1]
    v_pk_add_f32 v[166:167], v[166:167], v[174:175] neg_lo:[0,1] neg_hi:[0,1]
    v_pk_mul_f32 v[152:153], v[160:161], v[184:185]
    v_pk_mul_f32 v[168:169], v[144:145], v[184:185]
    v_pk_fma_f32 v[224:225], v[144:145], v[176:177], v[152:153]
    v_pk_fma_f32 v[232:233], v[160:161], v[176:177], v[168:169] neg_lo:[0,0,1] neg_hi:[0,0,1]
    v_pk_mul_f32 v[154:155], v[162:163], v[186:187]
    v_pk_mul_f32 v[170:171], v[146:147], v[186:187]
    v_pk_fma_f32 v[226:227], v[146:147], v[178:179], v[154:155]
    v_pk_fma_f32 v[234:235], v[162:163], v[178:179], v[170:171] neg_lo:[0,0,1] neg_hi:[0,0,1]
    v_pk_mul_f32 v[156:157], v[164:165], v[188:189]
    v_pk_mul_f32 v[172:173], v[148:149], v[188:189]
    v_pk_fma_f32 v[228:229], v[148:149], v[180:181], v[156:157]
    v_pk_fma_f32 v[236:237], v[164:165], v[180:181], v[172:173] neg_lo:[0,0,1] neg_hi:[0,0,1]
    v_pk_mul_f32 v[158:159], v[166:167], v[190:191]
    v_pk_mul_f32 v[174:175], v[150:151], v[190:191]
    v_pk_fma_f32 v[230:231], v[150:151], v[182:183], v[158:159]
    v_pk_fma_f32 v[238:239], v[166:167], v[182:183], v[174:175] neg_lo:[0,0,1] neg_hi:[0,0,1]
NOSP_23:
    s_mov_b32 s12, 0x40000
    s_branch CHK_26
POLL_24:
    buffer_load_dwordx4 v[96:99], v3, s[36:39], s66 offen sc1
    buffer_load_dwordx4 v[100:103], v11, s[36:39], s66 offen sc1
    buffer_load_dwordx4 v[104:107], v134, s[36:39], s66 offen sc1
    buffer_load_dwordx4 v[108:111], v135, s[36:39], s66 offen sc1
CHK_26:
    s_waitcnt vmcnt(0)
    v_xor_b32 v96, s16, v96
    v_xor_b32 v97, s1, v97
    v_bitop3_b32 v139, v96, v96, v97 bitop3:0xfd
    v_xor_b32 v98, s0, v98
    v_xor_b32 v99, s17, v99
    v_bitop3_b32 v139, v139, v98, v99 bitop3:0xfd
    v_xor_b32 v100, s16, v100
    v_xor_b32 v101, s1, v101
    v_bitop3_b32 v139, v139, v100, v101 bitop3:0xfd
    v_xor_b32 v102, s0, v102
    v_xor_b32 v103, s17, v103
    v_bitop3_b32 v139, v139, v102, v103 bitop3:0xfd
    v_xor_b32 v104, s16, v104
    v_xor_b32 v105, s1, v105
    v_bitop3_b32 v139, v139, v104, v105 bitop3:0xfd
    v_xor_b32 v106, s0, v106
    v_xor_b32 v107, s17, v107
    v_bitop3_b32 v139, v139, v106, v107 bitop3:0xfd
    v_xor_b32 v108, s16, v108
    v_xor_b32 v109, s1, v109
    v_bitop3_b32 v139, v139, v108, v109 bitop3:0xfd
    v_xor_b32 v110, s0, v110
    v_xor_b32 v111, s17, v111
    v_bitop3_b32 v139, v139, v110, v111 bitop3:0xfd
    v_and_b32 v139, 0x10001, v139
    v_cmp_ne_u32 vcc, 0, v139
    s_nop 0
    s_cbranch_vccz DONE_25
    s_sleep 2
    s_sub_u32 s12, s12, 1
    s_cbranch_scc0 POLL_24
DONE_25:
    ds_write_b128 v6, v[96:99] offset:0
    ds_write_b128 v6, v[100:103] offset:128
    ds_write_b128 v6, v[104:107] offset:256
    ds_write_b128 v6, v[108:111] offset:384
    s_waitcnt lgkmcnt(0)
    s_barrier
    s_cmp_lg_u32 s71, 0
    s_cbranch_scc1 NOSP_27
    s_mov_b32 s12, 0x40000
    s_branch CHK_30
POLL_28:
    buffer_load_dwordx4 v[112:115], v129, s[36:39], s56 offen sc1
    buffer_load_dwordx4 v[116:119], v129, s[36:39], s57 offen sc1
    buffer_load_dwordx4 v[120:123], v129, s[36:39], s58 offen sc1
    buffer_load_dwordx4 v[124:127], v129, s[36:39], s59 offen sc1
CHK_30:
    s_waitcnt vmcnt(0)
    v_xor_b32 v112, s16, v112
    v_xor_b32 v113, s1, v113
    v_bitop3_b32 v139, v112, v112, v113 bitop3:0xfd
    v_xor_b32 v114, s0, v114
    v_xor_b32 v115, s17, v115
    v_bitop3_b32 v139, v139, v114, v115 bitop3:0xfd
    v_xor_b32 v116, s16, v116
    v_xor_b32 v117, s1, v117
    v_bitop3_b32 v139, v139, v116, v117 bitop3:0xfd
    v_xor_b32 v118, s0, v118
    v_xor_b32 v119, s17, v119
    v_bitop3_b32 v139, v139, v118, v119 bitop3:0xfd
    v_xor_b32 v120, s16, v120
    v_xor_b32 v121, s1, v121
    v_bitop3_b32 v139, v139, v120, v121 bitop3:0xfd
    v_xor_b32 v122, s0, v122
    v_xor_b32 v123, s17, v123
    v_bitop3_b32 v139, v139, v122, v123 bitop3:0xfd
    v_xor_b32 v124, s16, v124
    v_xor_b32 v125, s1, v125
    v_bitop3_b32 v139, v139, v124, v125 bitop3:0xfd
    v_xor_b32 v126, s0, v126
    v_xor_b32 v127, s17, v127
    v_bitop3_b32 v139, v139, v126, v127 bitop3:0xfd
    v_and_b32 v139, 0x10001, v139
    v_cmp_ne_u32 vcc, 0, v139
    s_nop 0
    s_cbranch_vccz DONE_29
    s_sleep 2
    s_sub_u32 s12, s12, 1
    s_cbranch_scc0 POLL_28
DONE_29:
    s_xor_b32 s16, s16, 1
    s_xor_b32 s17, s17, 1
    s_xor_b32 s0, s0, 1
    s_xor_b32 s1, s1, 1
    ds_write_b128 v5, v[112:115] offset:0
    ds_write_b128 v5, v[116:119] offset:1024
    ds_write_b128 v5, v[120:123] offset:2048
    ds_write_b128 v5, v[124:127] offset:3072
    ds_read_b64_tr_b16 v[176:177], v128 offset:0
    ds_read_b64_tr_b16 v[178:179], v128 offset:256
    ds_read_b64_tr_b16 v[180:181], v128 offset:2048
    ds_read_b64_tr_b16 v[182:183], v128 offset:2304
    s_waitcnt lgkmcnt(2)
    v_mfma_f32_16x16x32_bf16 v[144:147], v[16:19], v[176:179], 0
    v_mfma_f32_16x16x32_bf16 v[152:155], v[24:27], v[176:179], 0
    v_mfma_f32_16x16x32_bf16 v[148:151], v[32:35], v[176:179], 0
    v_mfma_f32_16x16x32_bf16 v[156:159], v[40:43], v[176:179], 0
    s_waitcnt lgkmcnt(0)
    v_mfma_f32_16x16x32_bf16 v[144:147], v[20:23], v[180:183], v[144:147]
    v_mfma_f32_16x16x32_bf16 v[152:155], v[28:31], v[180:183], v[152:155]
    v_mfma_f32_16x16x32_bf16 v[148:151], v[36:39], v[180:183], v[148:151]
    v_mfma_f32_16x16x32_bf16 v[156:159], v[44:47], v[180:183], v[156:159]
    s_nop 0
    s_nop 3
    v_pk_mul_f32 v[192:193], v[208:209], v[144:145]
    v_pk_mul_f32 v[200:201], v[208:209], v[152:153]
    v_pk_fma_f32 v[192:193], v[216:217], v[152:153], v[192:193] neg_lo:[1,0,0] neg_hi:[1,0,0]
    v_pk_fma_f32 v[200:201], v[216:217], v[144:145], v[200:201]
    v_pk_mul_f32 v[194:195], v[210:211], v[146:147]
    v_pk_mul_f32 v[202:203], v[210:211], v[154:155]
    v_pk_fma_f32 v[194:195], v[218:219], v[154:155], v[194:195] neg_lo:[1,0,0] neg_hi:[1,0,0]
    v_pk_fma_f32 v[202:203], v[218:219], v[146:147], v[202:203]
    v_pk_mul_f32 v[196:197], v[212:213], v[148:149]
    v_pk_mul_f32 v[204:205], v[212:213], v[156:157]
    v_pk_fma_f32 v[196:197], v[220:221], v[156:157], v[196:197] neg_lo:[1,0,0] neg_hi:[1,0,0]
    v_pk_fma_f32 v[204:205], v[220:221], v[148:149], v[204:205]
    v_pk_mul_f32 v[198:199], v[214:215], v[150:151]
    v_pk_mul_f32 v[206:207], v[214:215], v[158:159]
    v_pk_fma_f32 v[198:199], v[222:223], v[158:159], v[198:199] neg_lo:[1,0,0] neg_hi:[1,0,0]
    v_pk_fma_f32 v[206:207], v[222:223], v[150:151], v[206:207]
    v_fmac_f32_dpp v192, v144, v224 row_ror:4 row_mask:0xf bank_mask:0xf
    v_fmac_f32_dpp v200, v152, v224 row_ror:4 row_mask:0xf bank_mask:0xf
    v_fmac_f32_dpp v193, v145, v225 row_ror:4 row_mask:0xf bank_mask:0xf
    v_fmac_f32_dpp v201, v153, v225 row_ror:4 row_mask:0xf bank_mask:0xf
    v_fmac_f32_dpp v194, v146, v226 row_ror:4 row_mask:0xf bank_mask:0xf
    v_fmac_f32_dpp v202, v154, v226 row_ror:4 row_mask:0xf bank_mask:0xf
    v_fmac_f32_dpp v195, v147, v227 row_ror:4 row_mask:0xf bank_mask:0xf
    v_fmac_f32_dpp v203, v155, v227 row_ror:4 row_mask:0xf bank_mask:0xf
    v_fmac_f32_dpp v196, v148, v228 row_ror:4 row_mask:0xf bank_mask:0xf
    v_fmac_f32_dpp v204, v156, v228 row_ror:4 row_mask:0xf bank_mask:0xf
    v_fmac_f32_dpp v197, v149, v229 row_ror:4 row_mask:0xf bank_mask:0xf
    v_fmac_f32_dpp v205, v157, v229 row_ror:4 row_mask:0xf bank_mask:0xf
    v_fmac_f32_dpp v198, v150, v230 row_ror:4 row_mask:0xf bank_mask:0xf
    v_fmac_f32_dpp v206, v158, v230 row_ror:4 row_mask:0xf bank_mask:0xf
    v_fmac_f32_dpp v199, v151, v231 row_ror:4 row_mask:0xf bank_mask:0xf
    v_fmac_f32_dpp v207, v159, v231 row_ror:4 row_mask:0xf bank_mask:0xf
    v_fmac_f32_dpp v192, -v152, v232 row_ror:4 row_mask:0xf bank_mask:0xf
    v_fmac_f32_dpp v200, v144, v232 row_ror:4 row_mask:0xf bank_mask:0xf
    v_fmac_f32_dpp v193, -v153, v233 row_ror:4 row_mask:0xf bank_mask:0xf
    v_fmac_f32_dpp v201, v145, v233 row_ror:4 row_mask:0xf bank_mask:0xf
    v_fmac_f32_dpp v194, -v154, v234 row_ror:4 row_mask:0xf bank_mask:0xf
    v_fmac_f32_dpp v202, v146, v234 row_ror:4 row_mask:0xf bank_mask:0xf
    v_fmac_f32_dpp v195, -v155, v235 row_ror:4 row_mask:0xf bank_mask:0xf
    v_fmac_f32_dpp v203, v147, v235 row_ror:4 row_mask:0xf bank_mask:0xf
    v_fmac_f32_dpp v196, -v156, v236 row_ror:4 row_mask:0xf bank_mask:0xf
    v_fmac_f32_dpp v204, v148, v236 row_ror:4 row_mask:0xf bank_mask:0xf
    v_fmac_f32_dpp v197, -v157, v237 row_ror:4 row_mask:0xf bank_mask:0xf
    v_fmac_f32_dpp v205, v149, v237 row_ror:4 row_mask:0xf bank_mask:0xf
    v_fmac_f32_dpp v198, -v158, v238 row_ror:4 row_mask:0xf bank_mask:0xf
    v_fmac_f32_dpp v206, v150, v238 row_ror:4 row_mask:0xf bank_mask:0xf
    v_fmac_f32_dpp v199, -v159, v239 row_ror:4 row_mask:0xf bank_mask:0xf
    v_fmac_f32_dpp v207, v151, v239 row_ror:4 row_mask:0xf bank_mask:0xf
    v_cvt_pk_bf16_f32 v176, v192, -v200
    v_cvt_pk_bf16_f32 v177, v193, -v201
    v_cvt_pk_bf16_f32 v178, v194, -v202
    v_cvt_pk_bf16_f32 v179, v195, -v203
    v_cvt_pk_bf16_f32 v180, v196, -v204
    v_cvt_pk_bf16_f32 v181, v197, -v205
    v_cvt_pk_bf16_f32 v182, v198, -v206
    v_cvt_pk_bf16_f32 v183, v199, -v207
    v_mfma_f32_16x16x32_bf16 v[144:147], v[176:179], v[16:19], 0
    v_mfma_f32_16x16x32_bf16 v[152:155], v[176:179], v[24:27], 0
    v_mfma_f32_16x16x32_bf16 v[148:151], v[176:179], v[32:35], 0
    v_mfma_f32_16x16x32_bf16 v[156:159], v[176:179], v[40:43], 0
    v_mfma_f32_16x16x32_bf16 v[144:147], v[180:183], v[20:23], v[144:147]
    v_mfma_f32_16x16x32_bf16 v[152:155], v[180:183], v[28:31], v[152:155]
    v_mfma_f32_16x16x32_bf16 v[148:151], v[180:183], v[36:39], v[148:151]
    v_mfma_f32_16x16x32_bf16 v[156:159], v[180:183], v[44:47], v[156:159]
    s_mov_b32 exec_hi, 0
    s_nop 4
    v_cvt_pk_bf16_f32 v208, v144, -v152
    v_cvt_pk_bf16_f32 v209, v145, -v153
    v_cvt_pk_bf16_f32 v210, v146, -v154
    v_cvt_pk_bf16_f32 v211, v147, -v155
    v_and_or_b32 v208, v208, v14, s16
    v_and_or_b32 v209, v209, v14, s17
    v_and_or_b32 v210, v210, v14, s0
    v_and_or_b32 v211, v211, v14, s1
    buffer_store_dwordx4 v[208:211], v2, s[36:39], s67 offen offset:0 sc1
    v_cvt_pk_bf16_f32 v212, v148, -v156
    v_cvt_pk_bf16_f32 v213, v149, -v157
    v_cvt_pk_bf16_f32 v214, v150, -v158
    v_cvt_pk_bf16_f32 v215, v151, -v159
    v_and_or_b32 v212, v212, v14, s16
    v_and_or_b32 v213, v213, v14, s17
    v_and_or_b32 v214, v214, v14, s0
    v_and_or_b32 v215, v215, v14, s1
    buffer_store_dwordx4 v[212:215], v2, s[36:39], s67 offen offset:512 sc1
    s_mov_b32 exec_hi, -1
    s_branch B2GO_31
NOSP_27:
    s_xor_b32 s16, s16, 1
    s_xor_b32 s17, s17, 1
    s_xor_b32 s0, s0, 1
    s_xor_b32 s1, s1, 1
B2GO_31:
    ds_read_b64_tr_b16 v[176:177], v132 offset:0
    ds_read_b64_tr_b16 v[178:179], v132 offset:256
    ds_read_b64_tr_b16 v[180:181], v132 offset:2048
    ds_read_b64_tr_b16 v[182:183], v132 offset:2304
    ds_read_b64_tr_b16 v[184:185], v133 offset:0
    ds_read_b64_tr_b16 v[186:187], v133 offset:256
    ds_read_b64_tr_b16 v[188:189], v133 offset:2048
    ds_read_b64_tr_b16 v[190:191], v133 offset:2304
    s_waitcnt lgkmcnt(6)
    v_mfma_f32_16x16x32_bf16 v[144:147], v[16:19], v[176:179], 0
    v_mfma_f32_16x16x32_bf16 v[152:155], v[24:27], v[176:179], 0
    s_waitcnt lgkmcnt(4)
    v_mfma_f32_16x16x32_bf16 v[144:147], v[20:23], v[180:183], v[144:147]
    v_mfma_f32_16x16x32_bf16 v[152:155], v[28:31], v[180:183], v[152:155]
    s_waitcnt lgkmcnt(2)
    v_mfma_f32_16x16x32_bf16 v[160:163], v[16:19], v[184:187], 0
    v_mfma_f32_16x16x32_bf16 v[168:171], v[24:27], v[184:187], 0
    s_waitcnt lgkmcnt(0)
    v_mfma_f32_16x16x32_bf16 v[160:163], v[20:23], v[188:191], v[160:163]
    v_mfma_f32_16x16x32_bf16 v[168:171], v[28:31], v[188:191], v[168:171]
    v_mfma_f32_16x16x32_bf16 v[148:151], v[32:35], v[176:179], 0
    v_mfma_f32_16x16x32_bf16 v[156:159], v[40:43], v[176:179], 0
    v_mfma_f32_16x16x32_bf16 v[148:151], v[36:39], v[180:183], v[148:151]
    v_mfma_f32_16x16x32_bf16 v[156:159], v[44:47], v[180:183], v[156:159]
    v_mfma_f32_16x16x32_bf16 v[164:167], v[32:35], v[184:187], 0
    v_mfma_f32_16x16x32_bf16 v[172:175], v[40:43], v[184:187], 0
    v_mfma_f32_16x16x32_bf16 v[164:167], v[36:39], v[188:191], v[164:167]
    v_mfma_f32_16x16x32_bf16 v[172:175], v[44:47], v[188:191], v[172:175]
    v_pk_mul_f32 v[192:193], v[48:49], v[144:145]
    v_pk_mul_f32 v[194:195], v[48:49], v[152:153]
    v_pk_mul_f32 v[196:197], v[80:81], v[144:145]
    v_pk_mul_f32 v[198:199], v[80:81], v[152:153]
    v_pk_fma_f32 v[192:193], v[56:57], v[152:153], v[192:193] neg_lo:[1,0,0] neg_hi:[1,0,0]
    v_pk_fma_f32 v[194:195], v[56:57], v[144:145], v[194:195]
    v_pk_fma_f32 v[196:197], v[88:89], v[152:153], v[196:197] neg_lo:[1,0,0] neg_hi:[1,0,0]
    v_pk_fma_f32 v[198:199], v[88:89], v[144:145], v[198:199]
    v_pk_fma_f32 v[192:193], v[64:65], v[160:161], v[192:193]
    v_pk_fma_f32 v[194:195], v[64:65], v[168:169], v[194:195]
    v_pk_fma_f32 v[196:197], v[48:49], v[160:161], v[196:197]
    v_pk_fma_f32 v[198:199], v[48:49], v[168:169], v[198:199]
    v_pk_fma_f32 v[192:193], v[72:73], v[168:169], v[192:193] neg_lo:[1,0,0] neg_hi:[1,0,0]
    v_pk_fma_f32 v[194:195], v[72:73], v[160:161], v[194:195]
    v_pk_fma_f32 v[196:197], v[56:57], v[168:169], v[196:197] neg_lo:[1,0,0] neg_hi:[1,0,0]
    v_pk_fma_f32 v[198:199], v[56:57], v[160:161], v[198:199]
    v_cvt_pk_bf16_f32 v208, v192, -v194
    v_cvt_pk_bf16_f32 v216, v196, -v198
    v_cvt_pk_bf16_f32 v209, v193, -v195
    v_cvt_pk_bf16_f32 v217, v197, -v199
    v_pk_mul_f32 v[200:201], v[50:51], v[146:147]
    v_pk_mul_f32 v[202:203], v[50:51], v[154:155]
    v_pk_mul_f32 v[204:205], v[82:83], v[146:147]
    v_pk_mul_f32 v[206:207], v[82:83], v[154:155]
    v_pk_fma_f32 v[200:201], v[58:59], v[154:155], v[200:201] neg_lo:[1,0,0] neg_hi:[1,0,0]
    v_pk_fma_f32 v[202:203], v[58:59], v[146:147], v[202:203]
    v_pk_fma_f32 v[204:205], v[90:91], v[154:155], v[204:205] neg_lo:[1,0,0] neg_hi:[1,0,0]
    v_pk_fma_f32 v[206:207], v[90:91], v[146:147], v[206:207]
    v_pk_fma_f32 v[200:201], v[66:67], v[162:163], v[200:201]
    v_pk_fma_f32 v[202:203], v[66:67], v[170:171], v[202:203]
    v_pk_fma_f32 v[204:205], v[50:51], v[162:163], v[204:205]
    v_pk_fma_f32 v[206:207], v[50:51], v[170:171], v[206:207]
    v_pk_fma_f32 v[200:201], v[74:75], v[170:171], v[200:201] neg_lo:[1,0,0] neg_hi:[1,0,0]
    v_pk_fma_f32 v[202:203], v[74:75], v[162:163], v[202:203]
    v_pk_fma_f32 v[204:205], v[58:59], v[170:171], v[204:205] neg_lo:[1,0,0] neg_hi:[1,0,0]
    v_pk_fma_f32 v[206:207], v[58:59], v[162:163], v[206:207]
    v_cvt_pk_bf16_f32 v210, v200, -v202
    v_cvt_pk_bf16_f32 v218, v204, -v206
    v_cvt_pk_bf16_f32 v211, v201, -v203
    v_cvt_pk_bf16_f32 v219, v205, -v207
    v_pk_mul_f32 v[224:225], v[52:53], v[148:149]
    v_pk_mul_f32 v[226:227], v[52:53], v[156:157]
    v_pk_mul_f32 v[228:229], v[84:85], v[148:149]
    v_pk_mul_f32 v[230:231], v[84:85], v[156:157]
    v_pk_fma_f32 v[224:225], v[60:61], v[156:157], v[224:225] neg_lo:[1,0,0] neg_hi:[1,0,0]
    v_pk_fma_f32 v[226:227], v[60:61], v[148:149], v[226:227]
    v_pk_fma_f32 v[228:229], v[92:93], v[156:157], v[228:229] neg_lo:[1,0,0] neg_hi:[1,0,0]
    v_pk_fma_f32 v[230:231], v[92:93], v[148:149], v[230:231]
    v_pk_fma_f32 v[224:225], v[68:69], v[164:165], v[224:225]
    v_pk_fma_f32 v[226:227], v[68:69], v[172:173], v[226:227]
    v_pk_fma_f32 v[228:229], v[52:53], v[164:165], v[228:229]
    v_pk_fma_f32 v[230:231], v[52:53], v[172:173], v[230:231]
    v_pk_fma_f32 v[224:225], v[76:77], v[172:173], v[224:225] neg_lo:[1,0,0] neg_hi:[1,0,0]
    v_pk_fma_f32 v[226:227], v[76:77], v[164:165], v[226:227]
    v_pk_fma_f32 v[228:229], v[60:61], v[172:173], v[228:229] neg_lo:[1,0,0] neg_hi:[1,0,0]
    v_pk_fma_f32 v[230:231], v[60:61], v[164:165], v[230:231]
    v_cvt_pk_bf16_f32 v212, v224, -v226
    v_cvt_pk_bf16_f32 v220, v228, -v230
    v_cvt_pk_bf16_f32 v213, v225, -v227
    v_cvt_pk_bf16_f32 v221, v229, -v231
    v_pk_mul_f32 v[232:233], v[54:55], v[150:151]
    v_pk_mul_f32 v[234:235], v[54:55], v[158:159]
    v_pk_mul_f32 v[236:237], v[86:87], v[150:151]
    v_pk_mul_f32 v[238:239], v[86:87], v[158:159]
    v_pk_fma_f32 v[232:233], v[62:63], v[158:159], v[232:233] neg_lo:[1,0,0] neg_hi:[1,0,0]
    v_pk_fma_f32 v[234:235], v[62:63], v[150:151], v[234:235]
    v_pk_fma_f32 v[236:237], v[94:95], v[158:159], v[236:237] neg_lo:[1,0,0] neg_hi:[1,0,0]
    v_pk_fma_f32 v[238:239], v[94:95], v[150:151], v[238:239]
    v_pk_fma_f32 v[232:233], v[70:71], v[166:167], v[232:233]
    v_pk_fma_f32 v[234:235], v[70:71], v[174:175], v[234:235]
    v_pk_fma_f32 v[236:237], v[54:55], v[166:167], v[236:237]
    v_pk_fma_f32 v[238:239], v[54:55], v[174:175], v[238:239]
    v_pk_fma_f32 v[232:233], v[78:79], v[174:175], v[232:233] neg_lo:[1,0,0] neg_hi:[1,0,0]
    v_pk_fma_f32 v[234:235], v[78:79], v[166:167], v[234:235]
    v_pk_fma_f32 v[236:237], v[62:63], v[174:175], v[236:237] neg_lo:[1,0,0] neg_hi:[1,0,0]
    v_pk_fma_f32 v[238:239], v[62:63], v[166:167], v[238:239]
    v_cvt_pk_bf16_f32 v214, v232, -v234
    v_cvt_pk_bf16_f32 v222, v236, -v238
    v_cvt_pk_bf16_f32 v215, v233, -v235
    v_cvt_pk_bf16_f32 v223, v237, -v239
    v_mfma_f32_16x16x32_bf16 v[96:99], v[208:211], v[16:19], 0
    v_mfma_f32_16x16x32_bf16 v[104:107], v[208:211], v[24:27], 0
    v_mfma_f32_16x16x32_bf16 v[100:103], v[208:211], v[32:35], 0
    v_mfma_f32_16x16x32_bf16 v[108:111], v[208:211], v[40:43], 0
    v_mfma_f32_16x16x32_bf16 v[112:115], v[216:219], v[16:19], 0
    v_mfma_f32_16x16x32_bf16 v[120:123], v[216:219], v[24:27], 0
    v_mfma_f32_16x16x32_bf16 v[116:119], v[216:219], v[32:35], 0
    v_mfma_f32_16x16x32_bf16 v[124:127], v[216:219], v[40:43], 0
    v_mfma_f32_16x16x32_bf16 v[96:99], v[212:215], v[20:23], v[96:99]
    v_mfma_f32_16x16x32_bf16 v[104:107], v[212:215], v[28:31], v[104:107]
    v_mfma_f32_16x16x32_bf16 v[100:103], v[212:215], v[36:39], v[100:103]
    v_mfma_f32_16x16x32_bf16 v[108:111], v[212:215], v[44:47], v[108:111]
    v_mfma_f32_16x16x32_bf16 v[112:115], v[220:223], v[20:23], v[112:115]
    v_mfma_f32_16x16x32_bf16 v[120:123], v[220:223], v[28:31], v[120:123]
    v_mfma_f32_16x16x32_bf16 v[116:119], v[220:223], v[36:39], v[116:119]
    v_mfma_f32_16x16x32_bf16 v[124:127], v[220:223], v[44:47], v[124:127]
    s_nop 0
    s_nop 0
    v_cvt_pk_bf16_f32 v240, v96, -v104
    v_cvt_pk_bf16_f32 v241, v97, -v105
    v_cvt_pk_bf16_f32 v242, v98, -v106
    v_cvt_pk_bf16_f32 v243, v99, -v107
    v_and_or_b32 v240, v240, v14, s16
    v_and_or_b32 v241, v241, v14, s17
    v_and_or_b32 v242, v242, v14, s0
    v_and_or_b32 v243, v243, v14, s1
    ds_write_b128 v15, v[240:243] offset:0
    v_cvt_pk_bf16_f32 v244, v100, -v108
    v_cvt_pk_bf16_f32 v245, v101, -v109
    v_cvt_pk_bf16_f32 v246, v102, -v110
    v_cvt_pk_bf16_f32 v247, v103, -v111
    v_and_or_b32 v244, v244, v14, s16
    v_and_or_b32 v245, v245, v14, s17
    v_and_or_b32 v246, v246, v14, s0
    v_and_or_b32 v247, v247, v14, s1
    ds_write_b128 v15, v[244:247] offset:16384
    v_cvt_pk_bf16_f32 v248, v112, -v120
    v_cvt_pk_bf16_f32 v249, v113, -v121
    v_cvt_pk_bf16_f32 v250, v114, -v122
    v_cvt_pk_bf16_f32 v251, v115, -v123
    v_and_or_b32 v248, v248, v14, s16
    v_and_or_b32 v249, v249, v14, s17
    v_and_or_b32 v250, v250, v14, s0
    v_and_or_b32 v251, v251, v14, s1
    ds_write_b128 v15, v[248:251] offset:512
    v_cvt_pk_bf16_f32 v252, v116, -v124
    v_cvt_pk_bf16_f32 v253, v117, -v125
    v_cvt_pk_bf16_f32 v254, v118, -v126
    v_cvt_pk_bf16_f32 v255, v119, -v127
    v_and_or_b32 v252, v252, v14, s16
    v_and_or_b32 v253, v253, v14, s17
    v_and_or_b32 v254, v254, v14, s0
    v_and_or_b32 v255, v255, v14, s1
    ds_write_b128 v15, v[252:255] offset:16896
    s_waitcnt lgkmcnt(0)
    s_barrier
    s_cmp_lg_u32 s3, 7
    s_cbranch_scc1 NOH_32
    s_lshl_b32 s14, s60, 7
    s_add_u32 s14, s14, 0x1000
    v_mov_b32 v140, s6
    v_mov_b32 v141, s7
    v_lshlrev_b32 v142, 3, v12
    buffer_store_dwordx2 v[140:141], v142, s[36:39], s14 offen sc1
NOH_32:
    ds_read_b128 v[96:99], v7 offset:0
    ds_read_b128 v[100:103], v136 offset:1024
    ds_read_b128 v[104:107], v137 offset:2048
    ds_read_b128 v[108:111], v138 offset:3072
    s_waitcnt lgkmcnt(3)
    buffer_store_dwordx4 v[96:99], v3, s[36:39], s66 offen sc1
    s_waitcnt lgkmcnt(2)
    buffer_store_dwordx4 v[100:103], v11, s[36:39], s66 offen sc1
    s_waitcnt lgkmcnt(1)
    buffer_store_dwordx4 v[104:107], v134, s[36:39], s66 offen sc1
    s_waitcnt lgkmcnt(0)
    buffer_store_dwordx4 v[108:111], v135, s[36:39], s66 offen sc1
    s_or_b32 s56, s60, s3
    s_cbranch_scc1 NONOTE_33
    v_mov_b32 v140, s6
    v_mov_b32 v141, s7
    v_lshlrev_b32_e64 v142, 3, v12
    buffer_store_dwordx2 v[140:141], v142, s[36:39], 0 offen offset:2048 sc1
NONOTE_33:
WB_1:
    s_mov_b32 s34, 0
B3_ENTRY:
    v_lshlrev_b32 v2, 4, v1
    v_add_u32 v131, 131072, v2
    ds_read_b128 v[64:67], v131 offset:24576
    ds_read_b128 v[68:71], v131 offset:25600
    ds_read_b128 v[72:75], v131 offset:26624
    ds_read_b128 v[76:79], v131 offset:27648
    ds_read_b128 v[16:19], v131 offset:0
    ds_read_b128 v[20:23], v131 offset:1024
    ds_read_b128 v[24:27], v131 offset:2048
    ds_read_b128 v[28:31], v131 offset:3072
    ds_read_b128 v[32:35], v131 offset:4096
    ds_read_b128 v[36:39], v131 offset:5120
    ds_read_b128 v[40:43], v131 offset:6144
    ds_read_b128 v[44:47], v131 offset:7168
    ds_read_b128 v[48:51], v131 offset:12288
    ds_read_b128 v[52:55], v131 offset:13312
    ds_read_b128 v[56:59], v131 offset:14336
    ds_read_b128 v[60:63], v131 offset:15360
    v_lshrrev_b32 v4, 5, v1
    v_and_b32 v5, 31, v1
    v_and_b32 v12, 15, v1
    v_lshrrev_b32 v13, 4, v1
    v_lshl_add_u32 v132, v4, 3, s3
    v_xor_b32 v8, s60, v132
    v_lshlrev_b32 v132, 15, v132
    v_lshl_add_u32 v132, v5, 4, v132
    v_lshl_add_u32 v132, v8, 9, v132
    v_xor_b32 v133, 0x82000, v132
    v_xor_b32 v134, 0x104000, v132
    v_xor_b32 v135, 0x186000, v132
    v_lshl_add_u32 v10, s3, 5, v5
    v_lshlrev_b32_e64 v130, 13, v4
    v_add_u32 v130, 32768, v130
    v_lshl_add_u32 v9, v10, 4, v130
    v_sub_u32_e64 v10, 0, v10
    v_and_b32 v10, 0x1ff, v10
    v_lshl_add_u32 v10, v10, 4, v130
    s_lshr_b32 s63, s3, 2
    s_lshl_b32 s63, s63, 13
    s_and_b32 s64, s3, 3
    s_lshl2_add_u32 s63, s64, s63
    s_add_u32 s63, s63, 32768
    v_lshlrev_b32_e64 v8, 11, v13
    v_lshl_add_u32 v8, v12, 4, v8
    v_add_u32 v8, s63, v8
    s_lshl_b32 s63, s3, 11
    s_add_u32 s63, s63, 65536
    v_bfe_u32 v5, v1, 2, 1
    v_lshlrev_b32 v5, 1, v5
    v_xor_b32 v5, v5, v13
    v_lshlrev_b32_e64 v5, 3, v5
    v_lshl_add_u32 v5, v12, 5, v5
    v_add_u32_e64 v5, s63, v5
    v_bfe_u32 v6, v1, 3, 1
    v_lshlrev_b32 v6, 4, v6
    v_xor_b32 v6, v6, v2
    v_add_u32 v6, s63, v6
    s_lshl_b32 s64, s3, 6
    s_add_u32 s64, s64, s60
    s_add_u32 s64, s64, s34
    s_lshl_b32 s64, s64, 11
    s_add_u32 s66, s64, 0x200000
    s_mov_b32 s56, 0.5
    s_mov_b32 s57, 0.5
    s_cmp_eq_u32 s3, 0
    s_cselect_b32 s68, -2, -1
    s_mov_b32 s69, s68
    s_lshr_b32 s63, s60, 5
    s_and_b32 s65, s60, 1
    s_lshl1_add_u32 s63, s63, s65
    s_bfe_u32 s65, s60, 0x40001
    s_lshl4_add_u32 s63, s63, s65
    v_and_b32 v11, 7, v1
    v_xor_b32 v11, s63, v11
    v_lshlrev_b32_e64 v11, 4, v11
    v_lshl_add_u32 v11, v4, 10, v11
    s_mov_b32 s63, 0x60000
    s_mov_b32 s65, 0x61000
    s_cmp_eq_u32 s34, 0
    s_cbranch_scc1 NOGO_34
    s_mov_b32 s12, 0x40000
POLL_35:
    buffer_load_dwordx2 v[140:141], off, s[36:39], s62 sc1
    s_waitcnt vmcnt(0)
    v_xor_b32 v139, s6, v140
    v_bitop3_b32 v139, v139, v141, s7 bitop3:0xf6
    v_cmp_ne_u32 vcc, 0, v139
    s_nop 0
    s_cbranch_vccz DONE_36
    s_sleep 2
    s_sub_u32 s12, s12, 1
    s_cbranch_scc0 POLL_35
DONE_36:
NOGO_34:
    s_mov_b32 s62, 0x400000
    s_and_b32 s15, s60, 7
    s_cmp_eq_u32 s15, 7
    s_cbranch_scc1 NODR_38
    s_waitcnt vmcnt(0)
NODR_38:
    buffer_load_dwordx4 v[144:147], v132, s[36:39], s62 offen sc1
    buffer_load_dwordx4 v[148:151], v133, s[36:39], s62 offen sc1
    buffer_load_dwordx4 v[152:155], v134, s[36:39], s62 offen sc1
    buffer_load_dwordx4 v[156:159], v135, s[36:39], s62 offen sc1
    s_cmp_lg_u32 s3, 1
    s_cbranch_scc1 NOX_39
    buffer_load_dwordx4 v[112:115], v11, s[36:39], s63 offen offset:0 sc1
    buffer_load_dwordx4 v[116:119], v11, s[36:39], s63 offen offset:2048 sc1
    buffer_load_dwordx4 v[120:123], v11, s[36:39], s65 offen offset:0 sc1
    buffer_load_dwordx4 v[124:127], v11, s[36:39], s65 offen offset:2048 sc1
NOX_39:
    s_waitcnt lgkmcnt(0)
WC_0:
    s_mov_b32 s12, 0x40000
    s_branch CHK_42
POLL_40:
    buffer_load_dwordx4 v[144:147], v132, s[36:39], s62 offen sc1
    buffer_load_dwordx4 v[148:151], v133, s[36:39], s62 offen sc1
    buffer_load_dwordx4 v[152:155], v134, s[36:39], s62 offen sc1
    buffer_load_dwordx4 v[156:159], v135, s[36:39], s62 offen sc1
CHK_42:
    s_waitcnt vmcnt(0)
    v_xor_b32 v144, s16, v144
    v_xor_b32_e64 v145, s1, v145
    v_bitop3_b32 v139, v144, v144, v145 bitop3:0xfd
    v_xor_b32 v146, s0, v146
    v_xor_b32 v147, s17, v147
    v_bitop3_b32 v139, v139, v146, v147 bitop3:0xfd
    v_xor_b32 v148, s16, v148
    v_xor_b32 v149, s1, v149
    v_bitop3_b32 v139, v139, v148, v149 bitop3:0xfd
    v_xor_b32 v150, s0, v150
    v_xor_b32 v151, s17, v151
    v_bitop3_b32 v139, v139, v150, v151 bitop3:0xfd
    v_xor_b32 v152, s16, v152
    v_xor_b32 v153, s1, v153
    v_bitop3_b32 v139, v139, v152, v153 bitop3:0xfd
    v_xor_b32 v154, s0, v154
    v_xor_b32 v155, s17, v155
    v_bitop3_b32 v139, v139, v154, v155 bitop3:0xfd
    v_xor_b32 v156, s16, v156
    v_xor_b32 v157, s1, v157
    v_bitop3_b32 v139, v139, v156, v157 bitop3:0xfd
    v_xor_b32 v158, s0, v158
    v_xor_b32 v159, s17, v159
    v_bitop3_b32 v139, v139, v158, v159 bitop3:0xfd
    v_and_b32 v139, 0x10001, v139
    v_cmp_ne_u32 vcc, 0, v139
    s_nop 0
    s_cbranch_vccz DONE_41
    s_sleep 2
    s_sub_u32 s12, s12, 1
    s_cbranch_scc0 POLL_40
DONE_41:
    v_mfma_f32_32x32x16_bf16 v[160:175], v[64:67], v[144:147], 0
    v_mfma_f32_32x32x16_bf16 v[160:175], v[68:71], v[148:151], v[160:175]
    v_mfma_f32_32x32x16_bf16 v[160:175], v[72:75], v[152:155], v[160:175]
    v_mfma_f32_32x32x16_bf16 v[160:175], v[76:79], v[156:159], v[160:175]
    s_nop 9
    s_cmp_lg_u32 s3, 0
    s_cbranch_scc1 NOAVG_43
    s_mov_b32 exec_lo, 1
    s_nop 0
    s_mov_b32 exec_hi, 1
    v_pk_add_f32 v[160:161], v[160:161], v[168:169]
    v_pk_add_f32 v[164:165], v[164:165], v[172:173] neg_lo:[0,1] neg_hi:[0,1]
    v_pk_add_f32 v[162:163], v[162:163], v[170:171]
    v_pk_add_f32 v[166:167], v[166:167], v[174:175] neg_lo:[0,1] neg_hi:[0,1]
    v_pk_mul_f32 v[160:161], v[160:161], s[56:57]
    v_pk_mul_f32 v[162:163], v[162:163], s[56:57]
    v_pk_mul_f32 v[164:165], v[164:165], s[56:57]
    v_pk_mul_f32 v[166:167], v[166:167], s[56:57]
    s_nop 0
    s_mov_b64 exec, -1
NOAVG_43:
    v_cvt_pk_bf16_f32 v192, v160, v164
    v_cvt_pk_bf16_f32 v193, v161, v165
    v_cvt_pk_bf16_f32 v194, v162, v166
    v_cvt_pk_bf16_f32 v195, v163, v167
    ds_write_b128 v9, v[192:195]
    v_cvt_pk_bf16_f32 v196, v168, -v172
    v_cvt_pk_bf16_f32 v197, v169, -v173
    v_cvt_pk_bf16_f32 v198, v170, -v174
    v_cvt_pk_bf16_f32 v199, v171, -v175
    s_mov_b64 exec, s[68:69]
    ds_write_b128 v10, v[196:199]
    s_mov_b64 exec, -1
    s_cmp_lg_u32 s3, 1
    s_cbranch_scc1 NOX_44
    s_mov_b32 s12, 0x40000
    s_branch CHK_47
POLL_45:
    buffer_load_dwordx4 v[112:115], v11, s[36:39], s63 offen offset:0 sc1
    buffer_load_dwordx4 v[116:119], v11, s[36:39], s63 offen offset:2048 sc1
    buffer_load_dwordx4 v[120:123], v11, s[36:39], s65 offen offset:0 sc1
    buffer_load_dwordx4 v[124:127], v11, s[36:39], s65 offen offset:2048 sc1
CHK_47:
    s_waitcnt vmcnt(0)
    v_xor_b32 v112, s16, v112
    v_xor_b32 v113, s1, v113
    v_bitop3_b32 v139, v112, v112, v113 bitop3:0xfd
    v_xor_b32 v114, s0, v114
    v_xor_b32 v115, s17, v115
    v_bitop3_b32 v139, v139, v114, v115 bitop3:0xfd
    v_xor_b32 v116, s16, v116
    v_xor_b32 v117, s1, v117
    v_bitop3_b32 v139, v139, v116, v117 bitop3:0xfd
    v_xor_b32 v118, s0, v118
    v_xor_b32 v119, s17, v119
    v_bitop3_b32 v139, v139, v118, v119 bitop3:0xfd
    v_xor_b32 v120, s16, v120
    v_xor_b32 v121, s1, v121
    v_bitop3_b32 v139, v139, v120, v121 bitop3:0xfd
    v_xor_b32 v122, s0, v122
    v_xor_b32 v123, s17, v123
    v_bitop3_b32 v139, v139, v122, v123 bitop3:0xfd
    v_xor_b32 v124, s16, v124
    v_xor_b32 v125, s1, v125
    v_bitop3_b32 v139, v139, v124, v125 bitop3:0xfd
    v_xor_b32 v126, s0, v126
    v_xor_b32 v127, s17, v127
    v_bitop3_b32 v139, v139, v126, v127 bitop3:0xfd
    v_and_b32 v139, 0x10001, v139
    v_cmp_ne_u32 vcc, 0, v139
    s_nop 0
    s_cbranch_vccz DONE_46
    s_sleep 2
    s_sub_u32 s12, s12, 1
    s_cbranch_scc0 POLL_45
DONE_46:
    v_mfma_f32_32x32x16_bf16 v[160:175], v[64:67], v[112:115], 0
    v_mfma_f32_32x32x16_bf16 v[160:175], v[68:71], v[116:119], v[160:175]
    v_mfma_f32_32x32x16_bf16 v[160:175], v[72:75], v[120:123], v[160:175]
    v_mfma_f32_32x32x16_bf16 v[160:175], v[76:79], v[124:127], v[160:175]
    s_mov_b32 exec_lo, 1
    s_mov_b32 exec_hi, 1
    s_nop 0
    s_nop 8
    v_pk_add_f32 v[160:161], v[160:161], v[168:169]
    v_pk_add_f32 v[164:165], v[164:165], v[172:173] neg_lo:[0,1] neg_hi:[0,1]
    v_pk_add_f32 v[162:163], v[162:163], v[170:171]
    v_pk_add_f32 v[166:167], v[166:167], v[174:175] neg_lo:[0,1] neg_hi:[0,1]
    v_pk_mul_f32 v[160:161], v[160:161], s[56:57]
    v_pk_mul_f32 v[162:163], v[162:163], s[56:57]
    v_pk_mul_f32 v[164:165], v[164:165], s[56:57]
    v_pk_mul_f32 v[166:167], v[166:167], s[56:57]
    v_cvt_pk_bf16_f32 v200, v160, v164
    v_cvt_pk_bf16_f32 v201, v161, v165
    v_cvt_pk_bf16_f32 v202, v162, v166
    v_cvt_pk_bf16_f32 v203, v163, v167
    ds_write_b128 v130, v[200:203] offset:4096
    s_mov_b64 exec, -1
NOX_44:
    s_waitcnt lgkmcnt(0)
    s_barrier
    ds_read2st64_b32 v[144:145], v8 offset0:0 offset1:2
    ds_read2st64_b32 v[146:147], v8 offset0:4 offset1:6
    ds_read2st64_b32 v[148:149], v8 offset0:1 offset1:3
    ds_read2st64_b32 v[150:151], v8 offset0:5 offset1:7
    s_waitcnt lgkmcnt(2)
    v_mfma_f32_16x16x32_bf16 v[160:163], v[144:147], v[56:59], 0
    v_mfma_f32_16x16x32_bf16 v[168:171], v[144:147], v[60:63], 0
    s_waitcnt lgkmcnt(0)
    v_mfma_f32_16x16x32_bf16 v[164:167], v[148:151], v[56:59], 0
    v_mfma_f32_16x16x32_bf16 v[172:175], v[148:151], v[60:63], 0
    s_nop 4
    v_pk_mul_f32 v[208:209], v[168:169], v[44:45]
    v_pk_mul_f32 v[210:211], v[160:161], v[44:45]
    v_pk_mul_f32 v[212:213], v[170:171], v[46:47]
    v_pk_mul_f32 v[214:215], v[162:163], v[46:47]
    v_pk_mul_f32 v[216:217], v[172:173], v[52:53]
    v_pk_mul_f32 v[218:219], v[164:165], v[52:53]
    v_pk_mul_f32 v[220:221], v[174:175], v[54:55]
    v_pk_mul_f32 v[222:223], v[166:167], v[54:55]
    v_pk_fma_f32 v[160:161], v[160:161], v[40:41], v[208:209] neg_lo:[0,0,1] neg_hi:[0,0,1]
    v_pk_fma_f32 v[168:169], v[168:169], v[40:41], v[210:211]
    v_pk_fma_f32 v[162:163], v[162:163], v[42:43], v[212:213] neg_lo:[0,0,1] neg_hi:[0,0,1]
    v_pk_fma_f32 v[170:171], v[170:171], v[42:43], v[214:215]
    v_pk_fma_f32 v[164:165], v[164:165], v[48:49], v[216:217] neg_lo:[0,0,1] neg_hi:[0,0,1]
    v_pk_fma_f32 v[172:173], v[172:173], v[48:49], v[218:219]
    v_pk_fma_f32 v[166:167], v[166:167], v[50:51], v[220:221] neg_lo:[0,0,1] neg_hi:[0,0,1]
    v_pk_fma_f32 v[174:175], v[174:175], v[50:51], v[222:223]
    v_cvt_pk_bf16_f32 v192, v160, v161
    v_cvt_pk_bf16_f32 v193, v162, v163
    v_cvt_pk_bf16_f32 v194, v164, v165
    v_cvt_pk_bf16_f32 v195, v166, v167
    v_cvt_pk_bf16_f32 v196, v168, v169
    v_cvt_pk_bf16_f32 v197, v170, v171
    v_cvt_pk_bf16_f32 v198, v172, v173
    v_cvt_pk_bf16_f32 v199, v174, v175
    v_mfma_f32_16x16x32_bf16 v[224:227], v[192:195], v[16:19], 0
    s_nop 0
    s_nop 0
    v_mfma_f32_16x16x32_bf16 v[232:235], v[196:199], v[16:19], 0
    v_mfma_f32_16x16x32_bf16 v[224:227], v[196:199], v[32:35], v[224:227]
    v_mfma_f32_16x16x32_bf16 v[232:235], v[192:195], v[24:27], v[232:235]
    v_mfma_f32_16x16x32_bf16 v[228:231], v[192:195], v[20:23], 0
    v_mfma_f32_16x16x32_bf16 v[236:239], v[196:199], v[20:23], 0
    v_mfma_f32_16x16x32_bf16 v[228:231], v[196:199], v[36:39], v[228:231]
    v_mfma_f32_16x16x32_bf16 v[236:239], v[192:195], v[28:31], v[236:239]
    s_nop 0
    s_nop 1
    v_cvt_pk_bf16_f32 v152, v224, v225
    v_cvt_pk_bf16_f32 v153, v226, v227
    ds_write_b64 v5, v[152:153] offset:0
    s_nop 0
    s_nop 0
    v_cvt_pk_bf16_f32 v154, v228, v229
    v_cvt_pk_bf16_f32 v155, v230, v231
    ds_write_b64 v5, v[154:155] offset:512
    ds_read_b128 v[176:179], v6 offset:0
    v_cvt_pk_bf16_f32 v156, v232, v233
    v_cvt_pk_bf16_f32 v157, v234, v235
    ds_write_b64 v5, v[156:157] offset:1024
    v_cvt_pk_bf16_f32 v158, v236, v237
    v_cvt_pk_bf16_f32 v159, v238, v239
    ds_write_b64 v5, v[158:159] offset:1536
    ds_read_b128 v[180:183], v6 offset:1024
    s_waitcnt lgkmcnt(3)
    buffer_store_dwordx4 v[176:179], v2, s[40:43], s64 offen offset:1024 sc1
    s_waitcnt lgkmcnt(0)
    buffer_store_dwordx4 v[180:183], v2, s[40:43], s66 offen offset:1024 sc1
    s_endpgm
CODE_END:
.p2align 8
.type TABLE,@object
TABLE:
.long 0x3f803f80,0x3f803f80,0x3f803f80,0x3f803f80,0x3f7b3f80,0x3f553f6d,0xbf7bbf80,0xbf55bf6d
.long 0x3f6d3f80,0x3ec43f35,0x3f6d3f80,0x3ec43f35,0x3f553f80,0xbe483ec4,0xbf55bf80,0x3e48bec4
.long 0x3f353f80,0xbf35248d,0x3f353f80,0xbf35261f,0x3f0e3f80,0xbf7bbec4,0xbf0ebf80,0x3f7b3ec4
.long 0x3ec43f80,0xbf6dbf35,0x3ec43f80,0xbf6dbf35,0x3e483f80,0xbf0ebf6d,0xbe48bf80,0x3f0e3f6d
.long 0x248d3f80,0xa554bf80,0xa6543f80,0xa754bf80,0xbe483f80,0x3f0ebf6d,0x3e48bf80,0xbf0e3f6d
.long 0xbec43f80,0x3f6dbf35,0xbec43f80,0x3f6dbf35,0xbf0e3f80,0x3f7bbec4,0x3f0ebf80,0xbf7b3ec4
.long 0xbf353f80,0x3f35a554,0xbf353f80,0x3f35a777,0xbf553f80,0x3e483ec4,0x3f55bf80,0xbe48bec4
.long 0xbf6d3f80,0xbec43f35,0xbf6d3f80,0xbec43f35,0xbf7b3f80,0xbf553f6d,0x3f7bbf80,0x3f55bf6d
.long 0x3f803f80,0x3f803f80,0x3f803f80,0x3f803f80,0x3f0e3f35,0x3e483ec4,0xbf0ebf35,0xbe48bec4
.long 0xbec4248d,0xbf6dbf35,0xbec425b0,0xbf6dbf35,0xbf7bbf35,0xbf0ebf6d,0x3f7b3f35,0x3f0e3f6d
.long 0xbf35bf80,0x3f35a554,0xbf35bf80,0x3f35a731,0x3e48bf35,0x3f553f6d,0xbe483f35,0xbf55bf6d
.long 0x3f6da554,0xbec43f35,0x3f6da742,0xbec43f35,0x3f553f35,0xbf7bbec4,0xbf55bf35,0x3f7b3ec4
.long 0x25b03f80,0xa5f7bf80,0xa60d3f80,0xa765bf80,0xbf553f35,0x3f7bbec4,0x3f55bf35,0xbf7b3ec4
.long 0xbf6d25b0,0x3ec43f35,0xbf6da58e,0x3ec43f35,0xbe48bf35,0xbf553f6d,0x3e483f35,0x3f55bf6d
.long 0x3f35bf80,0xbf35261f,0x3f35bf80,0xbf35258d,0x3f7bbf35,0x3f0ebf6d,0xbf7b3f35,0xbf0e3f6d
.long 0x3ec4a5f7,0x3f6dbf35,0x3ec4a78d,0x3f6dbf35,0xbf0e3f35,0xbe483ec4,0x3f0ebf35,0x3e48bec4
.long 0x3f803f80,0x3f803f80,0x3f803f80,0x3f803f80,0xbe48248d,0xbf0ebec4,0x3e48a554,0x3f0e3ec4
.long 0xbf6dbf80,0xbec4bf35,0xbf6dbf80,0xbec4bf35,0x3f0ea554,0x3f7b3f6d,0xbf0e261f,0xbf7bbf6d
.long 0x3f353f80,0xbf3525b0,0x3f353f80,0xbf35a68d,0xbf5525b0,0xbe48bf6d,0x3f55a742,0x3e483f6d
.long 0xbec4bf80,0x3f6d3f35,0xbec4bf80,0x3f6d3f35,0x3f7ba5f7,0xbf553ec4,0xbf7ba60d,0x3f55bec4
.long 0x261f3f80,0xa731bf80,0xa58e3f80,0xa777bf80,0xbf7b261f,0x3f553ec4,0x3f7ba777,0xbf55bec4
.long 0x3ec4bf80,0xbf6d3f35,0x3ec4bf80,0xbf6d3f35,0x3f55a731,0x3e48bf6d,0xbf55258d,0xbe483f6d
.long 0xbf353f80,0x3f35a742,0xbf353f80,0x3f35a796,0xbf0ea68d,0xbf7b3f6d,0x3f0ea796,0x3f7bbf6d
.long 0x3f6dbf80,0x3ec4bf35,0x3f6dbf80,0x3ec4bf35,0x3e48a742,0x3f0ebec4,0xbe48268d,0xbf0e3ec4
.long 0x3f803f80,0x3f803f80,0x3f803f80,0x3f803f80,0xbf55bf35,0xbf7bbf6d,0x3f553f35,0x3f7b3f6d
.long 0x3ec4a554,0x3f6d3f35,0x3ec4a5f7,0x3f6d3f35,0x3e483f35,0xbf55bec4,0xbe48bf35,0x3f553ec4
.long 0xbf35bf80,0x3f35a5f7,0xbf35bf80,0x3f35a742,0x3f7b3f35,0xbf0e3ec4,0xbf7bbf35,0x3f0ebec4
.long 0xbf6d261f,0x3ec4bf35,0xbf6da60d,0x3ec4bf35,0x3f0ebf35,0xbe483f6d,0xbf0e3f35,0x3e48bf6d
.long 0xa68d3f80,0xa742bf80,0xa1373f80,0xa784bf80,0xbf0ebf35,0x3e483f6d,0x3f0e3f35,0xbe48bf6d
.long 0x3f6da742,0xbec4bf35,0x3f6da78d,0xbec4bf35,0xbf7b3f35,0x3f0e3ec4,0x3f7bbf35,0xbf0ebec4
.long 0x3f35bf80,0xbf35a60d,0x3f35bf80,0xbf35268d,0xbe483f35,0x3f55bec4,0x3e48bf35,0xbf553ec4
.long 0xbec4a60d,0xbf6d3f35,0xbec42816,0xbf6d3f35,0x3f55bf35,0x3f7bbf6d,0xbf553f35,0xbf7b3f6d
.long 0xbf803f80,0xbf803f80,0xbf803f80,0xbf803f80,0xbf7b3f80,0xbf553f6d,0x3f7bbf80,0x3f55bf6d
.long 0xbf6d3f80,0xbec43f35,0xbf6d3f80,0xbec43f35,0xbf553f80,0x3e483ec4,0x3f55bf80,0xbe48bec4
.long 0xbf353f80,0x3f3525b0,0xbf353f80,0x3f35268d,0xbf0e3f80,0x3f7bbec4,0x3f0ebf80,0xbf7b3ec4
.long 0xbec43f80,0x3f6dbf35,0xbec43f80,0x3f6dbf35,0xbe483f80,0x3f0ebf6d,0x3e48bf80,0xbf0e3f6d
.long 0xa5543f80,0x261fbf80,0xa7b13f80,0x281fbf80,0x3e483f80,0xbf0ebf6d,0xbe48bf80,0x3f0e3f6d
.long 0x3ec43f80,0xbf6dbf35,0x3ec43f80,0xbf6dbf35,0x3f0e3f80,0xbf7bbec4,0xbf0ebf80,0x3f7b3ec4
.long 0x3f353f80,0xbf35a5f7,0x3f353f80,0xbf3526d4,0x3f553f80,0xbe483ec4,0xbf55bf80,0x3e48bec4
.long 0x3f6d3f80,0x3ec43f35,0x3f6d3f80,0x3ec43f35,0x3f7b3f80,0x3f553f6d,0xbf7bbf80,0xbf55bf6d
.long 0xbf803f80,0xbf803f80,0xbf803f80,0xbf803f80,0xbf0e3f35,0xbe483ec4,0x3f0ebf35,0x3e48bec4
.long 0x3ec4261f,0x3f6dbf35,0x3ec4268d,0x3f6dbf35,0x3f7bbf35,0x3f0ebf6d,0xbf7b3f35,0xbf0e3f6d
.long 0x3f35bf80,0xbf35a742,0x3f35bf80,0xbf35270d,0xbe48bf35,0xbf553f6d,0x3e483f35,0x3f55bf6d
.long 0xbf6da731,0x3ec43f35,0xbf6d270d,0x3ec43f35,0xbf553f35,0x3f7bbec4,0x3f55bf35,0xbf7b3ec4
.long 0xa7423f80,0xa60dbf80,0x26d43f80,0x2730bf80,0x3f553f35,0xbf7bbec4,0xbf55bf35,0x3f7b3ec4
.long 0x3f6da68d,0xbec43f35,0x3f6d2828,0xbec43f35,0x3e48bf35,0x3f553f6d,0xbe483f35,0xbf55bf6d
.long 0xbf35bf80,0x3f35a60d,0xbf35bf80,0x3f352754,0xbf7bbf35,0xbf0ebf6d,0x3f7b3f35,0x3f0e3f6d
.long 0xbec4a742,0xbf6dbf35,0xbec4a7e5,0xbf6dbf35,0x3f0e3f35,0x3e483ec4,0xbf0ebf35,0xbe48bec4
.long 0xbf803f80,0xbf803f80,0xbf803f80,0xbf803f80,0x3e48a654,0x3f0ebec4,0xbe48a7b1,0xbf0e3ec4
.long 0x3f6dbf80,0x3ec4bf35,0x3f6dbf80,0x3ec4bf35,0xbf0ea754,0xbf7b3f6d,0x3f0e281f,0x3f7bbf6d
.long 0xbf353f80,0x3f35a58e,0xbf353f80,0x3f352828,0x3f55a60d,0x3e48bf6d,0xbf5526d4,0xbe483f6d
.long 0x3ec4bf80,0xbf6d3f35,0x3ec4bf80,0xbf6d3f35,0xbf7ba765,0x3f553ec4,0x3f7b2730,0xbf55bec4
.long 0xa7773f80,0x258dbf80,0xa7e53f80,0x2839bf80,0x3f7ba58e,0xbf553ec4,0xbf7ba7e5,0x3f55bec4
.long 0xbec4bf80,0x3f6d3f35,0xbec4bf80,0x3f6d3f35,0xbf55a777,0xbe48bf6d,0x3f552839,0x3e483f6d
.long 0x3f353f80,0xbf35a78d,0x3f353f80,0xbf35a804,0x3f0ea137,0x3f7b3f6d,0xbf0ea880,0xbf7bbf6d
.long 0xbf6dbf80,0xbec4bf35,0xbf6dbf80,0xbec4bf35,0xbe48a784,0xbf0ebec4,0x3e4828a3,0x3f0e3ec4
.long 0xbf803f80,0xbf803f80,0xbf803f80,0xbf803f80,0x3f55bf35,0x3f7bbf6d,0xbf553f35,0xbf7b3f6d
.long 0xbec4a777,0xbf6d3f35,0xbec426d4,0xbf6d3f35,0xbe483f35,0x3f55bec4,0x3e48bf35,0xbf553ec4
.long 0x3f35bf80,0xbf35a78d,0x3f35bf80,0xbf35a7e5,0xbf7b3f35,0x3f0e3ec4,0x3f7bbf35,0xbf0ebec4
.long 0x3f6d258d,0xbec4bf35,0x3f6d2754,0xbec4bf35,0xbf0ebf35,0x3e483f6d,0x3f0e3f35,0xbe48bf6d
.long 0xa7963f80,0x268dbf80,0xa8803f80,0x28a3bf80,0x3f0ebf35,0xbe483f6d,0xbf0e3f35,0x3e48bf6d
.long 0xbf6da796,0x3ec4bf35,0xbf6da804,0x3ec4bf35,0x3f7b3f35,0xbf0e3ec4,0xbf7bbf35,0x3f0ebec4
.long 0xbf35bf80,0x3f352816,0xbf35bf80,0x3f35a731,0x3e483f35,0xbf55bec4,0xbe48bf35,0x3f553ec4
.long 0x3ec4268d,0x3f6d3f35,0x3ec4a731,0x3f6d3f35,0xbf55bf35,0xbf7bbf6d,0x3f553f35,0x3f7b3f6d
.long 0x00000000,0x00000000,0x00000000,0x00000000,0x3e480000,0x3f0e3ec4,0xbe48250d,0xbf0ebec4
.long 0x3ec40000,0x3f6d3f35,0x3ec4a58d,0x3f6d3f35,0x3f0e0000,0x3f7b3f6d,0xbf0e25d4,0xbf7bbf6d
.long 0x3f350000,0x3f353f80,0x3f35a60d,0x3f353f80,0x3f550000,0x3e483f6d,0xbf552630,0xbe48bf6d
.long 0x3f6d0000,0xbec43f35,0x3f6da654,0xbec43f35,0x3f7b0000,0xbf553ec4,0xbf7b2677,0x3f55bec4
.long 0x3f800000,0xbf80250d,0x3f80a68d,0xbf80269f,0x3f7b0000,0xbf55bec4,0xbf7b269f,0x3f553ec4
.long 0x3f6d0000,0xbec4bf35,0x3f6da6b0,0xbec4bf35,0x3f550000,0x3e48bf6d,0xbf5527b1,0xbe483f6d
.long 0x3f350000,0x3f35bf80,0x3f35a6d4,0x3f35bf80,0x3f0e0000,0x3f7bbf6d,0xbf0ea70d,0xbf7b3f6d
.long 0x3ec40000,0x3f6dbf35,0x3ec4a6f7,0x3f6dbf35,0x3e480000,0x3f0ebec4,0xbe4827c2,0xbf0e3ec4
.long 0x00000000,0x00000000,0x00000000,0x00000000,0x3f553f35,0x3f7b3f6d,0xbf55bf35,0xbf7bbf6d
.long 0x3f6d3f80,0x3ec43f35,0x3f6d3f80,0x3ec43f35,0x3e483f35,0xbf55bec4,0xbe48bf35,0x3f553ec4
.long 0xbf35250d,0xbf35bf80,0xbf352630,0xbf35bf80,0xbf7bbf35,0x3f0ebec4,0x3f7b3f35,0xbf0e3ec4
.long 0xbec4bf80,0x3f6d3f35,0xbec4bf80,0x3f6d3f35,0x3f0ebf35,0xbe483f6d,0xbf0e3f35,0x3e48bf6d
.long 0x3f80a58d,0xbf8025d4,0x3f80a6b0,0xbf8027b1,0x3f0e3f35,0xbe48bf6d,0xbf0ebf35,0x3e483f6d
.long 0xbec43f80,0x3f6dbf35,0xbec43f80,0x3f6dbf35,0xbf7b3f35,0x3f0e3ec4,0x3f7bbf35,0xbf0ebec4
.long 0xbf3525d4,0xbf353f80,0xbf3527c2,0xbf353f80,0x3e48bf35,0xbf553ec4,0xbe483f35,0x3f55bec4
.long 0x3f6dbf80,0x3ec4bf35,0x3f6dbf80,0x3ec4bf35,0x3f55bf35,0x3f7bbf6d,0xbf553f35,0xbf7b3f6d
.long 0x00000000,0x00000000,0x00000000,0x00000000,0x3f7b3f80,0x3f553f6d,0xbf7bbf80,0xbf55bf6d
.long 0xbec4250d,0xbf6dbf35,0xbec425d4,0xbf6dbf35,0xbf55bf80,0x3e48bec4,0x3f553f80,0xbe483ec4
.long 0x3f35a58d,0x3f353f80,0x3f35a654,0x3f353f80,0x3f0e3f80,0xbf7bbec4,0xbf0ebf80,0x3f7b3ec4
.long 0xbf6d25d4,0x3ec4bf35,0xbf6d269f,0x3ec4bf35,0xbe48bf80,0x3f0e3f6d,0x3e483f80,0xbf0ebf6d
.long 0x3f80a60d,0xbf802630,0x3f80a6d4,0xbf80a70d,0xbe483f80,0x3f0ebf6d,0x3e48bf80,0xbf0e3f6d
.long 0xbf6d2630,0x3ec43f35,0xbf6d27c2,0x3ec43f35,0x3f0ebf80,0xbf7b3ec4,0xbf0e3f80,0x3f7bbec4
.long 0x3f35a654,0x3f35bf80,0x3f35a71f,0x3f35bf80,0xbf553f80,0x3e483ec4,0x3f55bf80,0xbe48bec4
.long 0xbec42677,0xbf6d3f35,0xbec4a68d,0xbf6d3f35,0x3f7bbf80,0x3f55bf6d,0xbf7b3f80,0xbf553f6d
.long 0x00000000,0x00000000,0x00000000,0x00000000,0x3f0e3f35,0x3e483ec4,0xbf0ebf35,0xbe48bec4
.long 0xbf6dbf80,0xbec4bf35,0xbf6dbf80,0xbec4bf35,0x3f7b3f35,0x3f0e3f6d,0xbf7bbf35,0xbf0ebf6d
.long 0xbf3525d4,0xbf35bf80,0xbf352677,0xbf35bf80,0x3e48bf35,0x3f553f6d,0xbe483f35,0xbf55bf6d
.long 0x3ec43f80,0xbf6dbf35,0x3ec43f80,0xbf6dbf35,0xbf55bf35,0x3f7b3ec4,0x3f553f35,0xbf7bbec4
.long 0x3f80a654,0xbf802677,0x3f80a6f7,0xbf8027c2,0xbf553f35,0x3f7bbec4,0x3f55bf35,0xbf7b3ec4
.long 0x3ec4bf80,0xbf6d3f35,0x3ec4bf80,0xbf6d3f35,0x3e483f35,0x3f55bf6d,0xbe48bf35,0xbf553f6d
.long 0xbf35269f,0xbf353f80,0xbf35a68d,0xbf353f80,0x3f7bbf35,0x3f0ebf6d,0xbf7b3f35,0xbf0e3f6d
.long 0xbf6d3f80,0xbec43f35,0xbf6d3f80,0xbec43f35,0x3f0ebf35,0x3e48bec4,0xbf0e3f35,0xbe483ec4
.long 0x250d0000,0x25d4a58d,0xa6d4a70d,0x27d4a71f,0xbe480000,0xbf0e3ec4,0x3e48a6d4,0x3f0ebec4
.long 0xbec40000,0xbf6d3f35,0xbec4a71f,0xbf6d3f35,0xbf0e0000,0xbf7b3f6d,0x3f0e27d4,0x3f7bbf6d
.long 0xbf350000,0xbf353f80,0xbf35a730,0xbf353f80,0xbf550000,0xbe483f6d,0x3f55a68d,0x3e48bf6d
.long 0xbf6d0000,0x3ec43f35,0xbf6da831,0x3ec43f35,0xbf7b0000,0x3f553ec4,0x3f7b27e5,0xbf55bec4
.long 0xbf800000,0x3f8025d4,0xbf80a754,0x3f8027f7,0xbf7b0000,0x3f55bec4,0x3f7ba60e,0xbf553ec4
.long 0xbf6d0000,0x3ec4bf35,0xbf6d278d,0x3ec4bf35,0xbf550000,0xbe48bf6d,0x3f5527f7,0x3e483f6d
.long 0xbf350000,0xbf35bf80,0xbf35a777,0xbf35bf80,0xbf0e0000,0xbf7bbf6d,0x3f0ea1b7,0x3f7b3f6d
.long 0xbec40000,0xbf6dbf35,0xbec4a842,0xbf6dbf35,0xbe480000,0xbf0ebec4,0x3e482804,0x3f0e3ec4
.long 0x2630a60d,0x2677a654,0xa68da730,0x27e5a831,0xbf553f35,0xbf7b3f6d,0x3f55bf35,0x3f7bbf6d
.long 0xbf6d3f80,0xbec43f35,0xbf6d3f80,0xbec43f35,0xbe483f35,0x3f55bec4,0x3e48bf35,0xbf553ec4
.long 0x3f352630,0x3f35bf80,0x3f35a60e,0x3f35bf80,0x3f7bbf35,0xbf0ebec4,0xbf7b3f35,0x3f0e3ec4
.long 0x3ec4bf80,0xbf6d3f35,0x3ec4bf80,0xbf6d3f35,0xbf0ebf35,0x3e483f6d,0x3f0e3f35,0xbe48bf6d
.long 0xbf80a654,0x3f80269f,0xbf80a842,0x3f80260d,0xbf0e3f35,0x3e48bf6d,0x3f0ebf35,0xbe483f6d
.long 0x3ec43f80,0xbf6dbf35,0x3ec43f80,0xbf6dbf35,0x3f7b3f35,0xbf0e3ec4,0xbf7bbf35,0x3f0ebec4
.long 0x3f352677,0x3f353f80,0x3f35280d,0x3f353f80,0xbe48bf35,0x3f553ec4,0x3e483f35,0xbf55bec4
.long 0xbf6dbf80,0xbec4bf35,0xbf6dbf80,0xbec4bf35,0xbf55bf35,0xbf7bbf6d,0x3f553f35,0x3f7b3f6d
.long 0x269fa68d,0x27b1a6b0,0xa60ea754,0x27f7278d,0xbf7b3f80,0xbf553f6d,0x3f7bbf80,0x3f55bf6d
.long 0x3ec4269f,0x3f6dbf35,0x3ec427f7,0x3f6dbf35,0x3f55bf80,0xbe48bec4,0xbf553f80,0x3e483ec4
.long 0xbf35a6b0,0xbf353f80,0xbf35a842,0xbf353f80,0xbf0e3f80,0x3f7bbec4,0x3f0ebf80,0xbf7b3ec4
.long 0x3f6d27b1,0xbec4bf35,0x3f6d260d,0xbec4bf35,0x3e48bf80,0xbf0e3f6d,0xbe483f80,0x3f0ebf6d
.long 0xbf80a6d4,0x3f8027c2,0xbf80a79f,0x3f802816,0x3e483f80,0xbf0ebf6d,0xbe48bf80,0x3f0e3f6d
.long 0x3f6da70d,0xbec43f35,0x3f6d2816,0xbec43f35,0xbf0ebf80,0x3f7b3ec4,0x3f0e3f80,0xbf7bbec4
.long 0xbf35a6f7,0xbf35bf80,0xbf35270d,0xbf35bf80,0x3f553f80,0xbe483ec4,0xbf55bf80,0x3e48bec4
.long 0x3ec427c2,0x3f6d3f35,0x3ec4270d,0x3f6d3f35,0xbf7bbf80,0xbf55bf6d,0x3f7b3f80,0x3f553f6d
.long 0xa70da6d4,0x27c2a6f7,0xa1b7a777,0x2804a842,0xbf0e3f35,0xbe483ec4,0x3f0ebf35,0x3e48bec4
.long 0x3f6dbf80,0x3ec4bf35,0x3f6dbf80,0x3ec4bf35,0xbf7b3f35,0xbf0e3f6d,0x3f7bbf35,0x3f0ebf6d
.long 0x3f3527c2,0x3f35bf80,0x3f35280d,0x3f35bf80,0xbe48bf35,0xbf553f6d,0x3e483f35,0x3f55bf6d
.long 0xbec43f80,0x3f6dbf35,0xbec43f80,0x3f6dbf35,0x3f55bf35,0xbf7b3ec4,0xbf553f35,0x3f7bbec4
.long 0xbf80a71f,0x3f80a68d,0xbf80270d,0x3f80270d,0x3f553f35,0xbf7bbec4,0xbf55bf35,0x3f7b3ec4
.long 0xbec4bf80,0x3f6d3f35,0xbec4bf80,0x3f6d3f35,0xbe483f35,0xbf55bf6d,0x3e48bf35,0x3f553f6d
.long 0x3f35a68d,0x3f353f80,0x3f352896,0x3f353f80,0xbf7bbf35,0xbf0ebf6d,0x3f7b3f35,0x3f0e3f6d
.long 0x3f6d3f80,0x3ec43f35,0x3f6d3f80,0x3ec43f35,0xbf0ebf35,0xbe48bec4,0x3f0e3f35,0x3e483ec4
.long 0x80008000,0x80008000,0x80008000,0x80008000,0xbe488000,0xbf0ebec4,0x3e48a50d,0x3f0e3ec4
.long 0xbec48000,0xbf6dbf35,0xbec4258d,0xbf6dbf35,0xbf0e8000,0xbf7bbf6d,0x3f0ea5d4,0x3f7b3f6d
.long 0xbf358000,0xbf35bf80,0xbf35260d,0xbf35bf80,0xbf558000,0xbe48bf6d,0x3f55a630,0x3e483f6d
.long 0xbf6d8000,0x3ec4bf35,0xbf6d2654,0x3ec4bf35,0xbf7b8000,0x3f55bec4,0x3f7ba677,0xbf553ec4
.long 0xbf808000,0x3f80a50d,0xbf80268d,0x3f80a69f,0xbf7b8000,0x3f553ec4,0x3f7ba69f,0xbf55bec4
.long 0xbf6d8000,0x3ec43f35,0xbf6d26b0,0x3ec43f35,0xbf558000,0xbe483f6d,0x3f55a7b1,0x3e48bf6d
.long 0xbf358000,0xbf353f80,0xbf3526d4,0xbf353f80,0xbf0e8000,0xbf7b3f6d,0x3f0e270d,0x3f7bbf6d
.long 0xbec48000,0xbf6d3f35,0xbec426f7,0xbf6d3f35,0xbe488000,0xbf0e3ec4,0x3e48a7c2,0x3f0ebec4
.long 0x80008000,0x80008000,0x80008000,0x80008000,0xbf55bf35,0xbf7bbf6d,0x3f553f35,0x3f7b3f6d
.long 0xbf6dbf80,0xbec4bf35,0xbf6dbf80,0xbec4bf35,0xbe48bf35,0x3f553ec4,0x3e483f35,0xbf55bec4
.long 0x3f35a50d,0x3f353f80,0x3f35a630,0x3f353f80,0x3f7b3f35,0xbf0e3ec4,0xbf7bbf35,0x3f0ebec4
.long 0x3ec43f80,0xbf6dbf35,0x3ec43f80,0xbf6dbf35,0xbf0e3f35,0x3e48bf6d,0x3f0ebf35,0xbe483f6d
.long 0xbf80258d,0x3f80a5d4,0xbf8026b0,0x3f80a7b1,0xbf0ebf35,0x3e483f6d,0x3f0e3f35,0xbe48bf6d
.long 0x3ec4bf80,0xbf6d3f35,0x3ec4bf80,0xbf6d3f35,0x3f7bbf35,0xbf0ebec4,0xbf7b3f35,0x3f0e3ec4
.long 0x3f35a5d4,0x3f35bf80,0x3f35a7c2,0x3f35bf80,0xbe483f35,0x3f55bec4,0x3e48bf35,0xbf553ec4
.long 0xbf6d3f80,0xbec43f35,0xbf6d3f80,0xbec43f35,0xbf553f35,0xbf7b3f6d,0x3f55bf35,0x3f7bbf6d
.long 0x80008000,0x80008000,0x80008000,0x80008000,0xbf7bbf80,0xbf55bf6d,0x3f7b3f80,0x3f553f6d
.long 0x3ec4a50d,0x3f6d3f35,0x3ec4a5d4,0x3f6d3f35,0x3f553f80,0xbe483ec4,0xbf55bf80,0x3e48bec4
.long 0xbf35258d,0xbf35bf80,0xbf352654,0xbf35bf80,0xbf0ebf80,0x3f7b3ec4,0x3f0e3f80,0xbf7bbec4
.long 0x3f6da5d4,0xbec43f35,0x3f6da69f,0xbec43f35,0x3e483f80,0xbf0ebf6d,0xbe48bf80,0x3f0e3f6d
.long 0xbf80260d,0x3f80a630,0xbf8026d4,0x3f80270d,0x3e48bf80,0xbf0e3f6d,0xbe483f80,0x3f0ebf6d
.long 0x3f6da630,0xbec4bf35,0x3f6da7c2,0xbec4bf35,0xbf0e3f80,0x3f7bbec4,0x3f0ebf80,0xbf7b3ec4
.long 0xbf352654,0xbf353f80,0xbf35271f,0xbf353f80,0x3f55bf80,0xbe48bec4,0xbf553f80,0x3e483ec4
.long 0x3ec4a677,0x3f6dbf35,0x3ec4268d,0x3f6dbf35,0xbf7b3f80,0xbf553f6d,0x3f7bbf80,0x3f55bf6d
.long 0x80008000,0x80008000,0x80008000,0x80008000,0xbf0ebf35,0xbe48bec4,0x3f0e3f35,0x3e483ec4
.long 0x3f6d3f80,0x3ec43f35,0x3f6d3f80,0x3ec43f35,0xbf7bbf35,0xbf0ebf6d,0x3f7b3f35,0x3f0e3f6d
.long 0x3f35a5d4,0x3f353f80,0x3f35a677,0x3f353f80,0xbe483f35,0xbf55bf6d,0x3e48bf35,0x3f553f6d
.long 0xbec4bf80,0x3f6d3f35,0xbec4bf80,0x3f6d3f35,0x3f553f35,0xbf7bbec4,0xbf55bf35,0x3f7b3ec4
.long 0xbf802654,0x3f80a677,0xbf8026f7,0x3f80a7c2,0x3f55bf35,0xbf7b3ec4,0xbf553f35,0x3f7bbec4
.long 0xbec43f80,0x3f6dbf35,0xbec43f80,0x3f6dbf35,0xbe48bf35,0xbf553f6d,0x3e483f35,0x3f55bf6d
.long 0x3f35a69f,0x3f35bf80,0x3f35268d,0x3f35bf80,0xbf7b3f35,0xbf0e3f6d,0x3f7bbf35,0x3f0ebf6d
.long 0x3f6dbf80,0x3ec4bf35,0x3f6dbf80,0x3ec4bf35,0xbf0e3f35,0xbe483ec4,0x3f0ebf35,0x3e48bec4
.long 0xa50d8000,0xa5d4258d,0x26d4270d,0xa7d4271f,0x3e488000,0x3f0ebec4,0xbe4826d4,0xbf0e3ec4
.long 0x3ec48000,0x3f6dbf35,0x3ec4271f,0x3f6dbf35,0x3f0e8000,0x3f7bbf6d,0xbf0ea7d4,0xbf7b3f6d
.long 0x3f358000,0x3f35bf80,0x3f352730,0x3f35bf80,0x3f558000,0x3e48bf6d,0xbf55268d,0xbe483f6d
.long 0x3f6d8000,0xbec4bf35,0x3f6d2831,0xbec4bf35,0x3f7b8000,0xbf55bec4,0xbf7ba7e5,0x3f553ec4
.long 0x3f808000,0xbf80a5d4,0x3f802754,0xbf80a7f7,0x3f7b8000,0xbf553ec4,0xbf7b260e,0x3f55bec4
.long 0x3f6d8000,0xbec43f35,0x3f6da78d,0xbec43f35,0x3f558000,0x3e483f6d,0xbf55a7f7,0xbe48bf6d
.long 0x3f358000,0x3f353f80,0x3f352777,0x3f353f80,0x3f0e8000,0x3f7b3f6d,0xbf0e21b7,0xbf7bbf6d
.long 0x3ec48000,0x3f6d3f35,0x3ec42842,0x3f6d3f35,0x3e488000,0x3f0e3ec4,0xbe48a804,0xbf0ebec4
.long 0xa630260d,0xa6772654,0x268d2730,0xa7e52831,0x3f55bf35,0x3f7bbf6d,0xbf553f35,0xbf7b3f6d
.long 0x3f6dbf80,0x3ec4bf35,0x3f6dbf80,0x3ec4bf35,0x3e48bf35,0xbf553ec4,0xbe483f35,0x3f55bec4
.long 0xbf35a630,0xbf353f80,0xbf35260e,0xbf353f80,0xbf7b3f35,0x3f0e3ec4,0x3f7bbf35,0xbf0ebec4
.long 0xbec43f80,0x3f6dbf35,0xbec43f80,0x3f6dbf35,0x3f0e3f35,0xbe48bf6d,0xbf0ebf35,0x3e483f6d
.long 0x3f802654,0xbf80a69f,0x3f802842,0xbf80a60d,0x3f0ebf35,0xbe483f6d,0xbf0e3f35,0x3e48bf6d
.long 0xbec4bf80,0x3f6d3f35,0xbec4bf80,0x3f6d3f35,0xbf7bbf35,0x3f0ebec4,0x3f7b3f35,0xbf0e3ec4
.long 0xbf35a677,0xbf35bf80,0xbf35a80d,0xbf35bf80,0x3e483f35,0xbf55bec4,0xbe48bf35,0x3f553ec4
.long 0x3f6d3f80,0x3ec43f35,0x3f6d3f80,0x3ec43f35,0x3f553f35,0x3f7b3f6d,0xbf55bf35,0xbf7bbf6d
.long 0xa69f268d,0xa7b126b0,0x260e2754,0xa7f7a78d,0x3f7bbf80,0x3f55bf6d,0xbf7b3f80,0xbf553f6d
.long 0xbec4a69f,0xbf6d3f35,0xbec4a7f7,0xbf6d3f35,0xbf553f80,0x3e483ec4,0x3f55bf80,0xbe48bec4
.long 0x3f3526b0,0x3f35bf80,0x3f352842,0x3f35bf80,0x3f0ebf80,0xbf7b3ec4,0xbf0e3f80,0x3f7bbec4
.long 0xbf6da7b1,0x3ec43f35,0xbf6da60d,0x3ec43f35,0xbe483f80,0x3f0ebf6d,0x3e48bf80,0xbf0e3f6d
.long 0x3f8026d4,0xbf80a7c2,0x3f80279f,0xbf80a816,0xbe48bf80,0x3f0e3f6d,0x3e483f80,0xbf0ebf6d
.long 0xbf6d270d,0x3ec4bf35,0xbf6da816,0x3ec4bf35,0x3f0e3f80,0xbf7bbec4,0xbf0ebf80,0x3f7b3ec4
.long 0x3f3526f7,0x3f353f80,0x3f35a70d,0x3f353f80,0xbf55bf80,0x3e48bec4,0x3f553f80,0xbe483ec4
.long 0xbec4a7c2,0xbf6dbf35,0xbec4a70d,0xbf6dbf35,0x3f7b3f80,0x3f553f6d,0xbf7bbf80,0xbf55bf6d
.long 0x270d26d4,0xa7c226f7,0x21b72777,0xa8042842,0x3f0ebf35,0x3e48bec4,0xbf0e3f35,0xbe483ec4
.long 0xbf6d3f80,0xbec43f35,0xbf6d3f80,0xbec43f35,0x3f7bbf35,0x3f0ebf6d,0xbf7b3f35,0xbf0e3f6d
.long 0xbf35a7c2,0xbf353f80,0xbf35a80d,0xbf353f80,0x3e483f35,0x3f55bf6d,0xbe48bf35,0xbf553f6d
.long 0x3ec4bf80,0xbf6d3f35,0x3ec4bf80,0xbf6d3f35,0xbf553f35,0x3f7bbec4,0x3f55bf35,0xbf7b3ec4
.long 0x3f80271f,0xbf80268d,0x3f80a70d,0xbf80a70d,0xbf55bf35,0x3f7b3ec4,0x3f553f35,0xbf7bbec4
.long 0x3ec43f80,0xbf6dbf35,0x3ec43f80,0xbf6dbf35,0x3e48bf35,0x3f553f6d,0xbe483f35,0xbf55bf6d
.long 0xbf35268d,0xbf35bf80,0xbf35a896,0xbf35bf80,0x3f7b3f35,0x3f0e3f6d,0xbf7bbf35,0xbf0ebf6d
.long 0xbf6dbf80,0xbec4bf35,0xbf6dbf80,0xbec4bf35,0x3f0e3f35,0x3e483ec4,0xbf0ebf35,0xbe48bec4
.long 0x3f800000,0x3f800000,0x3f800000,0x3f800000,0x3f800000,0x3f7ffb11,0x3f7fec43,0x3f7fd397
.long 0x3f800000,0x3f7fec43,0x3f7fb10f,0x3f7f4e6d,0x3f800000,0x3f7fd397,0x3f7f4e6d,0x3f7e70b0
.long 0x3f800000,0x3f7fb10f,0x3f7ec46d,0x3f7d3aac,0x3f800000,0x3f7f84ab,0x3f7e1324,0x3f7baccd
.long 0x3f800000,0x3f7f4e6d,0x3f7d3aac,0x3f79c79d,0x3f800000,0x3f7f0e58,0x3f7c3b28,0x3f778bc5
.long 0x3f800000,0x3f7ec46d,0x3f7b14be,0x3f74fa0b,0x3f800000,0x3f7e70b0,0x3f79c79d,0x3f721352
.long 0x3f800000,0x3f7e1324,0x3f7853f8,0x3f6ed89e,0x3f800000,0x3f7dabcc,0x3f76ba07,0x3f6b4b0c
.long 0x3f800000,0x3f7d3aac,0x3f74fa0b,0x3f676bd8,0x3f800000,0x3f7cbfc9,0x3f731447,0x3f633c5a
.long 0x3f800000,0x3f7c3b28,0x3f710908,0x3f5ebe05,0x3f800000,0x3f7baccd,0x3f6ed89e,0x3f59f26a
.long 0x3f800000,0x3f800000,0x3f800000,0x3f800000,0x3f7fb10f,0x3f7f84ab,0x3f7f4e6d,0x3f7f0e58
.long 0x3f7ec46d,0x3f7e1324,0x3f7d3aac,0x3f7c3b28,0x3f7d3aac,0x3f7baccd,0x3f79c79d,0x3f778bc5
.long 0x3f7b14be,0x3f7853f8,0x3f74fa0b,0x3f710908,0x3f7853f8,0x3f740bdd,0x3f6ed89e,0x3f68bf3c
.long 0x3f74fa0b,0x3f6ed89e,0x3f676bd8,0x3f5ebe05,0x3f710908,0x3f68bf3c,0x3f5ebe05,0x3f531849
.long 0x3f6c835e,0x3f61c598,0x3f54db31,0x3f45e403,0x3f676bd8,0x3f59f26a,0x3f49d112,0x3f373a23
.long 0x3f61c598,0x3f514d3d,0x3f3daef9,0x3f273656,0x3f5b941a,0x3f47de65,0x3f3085bb,0x3f15f6d9
.long 0x3f54db31,0x3f3daef9,0x3f226799,0x3f039c3d,0x3f4d9f02,0x3f32c8c9,0x3f13682a,0x3ee0924f
.long 0x3f45e403,0x3f273656,0x3f039c3d,0x3eb8442a,0x3f3daef9,0x3f1b02c6,0x3ee63375,0x3e8e9a22
.long 0x3f800000,0x3f800000,0x3f800000,0x3f800000,0x3f7ec46d,0x3f7e70b0,0x3f7e1324,0x3f7dabcc
.long 0x3f7b14be,0x3f79c79d,0x3f7853f8,0x3f76ba07,0x3f74fa0b,0x3f721352,0x3f6ed89e,0x3f6b4b0c
.long 0x3f6c835e,0x3f676bd8,0x3f61c598,0x3f5b941a,0x3f61c598,0x3f59f26a,0x3f514d3d,0x3f47de65
.long 0x3f54db31,0x3f49d112,0x3f3daef9,0x3f3085bb,0x3f45e403,0x3f373a23,0x3f273656,0x3f15f6d9
.long 0x3f3504f3,0x3f226799,0x3f0e39da,0x3ef15aea,0x3f226799,0x3f0b9a6b,0x3ee63375,0x3eb263ef
.long 0x3f0e39da,0x3ee63375,0x3eac7cd4,0x3e605c13,0x3ef15aea,0x3eb263ef,0x3e605c13,0x3dafb680
.long 0x3ec3ef15,0x3e78cfcc,0x3dc8bd36,0xbd48fb30,0x3e94a031,0x3e09cf86,0xbcc90ab0,0xbe3b6ecf
.long 0x3e47c5c2,0x3cc90ab0,0xbe164083,0xbea09ae5,0x3dc8bd36,0xbdafb680,0xbe888e93,0xbee0924f
.long 0x3f800000,0x3f800000,0x3f800000,0x3f800000,0x3f7d3aac,0x3f7cbfc9,0x3f7c3b28,0x3f7baccd
.long 0x3f74fa0b,0x3f731447,0x3f710908,0x3f6ed89e,0x3f676bd8,0x3f633c5a,0x3f5ebe05,0x3f59f26a
.long 0x3f54db31,0x3f4d9f02,0x3f45e403,0x3f3daef9,0x3f3daef9,0x3f32c8c9,0x3f273656,0x3f1b02c6
.long 0x3f226799,0x3f13682a,0x3f039c3d,0x3ee63375,0x3f039c3d,0x3ee0924f,0x3eb8442a,0x3e8e9a22
.long 0x3ec3ef15,0x3e94a031,0x3e47c5c2,0x3dc8bd36,0x3e78cfcc,0x3e09cf86,0x3cc90ab0,0xbdafb680
.long 0x3dc8bd36,0xbcc90ab0,0xbe164083,0xbe888e93,0xbd48fb30,0xbe3b6ecf,0xbea09ae5,0xbee0924f
.long 0xbe47c5c2,0xbeac7cd4,0xbef15aea,0xbf187fc0,0xbeac7cd4,0xbef6e0cb,0xbf1d7fd1,0xbf3b8f3b
.long 0xbef15aea,0xbf1d7fd1,0xbf3daef9,0xbf584853,0xbf187fc0,0xbf3b8f3b,0xbf584853,0xbf6db293
.long 0x00000000,0x00000000,0x00000000,0x00000000,0x00000000,0x3c490e90,0x3cc90ab0,0x3d16c32c
.long 0x00000000,0x3cc90ab0,0x3d48fb30,0x3d96a905,0x00000000,0x3d16c32c,0x3d96a905,0x3de1bc2e
.long 0x00000000,0x3d48fb30,0x3dc8bd36,0x3e164083,0x00000000,0x3d7b2b74,0x3dfab273,0x3e3b6ecf
.long 0x00000000,0x3d96a905,0x3e164083,0x3e605c13,0x00000000,0x3dafb680,0x3e2f10a2,0x3e827dc0
.long 0x00000000,0x3dc8bd36,0x3e47c5c2,0x3e94a031,0x00000000,0x3de1bc2e,0x3e605c13,0x3ea68f12
.long 0x00000000,0x3dfab273,0x3e78cfcc,0x3eb8442a,0x00000000,0x3e09cf86,0x3e888e93,0x3ec9b953
.long 0x00000000,0x3e164083,0x3e94a031,0x3edae880,0x00000000,0x3e22abb6,0x3ea09ae5,0x3eebcbbb
.long 0x00000000,0x3e2f10a2,0x3eac7cd4,0x3efc5d27,0x00000000,0x3e3b6ecf,0x3eb8442a,0x3f064b82
.long 0x00000000,0x00000000,0x00000000,0x00000000,0x3d48fb30,0x3d7b2b74,0x3d96a905,0x3dafb680
.long 0x3dc8bd36,0x3dfab273,0x3e164083,0x3e2f10a2,0x3e164083,0x3e3b6ecf,0x3e605c13,0x3e827dc0
.long 0x3e47c5c2,0x3e78cfcc,0x3e94a031,0x3eac7cd4,0x3e78cfcc,0x3e9aa086,0x3eb8442a,0x3ed53641
.long 0x3e94a031,0x3eb8442a,0x3edae880,0x3efc5d27,0x3eac7cd4,0x3ed53641,0x3efc5d27,0x3f10d3cd
.long 0x3ec3ef15,0x3ef15aea,0x3f0e39da,0x3f226799,0x3edae880,0x3f064b82,0x3f1d7fd1,0x3f32c8c9
.long 0x3ef15aea,0x3f13682a,0x3f2beb4a,0x3f41d870,0x3f039c3d,0x3f1ff6cb,0x3f396842,0x3f4f7a1f
.long 0x3f0e39da,0x3f2beb4a,0x3f45e403,0x3f5b941a,0x3f187fc0,0x3f373a23,0x3f514d3d,0x3f660f88
.long 0x3f226799,0x3f41d870,0x3f5b941a,0x3f6ed89e,0x3f2beb4a,0x3f4bbbf8,0x3f64aa59,0x3f75dec6
.long 0x00000000,0x00000000,0x00000000,0x00000000,0x3dc8bd36,0x3de1bc2e,0x3dfab273,0x3e09cf86
.long 0x3e47c5c2,0x3e605c13,0x3e78cfcc,0x3e888e93,0x3e94a031,0x3ea68f12,0x3eb8442a,0x3ec9b953
.long 0x3ec3ef15,0x3edae880,0x3ef15aea,0x3f039c3d,0x3ef15aea,0x3f064b82,0x3f13682a,0x3f1ff6cb
.long 0x3f0e39da,0x3f1d7fd1,0x3f2beb4a,0x3f396842,0x3f226799,0x3f32c8c9,0x3f41d870,0x3f4f7a1f
.long 0x3f3504f3,0x3f45e403,0x3f54db31,0x3f61c598,0x3f45e403,0x3f5695e5,0x3f64aa59,0x3f6ff573
.long 0x3f54db31,0x3f64aa59,0x3f710908,0x3f79c79d,0x3f61c598,0x3f6ff573,0x3f79c79d,0x3f7f0e58
.long 0x3f6c835e,0x3f7853f8,0x3f7ec46d,0x3f7fb10f,0x3f74fa0b,0x3f7dabcc,0x3f7fec43,0x3f7baccd
.long 0x3f7b14be,0x3f7fec43,0x3f7d3aac,0x3f731447,0x3f7ec46d,0x3f7f0e58,0x3f76ba07,0x3f660f88
.long 0x00000000,0x00000000,0x00000000,0x00000000,0x3e164083,0x3e22abb6,0x3e2f10a2,0x3e3b6ecf
.long 0x3e94a031,0x3ea09ae5,0x3eac7cd4,0x3eb8442a,0x3edae880,0x3eebcbbb,0x3efc5d27,0x3f064b82
.long 0x3f0e39da,0x3f187fc0,0x3f226799,0x3f2beb4a,0x3f2beb4a,0x3f373a23,0x3f41d870,0x3f4bbbf8
.long 0x3f45e403,0x3f514d3d,0x3f5b941a,0x3f64aa59,0x3f5b941a,0x3f660f88,0x3f6ed89e,0x3f75dec6
.long 0x3f6c835e,0x3f74fa0b,0x3f7b14be,0x3f7ec46d,0x3f7853f8,0x3f7dabcc,0x3f7fec43,0x3f7f0e58
.long 0x3f7ec46d,0x3f7fec43,0x3f7d3aac,0x3f76ba07,0x3f7fb10f,0x3f7baccd,0x3f731447,0x3f660f88
.long 0x3f7b14be,0x3f710908,0x3f61c598,0x3f4d9f02,0x3f710908,0x3f604621,0x3f49d112,0x3f2e3bde
.long 0x3f61c598,0x3f49d112,0x3f2beb4a,0x3f08f59b,0x3f4d9f02,0x3f2e3bde,0x3f08f59b,0x3ebe1d4a
.long 0x3f800000,0x3f7b14be,0x3f6c835e,0x3f54db31,0x3f800000,0x3f7a7302,0x3f6a09a7,0x3f4f7a1f
.long 0x3f800000,0x3f79c79d,0x3f676bd8,0x3f49d112,0x3f800000,0x3f791298,0x3f64aa59,0x3f43e200
.long 0x3f800000,0x3f7853f8,0x3f61c598,0x3f3daef9,0x3f800000,0x3f778bc5,0x3f5ebe05,0x3f373a23
.long 0x3f800000,0x3f76ba07,0x3f5b941a,0x3f3085bb,0x3f800000,0x3f75dec6,0x3f584853,0x3f299415
.long 0x3f800000,0x3f74fa0b,0x3f54db31,0x3f226799,0x3f800000,0x3f740bdd,0x3f514d3d,0x3f1b02c6
.long 0x3f800000,0x3f731447,0x3f4d9f02,0x3f13682a,0x3f800000,0x3f721352,0x3f49d112,0x3f0b9a6b
.long 0x3f800000,0x3f710908,0x3f45e403,0x3f039c3d,0x3f800000,0x3f6ff573,0x3f41d870,0x3ef6e0cb
.long 0x3f800000,0x3f6ed89e,0x3f3daef9,0x3ee63375,0x3f800000,0x3f6db293,0x3f396842,0x3ed53641
.long 0x3f3504f3,0x3f0e39da,0x3ec3ef15,0x3e47c5c2,0x3f2beb4a,0x3f00e7e4,0x3ea09ae5,0x3de1bc2e
.long 0x3f226799,0x3ee63375,0x3e78cfcc,0x3cc90ab0,0x3f187fc0,0x3ec9b953,0x3e2f10a2,0xbd7b2b74
.long 0x3f0e39da,0x3eac7cd4,0x3dc8bd36,0xbe164083,0x3f039c3d,0x3e8e9a22,0x3cc90ab0,0xbe6c9a7f
.long 0x3ef15aea,0x3e605c13,0xbd48fb30,0xbea09ae5,0x3edae880,0x3e22abb6,0xbdfab273,0xbec9b953
.long 0x3ec3ef15,0x3dc8bd36,0xbe47c5c2,0xbef15aea,0x3eac7cd4,0x3d16c32c,0xbe888e93,0xbf0b9a6b
.long 0x3e94a031,0xbcc90ab0,0xbeac7cd4,0xbf1d7fd1,0x3e78cfcc,0xbdafb680,0xbecf7bca,0xbf2e3bde
.long 0x3e47c5c2,0xbe164083,0xbef15aea,0xbf3daef9,0x3e164083,0xbe541501,0xbf08f59b,0xbf4bbbf8
.long 0x3dc8bd36,0xbe888e93,0xbf187fc0,0xbf584853,0x3d48fb30,0xbea68f12,0xbf273656,0xbf633c5a
.long 0x248d3132,0xbe47c5c2,0xbec3ef15,0xbf0e39da,0xbdc8bd36,0xbe9aa086,0xbefc5d27,0xbf299415
.long 0xbe47c5c2,0xbecf7bca,0xbf187fc0,0xbf41d870,0xbe94a031,0xbf00e7e4,0xbf3085bb,0xbf5695e5
.long 0xbec3ef15,0xbf187fc0,0xbf45e403,0xbf676bd8,0xbef15aea,0xbf2e3bde,0xbf584853,0xbf740bdd
.long 0xbf0e39da,0xbf41d870,0xbf676bd8,0xbf7c3b28,0xbf226799,0xbf531849,0xbf731447,0xbf7fd397
.long 0xbf3504f3,0xbf61c598,0xbf7b14be,0xbf7ec46d,0xbf45e403,0xbf6db293,0xbf7f4e6d,0xbf791298
.long 0xbf54db31,0xbf76ba07,0xbf7fb10f,0xbf6ed89e,0xbf61c598,0xbf7cbfc9,0xbf7c3b28,0xbf604621
.long 0xbf6c835e,0xbf7fb10f,0xbf74fa0b,0xbf4d9f02,0xbf74fa0b,0xbf7f84ab,0xbf6a09a7,0xbf373a23
.long 0xbf7b14be,0xbf7c3b28,0xbf5b941a,0xbf1d7fd1,0xbf7ec46d,0xbf75dec6,0xbf49d112,0xbf00e7e4
.long 0xbf3504f3,0xbf54db31,0xbf6c835e,0xbf7b14be,0xbf4d9f02,0xbf68bf3c,0xbf79c79d,0xbf7ffb11
.long 0xbf61c598,0xbf76ba07,0xbf7fb10f,0xbf7c3b28,0xbf710908,0xbf7e70b0,0xbf7e1324,0xbf6ff573
.long 0xbf7b14be,0xbf7fb10f,0xbf74fa0b,0xbf5b941a,0xbf7fb10f,0xbf7a7302,0xbf64aa59,0xbf3fc767
.long 0xbf7ec46d,0xbf6ed89e,0xbf4d9f02,0xbf1d7fd1,0xbf7853f8,0xbf5d2d53,0xbf3085bb,0xbeebcbbb
.long 0xbf6c835e,0xbf45e403,0xbf0e39da,0xbe94a031,0xbf5b941a,0xbf299415,0xbecf7bca,0xbde1bc2e
.long 0xbf45e403,0xbf08f59b,0xbe78cfcc,0x3d96a905,0xbf2beb4a,0xbec9b953,0xbd96a905,0x3e827dc0
.long 0xbf0e39da,0xbe78cfcc,0x3dc8bd36,0x3edae880,0xbedae880,0xbdafb680,0x3e888e93,0x3f15f6d9
.long 0xbe94a031,0x3d96a905,0x3edae880,0x3f396842,0xbe164083,0x3e6c9a7f,0x3f13682a,0x3f5695e5
.long 0x00000000,0x3e47c5c2,0x3ec3ef15,0x3f0e39da,0x00000000,0x3e541501,0x3ecf7bca,0x3f15f6d9
.long 0x00000000,0x3e605c13,0x3edae880,0x3f1d7fd1,0x00000000,0x3e6c9a7f,0x3ee63375,0x3f24d225
.long 0x00000000,0x3e78cfcc,0x3ef15aea,0x3f2beb4a,0x00000000,0x3e827dc0,0x3efc5d27,0x3f32c8c9
.long 0x00000000,0x3e888e93,0x3f039c3d,0x3f396842,0x00000000,0x3e8e9a22,0x3f08f59b,0x3f3fc767
.long 0x00000000,0x3e94a031,0x3f0e39da,0x3f45e403,0x00000000,0x3e9aa086,0x3f13682a,0x3f4bbbf8
.long 0x00000000,0x3ea09ae5,0x3f187fc0,0x3f514d3d,0x00000000,0x3ea68f12,0x3f1d7fd1,0x3f5695e5
.long 0x00000000,0x3eac7cd4,0x3f226799,0x3f5b941a,0x00000000,0x3eb263ef,0x3f273656,0x3f604621
.long 0x00000000,0x3eb8442a,0x3f2beb4a,0x3f64aa59,0x00000000,0x3ebe1d4a,0x3f3085bb,0x3f68bf3c
.long 0x3f3504f3,0x3f54db31,0x3f6c835e,0x3f7b14be,0x3f3daef9,0x3f5d2d53,0x3f731447,0x3f7e70b0
.long 0x3f45e403,0x3f64aa59,0x3f7853f8,0x3f7fec43,0x3f4d9f02,0x3f6b4b0c,0x3f7c3b28,0x3f7f84ab
.long 0x3f54db31,0x3f710908,0x3f7ec46d,0x3f7d3aac,0x3f5b941a,0x3f75dec6,0x3f7fec43,0x3f791298
.long 0x3f61c598,0x3f79c79d,0x3f7fb10f,0x3f731447,0x3f676bd8,0x3f7cbfc9,0x3f7e1324,0x3f6b4b0c
.long 0x3f6c835e,0x3f7ec46d,0x3f7b14be,0x3f61c598,0x3f710908,0x3f7fd397,0x3f76ba07,0x3f5695e5
.long 0x3f74fa0b,0x3f7fec43,0x3f710908,0x3f49d112,0x3f7853f8,0x3f7f0e58,0x3f6a09a7,0x3f3b8f3b
.long 0x3f7b14be,0x3f7d3aac,0x3f61c598,0x3f2beb4a,0x3f7d3aac,0x3f7a7302,0x3f584853,0x3f1b02c6
.long 0x3f7ec46d,0x3f76ba07,0x3f4d9f02,0x3f08f59b,0x3f7fb10f,0x3f721352,0x3f41d870,0x3eebcbbb
.long 0x3f800000,0x3f7b14be,0x3f6c835e,0x3f54db31,0x3f7ec46d,0x3f740bdd,0x3f5ebe05,0x3f3fc767
.long 0x3f7b14be,0x3f6a09a7,0x3f4d9f02,0x3f273656,0x3f74fa0b,0x3f5d2d53,0x3f396842,0x3f0b9a6b
.long 0x3f6c835e,0x3f4d9f02,0x3f226799,0x3edae880,0x3f61c598,0x3f3b8f3b,0x3f08f59b,0x3e9aa086
.long 0x3f54db31,0x3f273656,0x3edae880,0x3e2f10a2,0x3f45e403,0x3f10d3cd,0x3ea09ae5,0x3d16c32c
.long 0x3f3504f3,0x3ef15aea,0x3e47c5c2,0xbdc8bd36,0x3f226799,0x3ebe1d4a,0x3d96a905,0xbe6c9a7f
.long 0x3f0e39da,0x3e888e93,0xbd48fb30,0xbeb8442a,0x3ef15aea,0x3e22abb6,0xbe2f10a2,0xbef6e0cb
.long 0x3ec3ef15,0x3d48fb30,0xbe94a031,0xbf187fc0,0x3e94a031,0xbd7b2b74,0xbecf7bca,0xbf32c8c9
.long 0x3e47c5c2,0xbe2f10a2,0xbf039c3d,0xbf49d112,0x3dc8bd36,0xbe8e9a22,0xbf1d7fd1,0xbf5d2d53
.long 0x3f3504f3,0x3f0e39da,0x3ec3ef15,0x3e47c5c2,0x3f187fc0,0x3ed53641,0x3e605c13,0x3c490e90
.long 0x3ef15aea,0x3e888e93,0x3d48fb30,0xbe2f10a2,0x3eac7cd4,0x3de1bc2e,0xbdfab273,0xbeb263ef
.long 0x3e47c5c2,0xbd48fb30,0xbe94a031,0xbf039c3d,0x3d48fb30,0xbe541501,0xbee63375,0xbf299415
.long 0xbdc8bd36,0xbeb8442a,0xbf187fc0,0xbf49d112,0xbe78cfcc,0xbf00e7e4,0xbf396842,0xbf633c5a
.long 0xbec3ef15,0xbf226799,0xbf54db31,0xbf74fa0b,0xbf039c3d,0xbf3fc767,0xbf6a09a7,0xbf7e70b0
.long 0xbf226799,0xbf584853,0xbf7853f8,0xbf7f4e6d,0xbf3daef9,0xbf6b4b0c,0xbf7f4e6d,0xbf778bc5
.long 0xbf54db31,0xbf7853f8,0xbf7ec46d,0xbf676bd8,0xbf676bd8,0xbf7f0e58,0xbf76ba07,0xbf4f7a1f
.long 0xbf74fa0b,0xbf7f4e6d,0xbf676bd8,0xbf3085bb,0xbf7d3aac,0xbf791298,0xbf514d3d,0xbf0b9a6b
.long 0x3f803f80,0x3f803f80,0x00000000,0x00000000,0x3f6d3f80,0x3ec43f35,0x3ec40000,0x3f6d3f35
.long 0x3f353f80,0xbf35248d,0x3f350000,0x3f353f80,0x3ec43f80,0xbf6dbf35,0x3f6d0000,0xbec43f35
.long 0x248d3f80,0xa554bf80,0x3f800000,0xbf80250d,0xbec43f80,0x3f6dbf35,0x3f6d0000,0xbec4bf35
.long 0xbf353f80,0x3f35a554,0x3f350000,0x3f35bf80,0xbf6d3f80,0xbec43f35,0x3ec40000,0x3f6dbf35
.long 0xbf803f80,0xbf803f80,0x250d0000,0x25d4a58d,0xbf6d3f80,0xbec43f35,0xbec40000,0xbf6d3f35
.long 0xbf353f80,0x3f3525b0,0xbf350000,0xbf353f80,0xbec43f80,0x3f6dbf35,0xbf6d0000,0x3ec43f35
.long 0xa5543f80,0x261fbf80,0xbf800000,0x3f8025d4,0x3ec43f80,0xbf6dbf35,0xbf6d0000,0x3ec4bf35
.long 0x3f353f80,0xbf35a5f7,0xbf350000,0xbf35bf80,0x3f6d3f80,0x3ec43f35,0xbec40000,0xbf6dbf35
.long 0x3f803f80,0x3f803f80,0x00000000,0x00000000,0xbec4248d,0xbf6dbf35,0x3f6d3f80,0x3ec43f35
.long 0xbf35bf80,0x3f35a554,0xbf35250d,0xbf35bf80,0x3f6da554,0xbec43f35,0xbec4bf80,0x3f6d3f35
.long 0x25b03f80,0xa5f7bf80,0x3f80a58d,0xbf8025d4,0xbf6d25b0,0x3ec43f35,0xbec43f80,0x3f6dbf35
.long 0x3f35bf80,0xbf35261f,0xbf3525d4,0xbf353f80,0x3ec4a5f7,0x3f6dbf35,0x3f6dbf80,0x3ec4bf35
.long 0xbf803f80,0xbf803f80,0x2630a60d,0x2677a654,0x3ec4261f,0x3f6dbf35,0xbf6d3f80,0xbec43f35
.long 0x3f35bf80,0xbf35a742,0x3f352630,0x3f35bf80,0xbf6da731,0x3ec43f35,0x3ec4bf80,0xbf6d3f35
.long 0xa7423f80,0xa60dbf80,0xbf80a654,0x3f80269f,0x3f6da68d,0xbec43f35,0x3ec43f80,0xbf6dbf35
.long 0xbf35bf80,0x3f35a60d,0x3f352677,0x3f353f80,0xbec4a742,0xbf6dbf35,0xbf6dbf80,0xbec4bf35
.long 0x3f803f80,0x3f803f80,0x00000000,0x00000000,0xbf6dbf80,0xbec4bf35,0xbec4250d,0xbf6dbf35
.long 0x3f353f80,0xbf3525b0,0x3f35a58d,0x3f353f80,0xbec4bf80,0x3f6d3f35,0xbf6d25d4,0x3ec4bf35
.long 0x261f3f80,0xa731bf80,0x3f80a60d,0xbf802630,0x3ec4bf80,0xbf6d3f35,0xbf6d2630,0x3ec43f35
.long 0xbf353f80,0x3f35a742,0x3f35a654,0x3f35bf80,0x3f6dbf80,0x3ec4bf35,0xbec42677,0xbf6d3f35
.long 0xbf803f80,0xbf803f80,0x269fa68d,0x27b1a6b0,0x3f6dbf80,0x3ec4bf35,0x3ec4269f,0x3f6dbf35
.long 0xbf353f80,0x3f35a58e,0xbf35a6b0,0xbf353f80,0x3ec4bf80,0xbf6d3f35,0x3f6d27b1,0xbec4bf35
.long 0xa7773f80,0x258dbf80,0xbf80a6d4,0x3f8027c2,0xbec4bf80,0x3f6d3f35,0x3f6da70d,0xbec43f35
.long 0x3f353f80,0xbf35a78d,0xbf35a6f7,0xbf35bf80,0xbf6dbf80,0xbec4bf35,0x3ec427c2,0x3f6d3f35
.long 0x3f803f80,0x3f803f80,0x00000000,0x00000000,0x3ec4a554,0x3f6d3f35,0xbf6dbf80,0xbec4bf35
.long 0xbf35bf80,0x3f35a5f7,0xbf3525d4,0xbf35bf80,0xbf6d261f,0x3ec4bf35,0x3ec43f80,0xbf6dbf35
.long 0xa68d3f80,0xa742bf80,0x3f80a654,0xbf802677,0x3f6da742,0xbec4bf35,0x3ec4bf80,0xbf6d3f35
.long 0x3f35bf80,0xbf35a60d,0xbf35269f,0xbf353f80,0xbec4a60d,0xbf6d3f35,0xbf6d3f80,0xbec43f35
.long 0xbf803f80,0xbf803f80,0xa70da6d4,0x27c2a6f7,0xbec4a777,0xbf6d3f35,0x3f6dbf80,0x3ec4bf35
.long 0x3f35bf80,0xbf35a78d,0x3f3527c2,0x3f35bf80,0x3f6d258d,0xbec4bf35,0xbec43f80,0x3f6dbf35
.long 0xa7963f80,0x268dbf80,0xbf80a71f,0x3f80a68d,0xbf6da796,0x3ec4bf35,0xbec4bf80,0x3f6d3f35
.long 0xbf35bf80,0x3f352816,0x3f35a68d,0x3f353f80,0x3ec4268d,0x3f6d3f35,0x3f6d3f80,0x3ec43f35
.long 0x80008000,0x80008000,0x3f803f80,0x3f803f80,0xbec48000,0xbf6dbf35,0x3f6d3f80,0x3ec43f35
.long 0xbf358000,0xbf35bf80,0x3f353f80,0xbf35248d,0xbf6d8000,0x3ec4bf35,0x3ec43f80,0xbf6dbf35
.long 0xbf808000,0x3f80a50d,0x248d3f80,0xa554bf80,0xbf6d8000,0x3ec43f35,0xbec43f80,0x3f6dbf35
.long 0xbf358000,0xbf353f80,0xbf353f80,0x3f35a554,0xbec48000,0xbf6d3f35,0xbf6d3f80,0xbec43f35
.long 0xa50d8000,0xa5d4258d,0xbf803f80,0xbf803f80,0x3ec48000,0x3f6dbf35,0xbf6d3f80,0xbec43f35
.long 0x3f358000,0x3f35bf80,0xbf353f80,0x3f3525b0,0x3f6d8000,0xbec4bf35,0xbec43f80,0x3f6dbf35
.long 0x3f808000,0xbf80a5d4,0xa5543f80,0x261fbf80,0x3f6d8000,0xbec43f35,0x3ec43f80,0xbf6dbf35
.long 0x3f358000,0x3f353f80,0x3f353f80,0xbf35a5f7,0x3ec48000,0x3f6d3f35,0x3f6d3f80,0x3ec43f35
.long 0x80008000,0x80008000,0x3f803f80,0x3f803f80,0xbf6dbf80,0xbec4bf35,0xbec4248d,0xbf6dbf35
.long 0x3f35a50d,0x3f353f80,0xbf35bf80,0x3f35a554,0x3ec43f80,0xbf6dbf35,0x3f6da554,0xbec43f35
.long 0xbf80258d,0x3f80a5d4,0x25b03f80,0xa5f7bf80,0x3ec4bf80,0xbf6d3f35,0xbf6d25b0,0x3ec43f35
.long 0x3f35a5d4,0x3f35bf80,0x3f35bf80,0xbf35261f,0xbf6d3f80,0xbec43f35,0x3ec4a5f7,0x3f6dbf35
.long 0xa630260d,0xa6772654,0xbf803f80,0xbf803f80,0x3f6dbf80,0x3ec4bf35,0x3ec4261f,0x3f6dbf35
.long 0xbf35a630,0xbf353f80,0x3f35bf80,0xbf35a742,0xbec43f80,0x3f6dbf35,0xbf6da731,0x3ec43f35
.long 0x3f802654,0xbf80a69f,0xa7423f80,0xa60dbf80,0xbec4bf80,0x3f6d3f35,0x3f6da68d,0xbec43f35
.long 0xbf35a677,0xbf35bf80,0xbf35bf80,0x3f35a60d,0x3f6d3f80,0x3ec43f35,0xbec4a742,0xbf6dbf35
.long 0x80008000,0x80008000,0x3f803f80,0x3f803f80,0x3ec4a50d,0x3f6d3f35,0xbf6dbf80,0xbec4bf35
.long 0xbf35258d,0xbf35bf80,0x3f353f80,0xbf3525b0,0x3f6da5d4,0xbec43f35,0xbec4bf80,0x3f6d3f35
.long 0xbf80260d,0x3f80a630,0x261f3f80,0xa731bf80,0x3f6da630,0xbec4bf35,0x3ec4bf80,0xbf6d3f35
.long 0xbf352654,0xbf353f80,0xbf353f80,0x3f35a742,0x3ec4a677,0x3f6dbf35,0x3f6dbf80,0x3ec4bf35
.long 0xa69f268d,0xa7b126b0,0xbf803f80,0xbf803f80,0xbec4a69f,0xbf6d3f35,0x3f6dbf80,0x3ec4bf35
.long 0x3f3526b0,0x3f35bf80,0xbf353f80,0x3f35a58e,0xbf6da7b1,0x3ec43f35,0x3ec4bf80,0xbf6d3f35
.long 0x3f8026d4,0xbf80a7c2,0xa7773f80,0x258dbf80,0xbf6d270d,0x3ec4bf35,0xbec4bf80,0x3f6d3f35
.long 0x3f3526f7,0x3f353f80,0x3f353f80,0xbf35a78d,0xbec4a7c2,0xbf6dbf35,0xbf6dbf80,0xbec4bf35
.long 0x80008000,0x80008000,0x3f803f80,0x3f803f80,0x3f6d3f80,0x3ec43f35,0x3ec4a554,0x3f6d3f35
.long 0x3f35a5d4,0x3f353f80,0xbf35bf80,0x3f35a5f7,0xbec4bf80,0x3f6d3f35,0xbf6d261f,0x3ec4bf35
.long 0xbf802654,0x3f80a677,0xa68d3f80,0xa742bf80,0xbec43f80,0x3f6dbf35,0x3f6da742,0xbec4bf35
.long 0x3f35a69f,0x3f35bf80,0x3f35bf80,0xbf35a60d,0x3f6dbf80,0x3ec4bf35,0xbec4a60d,0xbf6d3f35
.long 0x270d26d4,0xa7c226f7,0xbf803f80,0xbf803f80,0xbf6d3f80,0xbec43f35,0xbec4a777,0xbf6d3f35
.long 0xbf35a7c2,0xbf353f80,0x3f35bf80,0xbf35a78d,0x3ec4bf80,0xbf6d3f35,0x3f6d258d,0xbec4bf35
.long 0x3f80271f,0xbf80268d,0xa7963f80,0x268dbf80,0x3ec43f80,0xbf6dbf35,0xbf6da796,0x3ec4bf35
.long 0xbf35268d,0xbf35bf80,0xbf35bf80,0x3f352816,0xbf6dbf80,0xbec4bf35,0x3ec4268d,0x3f6d3f35
.long 0x3f800000,0x3f800000,0x3f800000,0x3f800000,0x3f7b14be,0x3f7a7302,0x3f79c79d,0x3f791298
.long 0x3f6c835e,0x3f6a09a7,0x3f676bd8,0x3f64aa59,0x3f54db31,0x3f4f7a1f,0x3f49d112,0x3f43e200
.long 0x3f3504f3,0x3f2beb4a,0x3f226799,0x3f187fc0,0x3f0e39da,0x3f00e7e4,0x3ee63375,0x3ec9b953
.long 0x3ec3ef15,0x3ea09ae5,0x3e78cfcc,0x3e2f10a2,0x3e47c5c2,0x3de1bc2e,0x3cc90ab0,0xbd7b2b74
.long 0x248d3132,0xbdc8bd36,0xbe47c5c2,0xbe94a031,0xbe47c5c2,0xbe9aa086,0xbecf7bca,0xbf00e7e4
.long 0xbec3ef15,0xbefc5d27,0xbf187fc0,0xbf3085bb,0xbf0e39da,0xbf299415,0xbf41d870,0xbf5695e5
.long 0xbf3504f3,0xbf4d9f02,0xbf61c598,0xbf710908,0xbf54db31,0xbf68bf3c,0xbf76ba07,0xbf7e70b0
.long 0xbf6c835e,0xbf79c79d,0xbf7fb10f,0xbf7e1324,0xbf7b14be,0xbf7ffb11,0xbf7c3b28,0xbf6ff573
.long 0x3f800000,0x3f800000,0x3f800000,0x3f800000,0x3f7853f8,0x3f778bc5,0x3f76ba07,0x3f75dec6
.long 0x3f61c598,0x3f5ebe05,0x3f5b941a,0x3f584853,0x3f3daef9,0x3f373a23,0x3f3085bb,0x3f299415
.long 0x3f0e39da,0x3f039c3d,0x3ef15aea,0x3edae880,0x3eac7cd4,0x3e8e9a22,0x3e605c13,0x3e22abb6
.long 0x3dc8bd36,0x3cc90ab0,0xbd48fb30,0xbdfab273,0xbe164083,0xbe6c9a7f,0xbea09ae5,0xbec9b953
.long 0xbec3ef15,0xbef15aea,0xbf0e39da,0xbf226799,0xbf187fc0,0xbf2e3bde,0xbf41d870,0xbf531849
.long 0xbf45e403,0xbf584853,0xbf676bd8,0xbf731447,0xbf676bd8,0xbf740bdd,0xbf7c3b28,0xbf7fd397
.long 0xbf7b14be,0xbf7fb10f,0xbf7ec46d,0xbf7853f8,0xbf7fb10f,0xbf7a7302,0xbf6ed89e,0xbf5d2d53
.long 0xbf74fa0b,0xbf64aa59,0xbf4d9f02,0xbf3085bb,0xbf5b941a,0xbf3fc767,0xbf1d7fd1,0xbeebcbbb
.long 0x3f800000,0x3f800000,0x3f800000,0x3f800000,0x3f74fa0b,0x3f740bdd,0x3f731447,0x3f721352
.long 0x3f54db31,0x3f514d3d,0x3f4d9f02,0x3f49d112,0x3f226799,0x3f1b02c6,0x3f13682a,0x3f0b9a6b
.long 0x3ec3ef15,0x3eac7cd4,0x3e94a031,0x3e78cfcc,0x3dc8bd36,0x3d16c32c,0xbcc90ab0,0xbdafb680
.long 0xbe47c5c2,0xbe888e93,0xbeac7cd4,0xbecf7bca,0xbef15aea,0xbf0b9a6b,0xbf1d7fd1,0xbf2e3bde
.long 0xbf3504f3,0xbf45e403,0xbf54db31,0xbf61c598,0xbf61c598,0xbf6db293,0xbf76ba07,0xbf7cbfc9
.long 0xbf7b14be,0xbf7f4e6d,0xbf7fb10f,0xbf7c3b28,0xbf7ec46d,0xbf791298,0xbf6ed89e,0xbf604621
.long 0xbf6c835e,0xbf5b941a,0xbf45e403,0xbf2beb4a,0xbf45e403,0xbf299415,0xbf08f59b,0xbec9b953
.long 0xbf0e39da,0xbecf7bca,0xbe78cfcc,0xbd96a905,0xbe94a031,0xbde1bc2e,0x3d96a905,0x3e827dc0
.long 0x3f800000,0x3f800000,0x3f800000,0x3f800000,0x3f710908,0x3f6ff573,0x3f6ed89e,0x3f6db293
.long 0x3f45e403,0x3f41d870,0x3f3daef9,0x3f396842,0x3f039c3d,0x3ef6e0cb,0x3ee63375,0x3ed53641
.long 0x3e47c5c2,0x3e164083,0x3dc8bd36,0x3d48fb30,0xbe164083,0xbe541501,0xbe888e93,0xbea68f12
.long 0xbef15aea,0xbf08f59b,0xbf187fc0,0xbf273656,0xbf3daef9,0xbf4bbbf8,0xbf584853,0xbf633c5a
.long 0xbf6c835e,0xbf74fa0b,0xbf7b14be,0xbf7ec46d,0xbf7fb10f,0xbf7f84ab,0xbf7c3b28,0xbf75dec6
.long 0xbf74fa0b,0xbf6a09a7,0xbf5b941a,0xbf49d112,0xbf4d9f02,0xbf373a23,0xbf1d7fd1,0xbf00e7e4
.long 0xbf0e39da,0xbedae880,0xbe94a031,0xbe164083,0xbe78cfcc,0xbdafb680,0x3d96a905,0x3e6c9a7f
.long 0x3dc8bd36,0x3e888e93,0x3edae880,0x3f13682a,0x3edae880,0x3f15f6d9,0x3f396842,0x3f5695e5
.long 0x00000000,0x00000000,0x00000000,0x00000000,0x3e47c5c2,0x3e541501,0x3e605c13,0x3e6c9a7f
.long 0x3ec3ef15,0x3ecf7bca,0x3edae880,0x3ee63375,0x3f0e39da,0x3f15f6d9,0x3f1d7fd1,0x3f24d225
.long 0x3f3504f3,0x3f3daef9,0x3f45e403,0x3f4d9f02,0x3f54db31,0x3f5d2d53,0x3f64aa59,0x3f6b4b0c
.long 0x3f6c835e,0x3f731447,0x3f7853f8,0x3f7c3b28,0x3f7b14be,0x3f7e70b0,0x3f7fec43,0x3f7f84ab
.long 0x3f800000,0x3f7ec46d,0x3f7b14be,0x3f74fa0b,0x3f7b14be,0x3f740bdd,0x3f6a09a7,0x3f5d2d53
.long 0x3f6c835e,0x3f5ebe05,0x3f4d9f02,0x3f396842,0x3f54db31,0x3f3fc767,0x3f273656,0x3f0b9a6b
.long 0x3f3504f3,0x3f187fc0,0x3ef15aea,0x3eac7cd4,0x3f0e39da,0x3ed53641,0x3e888e93,0x3de1bc2e
.long 0x3ec3ef15,0x3e605c13,0x3d48fb30,0xbdfab273,0x3e47c5c2,0x3c490e90,0xbe2f10a2,0xbeb263ef
.long 0x00000000,0x00000000,0x00000000,0x00000000,0x3e78cfcc,0x3e827dc0,0x3e888e93,0x3e8e9a22
.long 0x3ef15aea,0x3efc5d27,0x3f039c3d,0x3f08f59b,0x3f2beb4a,0x3f32c8c9,0x3f396842,0x3f3fc767
.long 0x3f54db31,0x3f5b941a,0x3f61c598,0x3f676bd8,0x3f710908,0x3f75dec6,0x3f79c79d,0x3f7cbfc9
.long 0x3f7ec46d,0x3f7fec43,0x3f7fb10f,0x3f7e1324,0x3f7d3aac,0x3f791298,0x3f731447,0x3f6b4b0c
.long 0x3f6c835e,0x3f61c598,0x3f54db31,0x3f45e403,0x3f4d9f02,0x3f3b8f3b,0x3f273656,0x3f10d3cd
.long 0x3f226799,0x3f08f59b,0x3edae880,0x3ea09ae5,0x3edae880,0x3e9aa086,0x3e2f10a2,0x3d16c32c
.long 0x3e47c5c2,0x3d48fb30,0xbdc8bd36,0xbe78cfcc,0xbd48fb30,0xbe541501,0xbeb8442a,0xbf00e7e4
.long 0xbe94a031,0xbee63375,0xbf187fc0,0xbf396842,0xbf039c3d,0xbf299415,0xbf49d112,0xbf633c5a
.long 0x00000000,0x00000000,0x00000000,0x00000000,0x3e94a031,0x3e9aa086,0x3ea09ae5,0x3ea68f12
.long 0x3f0e39da,0x3f13682a,0x3f187fc0,0x3f1d7fd1,0x3f45e403,0x3f4bbbf8,0x3f514d3d,0x3f5695e5
.long 0x3f6c835e,0x3f710908,0x3f74fa0b,0x3f7853f8,0x3f7ec46d,0x3f7fd397,0x3f7fec43,0x3f7f0e58
.long 0x3f7b14be,0x3f76ba07,0x3f710908,0x3f6a09a7,0x3f61c598,0x3f5695e5,0x3f49d112,0x3f3b8f3b
.long 0x3f3504f3,0x3f226799,0x3f0e39da,0x3ef15aea,0x3ef15aea,0x3ebe1d4a,0x3e888e93,0x3e22abb6
.long 0x3e47c5c2,0x3d96a905,0xbd48fb30,0xbe2f10a2,0xbdc8bd36,0xbe6c9a7f,0xbeb8442a,0xbef6e0cb
.long 0xbec3ef15,0xbf039c3d,0xbf226799,0xbf3daef9,0xbf226799,0xbf3fc767,0xbf584853,0xbf6b4b0c
.long 0xbf54db31,0xbf6a09a7,0xbf7853f8,0xbf7f4e6d,0xbf74fa0b,0xbf7e70b0,0xbf7f4e6d,0xbf778bc5
.long 0x00000000,0x00000000,0x00000000,0x00000000,0x3eac7cd4,0x3eb263ef,0x3eb8442a,0x3ebe1d4a
.long 0x3f226799,0x3f273656,0x3f2beb4a,0x3f3085bb,0x3f5b941a,0x3f604621,0x3f64aa59,0x3f68bf3c
.long 0x3f7b14be,0x3f7d3aac,0x3f7ec46d,0x3f7fb10f,0x3f7d3aac,0x3f7a7302,0x3f76ba07,0x3f721352
.long 0x3f61c598,0x3f584853,0x3f4d9f02,0x3f41d870,0x3f2beb4a,0x3f1b02c6,0x3f08f59b,0x3eebcbbb
.long 0x3ec3ef15,0x3e94a031,0x3e47c5c2,0x3dc8bd36,0x3d48fb30,0xbd7b2b74,0xbe2f10a2,0xbe8e9a22
.long 0xbe94a031,0xbecf7bca,0xbf039c3d,0xbf1d7fd1,0xbf187fc0,0xbf32c8c9,0xbf49d112,0xbf5d2d53
.long 0xbf54db31,0xbf676bd8,0xbf74fa0b,0xbf7d3aac,0xbf7853f8,0xbf7f0e58,0xbf7f4e6d,0xbf791298
.long 0xbf7ec46d,0xbf76ba07,0xbf676bd8,0xbf514d3d,0xbf676bd8,0xbf4f7a1f,0xbf3085bb,0xbf0b9a6b
.long 0x80003580,0x80003580,0x80003580,0x80003580,0x80003580,0xb4c4356d,0xb5353535,0xb56d34c4
.long 0x80003580,0xb5353535,0xb5801a8d,0xb535b535,0x80003580,0xb56d34c4,0xb535b535,0x34c4b56d
.long 0x80003580,0xb5801a8d,0x9b0db580,0x35809b54,0x80003580,0xb56db4c4,0x3535b535,0x34c4356d
.long 0x80003580,0xb535b535,0x35809b54,0xb5353535,0x80003580,0xb4c4b56d,0x35353535,0xb56db4c4
.long 0x80003580,0x9b0db580,0x1b8d3580,0x9bd4b580,0x80003580,0x34c4b56d,0xb5353535,0x356db4c4
.long 0x80003580,0x3535b535,0xb5801bb0,0x35353535,0x80003580,0x356db4c4,0xb535b535,0xb4c4356d
.long 0x80003580,0x35809b54,0x9bd4b580,0xb5801c1f,0x80003580,0x356d34c4,0x3535b535,0xb4c4b56d
.long 0x80003580,0x35353535,0x35809bf7,0x3535b535,0x80003580,0x34c4356d,0x35353535,0x356d34c4
.long 0x80003580,0x80003580,0x80003580,0x80003580,0xb5801a8d,0xb56db4c4,0xb535b535,0xb4c4b56d
.long 0x9b0db580,0x3535b535,0x35809b54,0x35353535,0x35809b54,0x34c4356d,0xb5353535,0xb56db4c4
.long 0x1b8d3580,0xb5801bb0,0x9bd4b580,0x35809bf7,0xb5801bb0,0x34c4b56d,0x35353535,0xb56d34c4
.long 0x9bd4b580,0x35353535,0xb5801c1f,0x3535b535,0x35809bf7,0xb56d34c4,0x3535b535,0xb4c4356d
.long 0x1c0d3580,0x9c30b580,0x1c543580,0x9c77b580,0xb5801c1f,0x356d34c4,0xb535b535,0x34c4356d
.long 0x9c30b580,0xb5353535,0x35809d42,0xb535b535,0x35809d31,0xb4c4b56d,0xb5353535,0x356d34c4
.long 0x1c543580,0x35809d42,0x9c9fb580,0xb5809c0d,0xb5809c8d,0xb4c4356d,0x35353535,0x356db4c4
.long 0x9c77b580,0xb535b535,0xb5809c0d,0xb5353535,0x35809d42,0x356db4c4,0x3535b535,0x34c4b56d
.long 0x80003580,0x80003580,0x80003580,0x80003580,0x9b0db580,0x34c4b56d,0x3535b535,0x356db4c4
.long 0x1b8d3580,0xb5353535,0xb5801bb0,0xb535b535,0x9bd4b580,0x356db4c4,0x35353535,0xb4c4356d
.long 0x1c0d3580,0xb5801c1f,0x9c30b580,0x35809d31,0x9c30b580,0x356d34c4,0xb5353535,0xb4c4b56d
.long 0x1c543580,0xb535b535,0x35809d42,0xb5353535,0x9c77b580,0x34c4356d,0xb535b535,0x356d34c4
.long 0x1c8d3580,0x9c9fb580,0x1cb03580,0x9db1b580,0x9c9fb580,0xb4c4356d,0x3535b535,0xb56d34c4
.long 0x1cb03580,0x3535b535,0xb5809b8e,0x35353535,0x9db1b580,0xb56d34c4,0x35353535,0x34c4b56d
.long 0x1cd43580,0x35809d77,0x9dc2b580,0xb5801b8d,0x1d0db580,0xb56db4c4,0xb5353535,0x34c4356d
.long 0x1cf73580,0x35353535,0x35809d8d,0x3535b535,0x9dc2b580,0xb4c4b56d,0xb535b535,0xb56db4c4
.long 0x80003580,0x80003580,0x80003580,0x80003580,0x35809b54,0x356d34c4,0x35353535,0x34c4356d
.long 0x9bd4b580,0x3535b535,0x35809bf7,0x35353535,0xb5801c1f,0xb4c4b56d,0x3535b535,0x356d34c4
.long 0x1c543580,0xb5809c8d,0x9c77b580,0x35809d42,0x35809d42,0xb4c4356d,0xb535b535,0x356db4c4
.long 0x9c9fb580,0x35353535,0xb5809c0d,0x3535b535,0xb5809c0d,0x356db4c4,0xb5353535,0x34c4b56d
.long 0x1cd43580,0x1d0db580,0x1cf73580,0x9dc2b580,0x35809d77,0xb56db4c4,0x35353535,0xb4c4b56d
.long 0x9dc2b580,0xb5353535,0x35809d8d,0xb535b535,0xb5801b8d,0x34c4356d,0x3535b535,0xb56db4c4
.long 0x1d1f3580,0x35809d96,0x1c8db580,0xb5801c8d,0x35809d96,0x34c4b56d,0xb535b535,0xb56d34c4
.long 0x1c8db580,0xb535b535,0xb5801e16,0xb5353535,0xb5801c8d,0xb56d34c4,0xb5353535,0xb4c4356d
.long 0x35800000,0x35800000,0x35800000,0x35800000,0x35800000,0x356d34c4,0x35353535,0x34c4356d
.long 0x35800000,0x35353535,0x1a8d3580,0xb5353535,0x35800000,0x34c4356d,0xb5353535,0xb56db4c4
.long 0x35800000,0x1a8d3580,0xb5801b0d,0x9b54b580,0x35800000,0xb4c4356d,0xb535b535,0x356db4c4
.long 0x35800000,0xb5353535,0x9b54b580,0x35353535,0x35800000,0xb56d34c4,0x3535b535,0xb4c4356d
.long 0x35800000,0xb5801b0d,0x35809b8d,0xb5801bd4,0x35800000,0xb56db4c4,0x35353535,0xb4c4b56d
.long 0x35800000,0xb535b535,0x1bb03580,0x3535b535,0x35800000,0xb4c4b56d,0xb5353535,0x356d34c4
.long 0x35800000,0x9b54b580,0xb5801bd4,0x1c1f3580,0x35800000,0x34c4b56d,0xb535b535,0xb56d34c4
.long 0x35800000,0x3535b535,0x9bf7b580,0xb535b535,0x35800000,0x356db4c4,0x3535b535,0x34c4b56d
.long 0x35800000,0x35800000,0x35800000,0x35800000,0x1a8d3580,0xb4c4356d,0xb5353535,0xb56d34c4
.long 0xb5801b0d,0xb535b535,0x9b54b580,0x3535b535,0x9b54b580,0x356db4c4,0x35353535,0xb4c4356d
.long 0x35809b8d,0x1bb03580,0xb5801bd4,0x9bf7b580,0x1bb03580,0xb56db4c4,0x3535b535,0x34c4356d
.long 0xb5801bd4,0x3535b535,0x1c1f3580,0xb535b535,0x9bf7b580,0x34c4356d,0xb535b535,0x356d34c4
.long 0x35809c0d,0xb5801c30,0x35809c54,0xb5801c77,0x1c1f3580,0x34c4b56d,0xb5353535,0x356db4c4
.long 0xb5801c30,0x35353535,0x9d42b580,0xb5353535,0x9d31b580,0xb56d34c4,0x35353535,0x34c4b56d
.long 0x35809c54,0x9d42b580,0xb5801c9f,0x9c0d3580,0x9c8d3580,0x356d34c4,0x3535b535,0xb4c4b56d
.long 0xb5801c77,0xb5353535,0x9c0d3580,0x35353535,0x9d42b580,0xb4c4b56d,0xb535b535,0xb56db4c4
.long 0x35800000,0x35800000,0x35800000,0x35800000,0xb5801b0d,0xb56db4c4,0xb535b535,0xb4c4b56d
.long 0x35809b8d,0x35353535,0x1bb03580,0xb5353535,0xb5801bd4,0xb4c4b56d,0x3535b535,0x356d34c4
.long 0x35809c0d,0x1c1f3580,0xb5801c30,0x9d31b580,0xb5801c30,0x34c4b56d,0x35353535,0xb56d34c4
.long 0x35809c54,0xb5353535,0x9d42b580,0x35353535,0xb5801c77,0x356db4c4,0xb5353535,0x34c4b56d
.long 0x35809c8d,0xb5801c9f,0x35809cb0,0xb5801db1,0xb5801c9f,0x356d34c4,0xb535b535,0x34c4356d
.long 0x35809cb0,0xb535b535,0x9b8e3580,0x3535b535,0xb5801db1,0x34c4356d,0x3535b535,0xb56db4c4
.long 0x35809cd4,0x9d77b580,0xb5801dc2,0x1b8d3580,0xb5809d0d,0xb4c4356d,0x35353535,0x356db4c4
.long 0x35809cf7,0x3535b535,0x9d8db580,0xb535b535,0xb5801dc2,0xb56d34c4,0xb5353535,0xb4c4356d
.long 0x35800000,0x35800000,0x35800000,0x35800000,0x9b54b580,0x34c4b56d,0x3535b535,0x356db4c4
.long 0xb5801bd4,0xb535b535,0x9bf7b580,0x3535b535,0x1c1f3580,0xb56d34c4,0xb535b535,0x34c4b56d
.long 0x35809c54,0x9c8d3580,0xb5801c77,0x9d42b580,0x9d42b580,0x356d34c4,0xb5353535,0xb4c4b56d
.long 0xb5801c9f,0x3535b535,0x9c0d3580,0xb535b535,0x9c0d3580,0xb4c4b56d,0x35353535,0xb56db4c4
.long 0x35809cd4,0xb5809d0d,0x35809cf7,0xb5801dc2,0x9d77b580,0xb4c4356d,0x3535b535,0xb56d34c4
.long 0xb5801dc2,0x35353535,0x9d8db580,0xb5353535,0x1b8d3580,0x356db4c4,0xb535b535,0xb4c4356d
.long 0x35809d1f,0x9d96b580,0xb5809c8d,0x1c8d3580,0x9d96b580,0xb56db4c4,0xb5353535,0x34c4356d
.long 0xb5809c8d,0xb5353535,0x1e163580,0x35353535,0x1c8d3580,0x34c4356d,0x35353535,0x356d34c4
.long 0x00003f80,0x00003f80,0x00003f80,0x00003f80,0x00003f80,0x3e483f7b,0x3ec43f6d,0x3f0e3f55
.long 0x00003f80,0x3ec43f6d,0x3f353f35,0x3f6d3ec4,0x00003f80,0x3f0e3f55,0x3f6d3ec4,0x3f7bbe48
.long 0x00003f80,0x3f353f35,0x3f80248d,0x3f35bf35,0x00003f80,0x3f553f0e,0x3f6dbec4,0x3e48bf7b
.long 0x00003f80,0x3f6d3ec4,0x3f35bf35,0xbec4bf6d,0x00003f80,0x3f7b3e48,0x3ec4bf6d,0xbf55bf0e
.long 0x00003f80,0x3f80248d,0x250dbf80,0xbf80a554,0x00003f80,0x3f7bbe48,0xbec4bf6d,0xbf553f0e
.long 0x00003f80,0x3f6dbec4,0xbf35bf35,0xbec43f6d,0x00003f80,0x3f55bf0e,0xbf6dbec4,0x3e483f7b
.long 0x00003f80,0x3f35bf35,0xbf80a554,0x3f353f35,0x00003f80,0x3f0ebf55,0xbf6d3ec4,0x3f7b3e48
.long 0x00003f80,0x3ec4bf6d,0xbf353f35,0x3f6dbec4,0x00003f80,0x3e48bf7b,0xbec43f6d,0x3f0ebf55
.long 0x00003f80,0x00003f80,0x00003f80,0x00003f80,0x3f353f35,0x3f553f0e,0x3f6d3ec4,0x3f7b3e48
.long 0x3f80248d,0x3f6dbec4,0x3f35bf35,0x3ec4bf6d,0x3f35bf35,0x3e48bf7b,0xbec4bf6d,0xbf55bf0e
.long 0x250dbf80,0xbf35bf35,0xbf80a554,0xbf353f35,0xbf35bf35,0xbf7b3e48,0xbec43f6d,0x3f0e3f55
.long 0xbf80a554,0xbec43f6d,0x3f353f35,0x3f6dbec4,0xbf353f35,0x3f0e3f55,0x3f6dbec4,0xbe48bf7b
.long 0xa58d3f80,0x3f8025b0,0x25d4bf80,0xbf80a5f7,0x3f353f35,0x3f0ebf55,0xbf6dbec4,0xbe483f7b
.long 0x3f8025b0,0xbec4bf6d,0xbf353f35,0x3f6d3ec4,0x3f35bf35,0xbf7bbe48,0x3ec43f6d,0x3f0ebf55
.long 0x25d4bf80,0xbf353f35,0x3f80261f,0xbf35bf35,0xbf35bf35,0x3e483f7b,0x3ec4bf6d,0xbf553f0e
.long 0xbf80a5f7,0x3f6d3ec4,0xbf35bf35,0x3ec43f6d,0xbf353f35,0x3f55bf0e,0xbf6d3ec4,0x3f7bbe48
.long 0x00003f80,0x00003f80,0x00003f80,0x00003f80,0x3f80248d,0x3f7bbe48,0x3f6dbec4,0x3f55bf0e
.long 0x250dbf80,0xbec4bf6d,0xbf35bf35,0xbf6dbec4,0xbf80a554,0xbf553f0e,0xbec43f6d,0x3e483f7b
.long 0xa58d3f80,0x3f353f35,0x3f8025b0,0x3f35bf35,0x3f8025b0,0x3f0ebf55,0xbec4bf6d,0xbf7bbe48
.long 0x25d4bf80,0xbf6dbec4,0xbf353f35,0x3ec43f6d,0xbf80a5f7,0xbe483f7b,0x3f6d3ec4,0x3f0ebf55
.long 0xa60d3f80,0x3f80261f,0x2630bf80,0xbf80a731,0x3f80261f,0xbe48bf7b,0xbf6d3ec4,0x3f0e3f55
.long 0x2630bf80,0xbf6d3ec4,0x3f353f35,0x3ec4bf6d,0xbf80a731,0x3f0e3f55,0x3ec4bf6d,0xbf7b3e48
.long 0xa6543f80,0x3f35bf35,0xbf80a742,0x3f353f35,0x3f80a68d,0xbf55bf0e,0x3ec43f6d,0x3e48bf7b
.long 0x2677bf80,0xbec43f6d,0x3f35bf35,0xbf6d3ec4,0xbf80a742,0x3f7b3e48,0xbf6dbec4,0x3f553f0e
.long 0x00003f80,0x00003f80,0x00003f80,0x00003f80,0x3f35bf35,0x3f0ebf55,0x3ec4bf6d,0x3e48bf7b
.long 0xbf80a554,0xbf6d3ec4,0xbf353f35,0xbec43f6d,0x3f353f35,0x3f7b3e48,0x3f6dbec4,0x3f0ebf55
.long 0x25d4bf80,0xbf35bf35,0xbf80a5f7,0xbf353f35,0xbf353f35,0x3e483f7b,0x3f6d3ec4,0x3f55bf0e
.long 0x3f80261f,0x3ec4bf6d,0xbf35bf35,0xbf6d3ec4,0xbf35bf35,0xbf553f0e,0x3ec43f6d,0x3f7bbe48
.long 0xa6543f80,0x3f80a68d,0x2677bf80,0xbf80a742,0x3f35bf35,0xbf55bf0e,0xbec43f6d,0x3f7b3e48
.long 0xbf80a742,0x3ec43f6d,0x3f35bf35,0xbf6dbec4,0x3f353f35,0x3e48bf7b,0xbf6d3ec4,0x3f553f0e
.long 0x269fbf80,0xbf353f35,0x3f80a60d,0xbf35bf35,0xbf353f35,0x3f7bbe48,0xbf6dbec4,0x3f0e3f55
.long 0x3f80a60d,0xbf6dbec4,0x3f353f35,0xbec4bf6d,0xbf35bf35,0x3f0e3f55,0xbec4bf6d,0x3e483f7b
.long 0x00003f80,0x00003f80,0x00003f80,0x00003f80,0x250dbf80,0xbe48bf7b,0xbec4bf6d,0xbf0ebf55
.long 0xa58d3f80,0x3ec43f6d,0x3f353f35,0x3f6d3ec4,0x25d4bf80,0xbf0ebf55,0xbf6dbec4,0xbf7b3e48
.long 0xa60d3f80,0x3f353f35,0x3f80261f,0x3f35bf35,0x2630bf80,0xbf55bf0e,0xbf6d3ec4,0xbe483f7b
.long 0xa6543f80,0x3f6d3ec4,0x3f35bf35,0xbec4bf6d,0x2677bf80,0xbf7bbe48,0xbec43f6d,0x3f553f0e
.long 0xa68d3f80,0x3f80a654,0x269fbf80,0xbf80a754,0x269fbf80,0xbf7b3e48,0x3ec43f6d,0x3f55bf0e
.long 0xa6b03f80,0x3f6dbec4,0xbf35bf35,0xbec43f6d,0x27b1bf80,0xbf553f0e,0x3f6d3ec4,0xbe48bf7b
.long 0xa6d43f80,0x3f35bf35,0xbf80a777,0x3f353f35,0xa70dbf80,0xbf0e3f55,0x3f6dbec4,0xbf7bbe48
.long 0xa6f73f80,0x3ec4bf6d,0xbf353f35,0x3f6dbec4,0x27c2bf80,0xbe483f7b,0x3ec4bf6d,0xbf0e3f55
.long 0x00003f80,0x00003f80,0x00003f80,0x00003f80,0xbf35bf35,0xbf55bf0e,0xbf6dbec4,0xbf7bbe48
.long 0x3f8025b0,0x3f6dbec4,0x3f35bf35,0x3ec4bf6d,0xbf353f35,0xbe483f7b,0x3ec43f6d,0x3f553f0e
.long 0x2630bf80,0xbf35bf35,0xbf80a731,0xbf353f35,0x3f353f35,0x3f7bbe48,0x3ec4bf6d,0xbf0ebf55
.long 0xbf80a742,0xbec43f6d,0x3f353f35,0x3f6dbec4,0x3f35bf35,0xbf0ebf55,0xbf6d3ec4,0x3e483f7b
.long 0xa6b03f80,0x3f80a60d,0x27b1bf80,0xbf80a765,0xbf35bf35,0xbf0e3f55,0x3f6d3ec4,0x3e48bf7b
.long 0x3f80a58e,0xbec4bf6d,0xbf353f35,0x3f6d3ec4,0xbf353f35,0x3f7b3e48,0xbec4bf6d,0xbf0e3f55
.long 0x27c2bf80,0xbf353f35,0x3f80258d,0xbf35bf35,0x3f353f35,0xbe48bf7b,0xbec43f6d,0x3f55bf0e
.long 0xbf80a78d,0x3f6d3ec4,0xbf35bf35,0x3ec43f6d,0x3f35bf35,0xbf553f0e,0x3f6dbec4,0xbf7b3e48
.long 0x00003f80,0x00003f80,0x00003f80,0x00003f80,0xbf80a554,0xbf7b3e48,0xbf6d3ec4,0xbf553f0e
.long 0x25d4bf80,0xbec4bf6d,0xbf35bf35,0xbf6dbec4,0x3f80261f,0x3f55bf0e,0x3ec4bf6d,0xbe48bf7b
.long 0xa6543f80,0x3f353f35,0x3f80a68d,0x3f35bf35,0xbf80a742,0xbf0e3f55,0x3ec43f6d,0x3f7b3e48
.long 0x269fbf80,0xbf6dbec4,0xbf353f35,0x3ec43f6d,0x3f80a60d,0x3e48bf7b,0xbf6dbec4,0xbf0e3f55
.long 0xa6d43f80,0x3f80a58e,0xa70dbf80,0xbf80a777,0xbf80a777,0x3e483f7b,0x3f6dbec4,0xbf0ebf55
.long 0x27c2bf80,0xbf6d3ec4,0x3f353f35,0x3ec4bf6d,0x3f80258d,0xbf0ebf55,0xbec43f6d,0x3f7bbe48
.long 0xa71f3f80,0x3f35bf35,0xbf80a796,0x3f353f35,0xbf80a796,0x3f553f0e,0xbec4bf6d,0xbe483f7b
.long 0xa68dbf80,0xbec43f6d,0x3f35bf35,0xbf6d3ec4,0x3f80268d,0xbf7bbe48,0x3f6d3ec4,0xbf55bf0e
.long 0x00003f80,0x00003f80,0x00003f80,0x00003f80,0xbf353f35,0xbf0e3f55,0xbec43f6d,0xbe483f7b
.long 0xbf80a5f7,0xbf6d3ec4,0xbf353f35,0xbec43f6d,0xbf35bf35,0xbf7bbe48,0xbf6d3ec4,0xbf0e3f55
.long 0x2677bf80,0xbf35bf35,0xbf80a742,0xbf353f35,0x3f35bf35,0xbe48bf7b,0xbf6dbec4,0xbf553f0e
.long 0x3f80a60d,0x3ec4bf6d,0xbf35bf35,0xbf6d3ec4,0x3f353f35,0x3f55bf0e,0xbec4bf6d,0xbf7b3e48
.long 0xa6f73f80,0x3f80a137,0x27c2bf80,0xbf80a784,0xbf353f35,0x3f553f0e,0x3ec4bf6d,0xbf7bbe48
.long 0xbf80a78d,0x3ec43f6d,0x3f35bf35,0xbf6dbec4,0xbf35bf35,0xbe483f7b,0x3f6dbec4,0xbf55bf0e
.long 0xa68dbf80,0xbf353f35,0x3f80268d,0xbf35bf35,0x3f35bf35,0xbf7b3e48,0x3f6d3ec4,0xbf0ebf55
.long 0x3f802816,0xbf6dbec4,0x3f353f35,0xbec4bf6d,0x3f353f35,0xbf0ebf55,0x3ec43f6d,0xbe48bf7b
.long 0x3f808000,0x3f808000,0x3f808000,0x3f808000,0x3f808000,0x3f7bbe48,0x3f6dbec4,0x3f55bf0e
.long 0x3f808000,0x3f6dbec4,0x3f35bf35,0x3ec4bf6d,0x3f808000,0x3f55bf0e,0x3ec4bf6d,0xbe48bf7b
.long 0x3f808000,0x3f35bf35,0x248dbf80,0xbf35bf35,0x3f808000,0x3f0ebf55,0xbec4bf6d,0xbf7bbe48
.long 0x3f808000,0x3ec4bf6d,0xbf35bf35,0xbf6d3ec4,0x3f808000,0x3e48bf7b,0xbf6dbec4,0xbf0e3f55
.long 0x3f808000,0x248dbf80,0xbf80a50d,0xa5543f80,0x3f808000,0xbe48bf7b,0xbf6d3ec4,0x3f0e3f55
.long 0x3f808000,0xbec4bf6d,0xbf353f35,0x3f6d3ec4,0x3f808000,0xbf0ebf55,0xbec43f6d,0x3f7bbe48
.long 0x3f808000,0xbf35bf35,0xa5543f80,0x3f35bf35,0x3f808000,0xbf55bf0e,0x3ec43f6d,0x3e48bf7b
.long 0x3f808000,0xbf6dbec4,0x3f353f35,0xbec4bf6d,0x3f808000,0xbf7bbe48,0x3f6d3ec4,0xbf55bf0e
.long 0x3f808000,0x3f808000,0x3f808000,0x3f808000,0x3f35bf35,0x3f0ebf55,0x3ec4bf6d,0x3e48bf7b
.long 0x248dbf80,0xbec4bf6d,0xbf35bf35,0xbf6dbec4,0xbf35bf35,0xbf7bbe48,0xbf6d3ec4,0xbf0e3f55
.long 0xbf80a50d,0xbf353f35,0xa5543f80,0x3f353f35,0xbf353f35,0x3e483f7b,0x3f6d3ec4,0x3f55bf0e
.long 0xa5543f80,0x3f6d3ec4,0x3f35bf35,0xbec4bf6d,0x3f353f35,0x3f55bf0e,0xbec4bf6d,0xbf7b3e48
.long 0x3f80258d,0x25b0bf80,0xbf80a5d4,0xa5f73f80,0x3f35bf35,0xbf55bf0e,0xbec43f6d,0x3f7b3e48
.long 0x25b0bf80,0xbf6d3ec4,0x3f353f35,0x3ec4bf6d,0xbf35bf35,0xbe483f7b,0x3f6dbec4,0xbf55bf0e
.long 0xbf80a5d4,0x3f353f35,0x261fbf80,0xbf353f35,0xbf353f35,0x3f7bbe48,0xbf6dbec4,0x3f0e3f55
.long 0xa5f73f80,0x3ec4bf6d,0xbf353f35,0x3f6dbec4,0x3f353f35,0xbf0ebf55,0x3ec43f6d,0xbe48bf7b
.long 0x3f808000,0x3f808000,0x3f808000,0x3f808000,0x248dbf80,0xbe48bf7b,0xbec4bf6d,0xbf0ebf55
.long 0xbf80a50d,0xbf6d3ec4,0xbf353f35,0xbec43f6d,0xa5543f80,0x3f0e3f55,0x3f6d3ec4,0x3f7bbe48
.long 0x3f80258d,0x3f35bf35,0x25b0bf80,0xbf35bf35,0x25b0bf80,0xbf55bf0e,0xbf6d3ec4,0xbe483f7b
.long 0xbf80a5d4,0xbec43f6d,0x3f353f35,0x3f6dbec4,0xa5f73f80,0x3f7b3e48,0x3ec4bf6d,0xbf55bf0e
.long 0x3f80260d,0x261fbf80,0xbf80a630,0xa7313f80,0x261fbf80,0xbf7b3e48,0x3ec43f6d,0x3f55bf0e
.long 0xbf80a630,0x3ec43f6d,0x3f35bf35,0xbf6dbec4,0xa7313f80,0x3f55bf0e,0xbf6dbec4,0x3e483f7b
.long 0x3f802654,0xbf35bf35,0xa7423f80,0x3f35bf35,0xa68dbf80,0xbf0e3f55,0x3f6dbec4,0xbf7bbe48
.long 0xbf80a677,0x3f6d3ec4,0xbf35bf35,0x3ec43f6d,0xa7423f80,0x3e48bf7b,0xbec43f6d,0x3f0ebf55
.long 0x3f808000,0x3f808000,0x3f808000,0x3f808000,0xbf35bf35,0xbf55bf0e,0xbf6dbec4,0xbf7bbe48
.long 0xa5543f80,0x3ec43f6d,0x3f353f35,0x3f6d3ec4,0x3f35bf35,0x3e48bf7b,0xbec4bf6d,0xbf55bf0e
.long 0xbf80a5d4,0xbf353f35,0xa5f73f80,0x3f353f35,0x3f353f35,0x3f7bbe48,0x3ec4bf6d,0xbf0ebf55
.long 0x261fbf80,0xbf6dbec4,0xbf353f35,0x3ec43f6d,0xbf353f35,0x3f0e3f55,0x3f6dbec4,0xbe48bf7b
.long 0x3f802654,0xa68dbf80,0xbf80a677,0xa7423f80,0xbf35bf35,0xbf0e3f55,0x3f6d3ec4,0x3e48bf7b
.long 0xa7423f80,0x3f6dbec4,0xbf35bf35,0xbec43f6d,0x3f35bf35,0xbf7bbe48,0x3ec43f6d,0x3f0ebf55
.long 0xbf80a69f,0x3f353f35,0xa60dbf80,0xbf353f35,0x3f353f35,0xbe48bf7b,0xbec43f6d,0x3f55bf0e
.long 0xa60dbf80,0xbec43f6d,0x3f35bf35,0xbf6d3ec4,0xbf353f35,0x3f55bf0e,0xbf6d3ec4,0x3f7bbe48
.long 0x3f808000,0x3f808000,0x3f808000,0x3f808000,0xbf80a50d,0xbf7b3e48,0xbf6d3ec4,0xbf553f0e
.long 0x3f80258d,0x3f6dbec4,0x3f35bf35,0x3ec4bf6d,0xbf80a5d4,0xbf553f0e,0xbec43f6d,0x3e483f7b
.long 0x3f80260d,0x3f35bf35,0x261fbf80,0xbf35bf35,0xbf80a630,0xbf0e3f55,0x3ec43f6d,0x3f7b3e48
.long 0x3f802654,0x3ec4bf6d,0xbf35bf35,0xbf6d3ec4,0xbf80a677,0xbe483f7b,0x3f6d3ec4,0x3f0ebf55
.long 0x3f80268d,0xa654bf80,0xbf80a69f,0xa7543f80,0xbf80a69f,0x3e483f7b,0x3f6dbec4,0xbf0ebf55
.long 0x3f8026b0,0xbec4bf6d,0xbf353f35,0x3f6d3ec4,0xbf80a7b1,0x3f0e3f55,0x3ec4bf6d,0xbf7b3e48
.long 0x3f8026d4,0xbf35bf35,0xa7773f80,0x3f35bf35,0xbf80270d,0x3f553f0e,0xbec4bf6d,0xbe483f7b
.long 0x3f8026f7,0xbf6dbec4,0x3f353f35,0xbec4bf6d,0xbf80a7c2,0x3f7b3e48,0xbf6dbec4,0x3f553f0e
.long 0x3f808000,0x3f808000,0x3f808000,0x3f808000,0xbf353f35,0xbf0e3f55,0xbec43f6d,0xbe483f7b
.long 0x25b0bf80,0xbec4bf6d,0xbf35bf35,0xbf6dbec4,0x3f353f35,0x3f7b3e48,0x3f6dbec4,0x3f0ebf55
.long 0xbf80a630,0xbf353f35,0xa7313f80,0x3f353f35,0x3f35bf35,0xbe48bf7b,0xbf6dbec4,0xbf553f0e
.long 0xa7423f80,0x3f6d3ec4,0x3f35bf35,0xbec4bf6d,0xbf35bf35,0xbf553f0e,0x3ec43f6d,0x3f7bbe48
.long 0x3f8026b0,0xa60dbf80,0xbf80a7b1,0xa7653f80,0xbf353f35,0x3f553f0e,0x3ec4bf6d,0xbf7bbe48
.long 0xa58ebf80,0xbf6d3ec4,0x3f353f35,0x3ec4bf6d,0x3f353f35,0x3e48bf7b,0xbf6d3ec4,0x3f553f0e
.long 0xbf80a7c2,0x3f353f35,0x258dbf80,0xbf353f35,0x3f35bf35,0xbf7b3e48,0x3f6d3ec4,0xbf0ebf55
.long 0xa78d3f80,0x3ec4bf6d,0xbf353f35,0x3f6dbec4,0xbf35bf35,0x3f0e3f55,0xbec4bf6d,0x3e483f7b
.long 0x3f808000,0x3f808000,0x3f808000,0x3f808000,0xa5543f80,0x3e483f7b,0x3ec43f6d,0x3f0e3f55
.long 0xbf80a5d4,0xbf6d3ec4,0xbf353f35,0xbec43f6d,0x261fbf80,0xbf0ebf55,0xbf6dbec4,0xbf7b3e48
.long 0x3f802654,0x3f35bf35,0xa68dbf80,0xbf35bf35,0xa7423f80,0x3f553f0e,0x3f6dbec4,0x3e48bf7b
.long 0xbf80a69f,0xbec43f6d,0x3f353f35,0x3f6dbec4,0xa60dbf80,0xbf7bbe48,0xbec43f6d,0x3f553f0e
.long 0x3f8026d4,0xa58ebf80,0xbf80270d,0xa7773f80,0xa7773f80,0x3f7bbe48,0xbec4bf6d,0xbf553f0e
.long 0xbf80a7c2,0x3ec43f6d,0x3f35bf35,0xbf6dbec4,0x258dbf80,0xbf553f0e,0x3f6d3ec4,0xbe48bf7b
.long 0x3f80271f,0xbf35bf35,0xa7963f80,0x3f35bf35,0xa7963f80,0x3f0ebf55,0xbf6d3ec4,0x3f7b3e48
.long 0xbf80268d,0x3f6d3ec4,0xbf35bf35,0x3ec43f6d,0x268dbf80,0xbe483f7b,0x3ec4bf6d,0xbf0e3f55
.long 0x3f808000,0x3f808000,0x3f808000,0x3f808000,0x3f353f35,0x3f553f0e,0x3f6d3ec4,0x3f7b3e48
.long 0xa5f73f80,0x3ec43f6d,0x3f353f35,0x3f6d3ec4,0xbf353f35,0xbe483f7b,0x3ec43f6d,0x3f553f0e
.long 0xbf80a677,0xbf353f35,0xa7423f80,0x3f353f35,0xbf35bf35,0xbf7b3e48,0xbec43f6d,0x3f0e3f55
.long 0xa60dbf80,0xbf6dbec4,0xbf353f35,0x3ec43f6d,0x3f35bf35,0xbf0ebf55,0xbf6d3ec4,0x3e483f7b
.long 0x3f8026f7,0xa137bf80,0xbf80a7c2,0xa7843f80,0x3f353f35,0x3f0ebf55,0xbf6dbec4,0xbe483f7b
.long 0xa78d3f80,0x3f6dbec4,0xbf35bf35,0xbec43f6d,0xbf353f35,0x3f7b3e48,0xbec4bf6d,0xbf0e3f55
.long 0xbf80268d,0x3f353f35,0x268dbf80,0xbf353f35,0xbf35bf35,0x3e483f7b,0x3ec4bf6d,0xbf553f0e
.long 0x2816bf80,0xbec43f6d,0x3f35bf35,0xbf6d3ec4,0x3f35bf35,0xbf553f0e,0x3f6dbec4,0xbf7b3e48
.long 0x3f800000,0x3f7ec46d,0x3f7b14be,0x3f74fa0b,0x3f800000,0x3f7ec46d,0x3f7b14be,0x3f74fa0b
.long 0x3f800000,0x3f7ec46d,0x3f7b14be,0x3f74fa0b,0x3f800000,0x3f7ec46d,0x3f7b14be,0x3f74fa0b
.long 0x3f800000,0x3f7ec46d,0x3f7b14be,0x3f74fa0b,0x3f800000,0x3f7ec46d,0x3f7b14be,0x3f74fa0b
.long 0x3f800000,0x3f7ec46d,0x3f7b14be,0x3f74fa0b,0x3f800000,0x3f7ec46d,0x3f7b14be,0x3f74fa0b
.long 0x3f800000,0x3f7ec46d,0x3f7b14be,0x3f74fa0b,0x3f800000,0x3f7ec46d,0x3f7b14be,0x3f74fa0b
.long 0x3f800000,0x3f7ec46d,0x3f7b14be,0x3f74fa0b,0x3f800000,0x3f7ec46d,0x3f7b14be,0x3f74fa0b
.long 0x3f800000,0x3f7ec46d,0x3f7b14be,0x3f74fa0b,0x3f800000,0x3f7ec46d,0x3f7b14be,0x3f74fa0b
.long 0x3f800000,0x3f7ec46d,0x3f7b14be,0x3f74fa0b,0x3f800000,0x3f7ec46d,0x3f7b14be,0x3f74fa0b
.long 0x3f6c835e,0x3f61c598,0x3f54db31,0x3f45e403,0x3f6c835e,0x3f61c598,0x3f54db31,0x3f45e403
.long 0x3f6c835e,0x3f61c598,0x3f54db31,0x3f45e403,0x3f6c835e,0x3f61c598,0x3f54db31,0x3f45e403
.long 0x3f6c835e,0x3f61c598,0x3f54db31,0x3f45e403,0x3f6c835e,0x3f61c598,0x3f54db31,0x3f45e403
.long 0x3f6c835e,0x3f61c598,0x3f54db31,0x3f45e403,0x3f6c835e,0x3f61c598,0x3f54db31,0x3f45e403
.long 0x3f6c835e,0x3f61c598,0x3f54db31,0x3f45e403,0x3f6c835e,0x3f61c598,0x3f54db31,0x3f45e403
.long 0x3f6c835e,0x3f61c598,0x3f54db31,0x3f45e403,0x3f6c835e,0x3f61c598,0x3f54db31,0x3f45e403
.long 0x3f6c835e,0x3f61c598,0x3f54db31,0x3f45e403,0x3f6c835e,0x3f61c598,0x3f54db31,0x3f45e403
.long 0x3f6c835e,0x3f61c598,0x3f54db31,0x3f45e403,0x3f6c835e,0x3f61c598,0x3f54db31,0x3f45e403
.long 0x3f3504f3,0x3f226799,0x3f0e39da,0x3ef15aea,0x3f3504f3,0x3f226799,0x3f0e39da,0x3ef15aea
.long 0x3f3504f3,0x3f226799,0x3f0e39da,0x3ef15aea,0x3f3504f3,0x3f226799,0x3f0e39da,0x3ef15aea
.long 0x3f3504f3,0x3f226799,0x3f0e39da,0x3ef15aea,0x3f3504f3,0x3f226799,0x3f0e39da,0x3ef15aea
.long 0x3f3504f3,0x3f226799,0x3f0e39da,0x3ef15aea,0x3f3504f3,0x3f226799,0x3f0e39da,0x3ef15aea
.long 0x3f3504f3,0x3f226799,0x3f0e39da,0x3ef15aea,0x3f3504f3,0x3f226799,0x3f0e39da,0x3ef15aea
.long 0x3f3504f3,0x3f226799,0x3f0e39da,0x3ef15aea,0x3f3504f3,0x3f226799,0x3f0e39da,0x3ef15aea
.long 0x3f3504f3,0x3f226799,0x3f0e39da,0x3ef15aea,0x3f3504f3,0x3f226799,0x3f0e39da,0x3ef15aea
.long 0x3f3504f3,0x3f226799,0x3f0e39da,0x3ef15aea,0x3f3504f3,0x3f226799,0x3f0e39da,0x3ef15aea
.long 0x3ec3ef15,0x3e94a031,0x3e47c5c2,0x3dc8bd36,0x3ec3ef15,0x3e94a031,0x3e47c5c2,0x3dc8bd36
.long 0x3ec3ef15,0x3e94a031,0x3e47c5c2,0x3dc8bd36,0x3ec3ef15,0x3e94a031,0x3e47c5c2,0x3dc8bd36
.long 0x3ec3ef15,0x3e94a031,0x3e47c5c2,0x3dc8bd36,0x3ec3ef15,0x3e94a031,0x3e47c5c2,0x3dc8bd36
.long 0x3ec3ef15,0x3e94a031,0x3e47c5c2,0x3dc8bd36,0x3ec3ef15,0x3e94a031,0x3e47c5c2,0x3dc8bd36
.long 0x3ec3ef15,0x3e94a031,0x3e47c5c2,0x3dc8bd36,0x3ec3ef15,0x3e94a031,0x3e47c5c2,0x3dc8bd36
.long 0x3ec3ef15,0x3e94a031,0x3e47c5c2,0x3dc8bd36,0x3ec3ef15,0x3e94a031,0x3e47c5c2,0x3dc8bd36
.long 0x3ec3ef15,0x3e94a031,0x3e47c5c2,0x3dc8bd36,0x3ec3ef15,0x3e94a031,0x3e47c5c2,0x3dc8bd36
.long 0x3ec3ef15,0x3e94a031,0x3e47c5c2,0x3dc8bd36,0x3ec3ef15,0x3e94a031,0x3e47c5c2,0x3dc8bd36
.long 0x248d3132,0xbdc8bd36,0xbe47c5c2,0xbe94a031,0x248d3132,0xbdc8bd36,0xbe47c5c2,0xbe94a031
.long 0x248d3132,0xbdc8bd36,0xbe47c5c2,0xbe94a031,0x248d3132,0xbdc8bd36,0xbe47c5c2,0xbe94a031
.long 0x248d3132,0xbdc8bd36,0xbe47c5c2,0xbe94a031,0x248d3132,0xbdc8bd36,0xbe47c5c2,0xbe94a031
.long 0x248d3132,0xbdc8bd36,0xbe47c5c2,0xbe94a031,0x248d3132,0xbdc8bd36,0xbe47c5c2,0xbe94a031
.long 0x248d3132,0xbdc8bd36,0xbe47c5c2,0xbe94a031,0x248d3132,0xbdc8bd36,0xbe47c5c2,0xbe94a031
.long 0x248d3132,0xbdc8bd36,0xbe47c5c2,0xbe94a031,0x248d3132,0xbdc8bd36,0xbe47c5c2,0xbe94a031
.long 0x248d3132,0xbdc8bd36,0xbe47c5c2,0xbe94a031,0x248d3132,0xbdc8bd36,0xbe47c5c2,0xbe94a031
.long 0x248d3132,0xbdc8bd36,0xbe47c5c2,0xbe94a031,0x248d3132,0xbdc8bd36,0xbe47c5c2,0xbe94a031
.long 0xbec3ef15,0xbef15aea,0xbf0e39da,0xbf226799,0xbec3ef15,0xbef15aea,0xbf0e39da,0xbf226799
.long 0xbec3ef15,0xbef15aea,0xbf0e39da,0xbf226799,0xbec3ef15,0xbef15aea,0xbf0e39da,0xbf226799
.long 0xbec3ef15,0xbef15aea,0xbf0e39da,0xbf226799,0xbec3ef15,0xbef15aea,0xbf0e39da,0xbf226799
.long 0xbec3ef15,0xbef15aea,0xbf0e39da,0xbf226799,0xbec3ef15,0xbef15aea,0xbf0e39da,0xbf226799
.long 0xbec3ef15,0xbef15aea,0xbf0e39da,0xbf226799,0xbec3ef15,0xbef15aea,0xbf0e39da,0xbf226799
.long 0xbec3ef15,0xbef15aea,0xbf0e39da,0xbf226799,0xbec3ef15,0xbef15aea,0xbf0e39da,0xbf226799
.long 0xbec3ef15,0xbef15aea,0xbf0e39da,0xbf226799,0xbec3ef15,0xbef15aea,0xbf0e39da,0xbf226799
.long 0xbec3ef15,0xbef15aea,0xbf0e39da,0xbf226799,0xbec3ef15,0xbef15aea,0xbf0e39da,0xbf226799
.long 0xbf3504f3,0xbf45e403,0xbf54db31,0xbf61c598,0xbf3504f3,0xbf45e403,0xbf54db31,0xbf61c598
.long 0xbf3504f3,0xbf45e403,0xbf54db31,0xbf61c598,0xbf3504f3,0xbf45e403,0xbf54db31,0xbf61c598
.long 0xbf3504f3,0xbf45e403,0xbf54db31,0xbf61c598,0xbf3504f3,0xbf45e403,0xbf54db31,0xbf61c598
.long 0xbf3504f3,0xbf45e403,0xbf54db31,0xbf61c598,0xbf3504f3,0xbf45e403,0xbf54db31,0xbf61c598
.long 0xbf3504f3,0xbf45e403,0xbf54db31,0xbf61c598,0xbf3504f3,0xbf45e403,0xbf54db31,0xbf61c598
.long 0xbf3504f3,0xbf45e403,0xbf54db31,0xbf61c598,0xbf3504f3,0xbf45e403,0xbf54db31,0xbf61c598
.long 0xbf3504f3,0xbf45e403,0xbf54db31,0xbf61c598,0xbf3504f3,0xbf45e403,0xbf54db31,0xbf61c598
.long 0xbf3504f3,0xbf45e403,0xbf54db31,0xbf61c598,0xbf3504f3,0xbf45e403,0xbf54db31,0xbf61c598
.long 0xbf6c835e,0xbf74fa0b,0xbf7b14be,0xbf7ec46d,0xbf6c835e,0xbf74fa0b,0xbf7b14be,0xbf7ec46d
.long 0xbf6c835e,0xbf74fa0b,0xbf7b14be,0xbf7ec46d,0xbf6c835e,0xbf74fa0b,0xbf7b14be,0xbf7ec46d
.long 0xbf6c835e,0xbf74fa0b,0xbf7b14be,0xbf7ec46d,0xbf6c835e,0xbf74fa0b,0xbf7b14be,0xbf7ec46d
.long 0xbf6c835e,0xbf74fa0b,0xbf7b14be,0xbf7ec46d,0xbf6c835e,0xbf74fa0b,0xbf7b14be,0xbf7ec46d
.long 0xbf6c835e,0xbf74fa0b,0xbf7b14be,0xbf7ec46d,0xbf6c835e,0xbf74fa0b,0xbf7b14be,0xbf7ec46d
.long 0xbf6c835e,0xbf74fa0b,0xbf7b14be,0xbf7ec46d,0xbf6c835e,0xbf74fa0b,0xbf7b14be,0xbf7ec46d
.long 0xbf6c835e,0xbf74fa0b,0xbf7b14be,0xbf7ec46d,0xbf6c835e,0xbf74fa0b,0xbf7b14be,0xbf7ec46d
.long 0xbf6c835e,0xbf74fa0b,0xbf7b14be,0xbf7ec46d,0xbf6c835e,0xbf74fa0b,0xbf7b14be,0xbf7ec46d
.long 0x00000000,0x3dc8bd36,0x3e47c5c2,0x3e94a031,0x00000000,0x3dc8bd36,0x3e47c5c2,0x3e94a031
.long 0x00000000,0x3dc8bd36,0x3e47c5c2,0x3e94a031,0x00000000,0x3dc8bd36,0x3e47c5c2,0x3e94a031
.long 0x00000000,0x3dc8bd36,0x3e47c5c2,0x3e94a031,0x00000000,0x3dc8bd36,0x3e47c5c2,0x3e94a031
.long 0x00000000,0x3dc8bd36,0x3e47c5c2,0x3e94a031,0x00000000,0x3dc8bd36,0x3e47c5c2,0x3e94a031
.long 0x00000000,0x3dc8bd36,0x3e47c5c2,0x3e94a031,0x00000000,0x3dc8bd36,0x3e47c5c2,0x3e94a031
.long 0x00000000,0x3dc8bd36,0x3e47c5c2,0x3e94a031,0x00000000,0x3dc8bd36,0x3e47c5c2,0x3e94a031
.long 0x00000000,0x3dc8bd36,0x3e47c5c2,0x3e94a031,0x00000000,0x3dc8bd36,0x3e47c5c2,0x3e94a031
.long 0x00000000,0x3dc8bd36,0x3e47c5c2,0x3e94a031,0x00000000,0x3dc8bd36,0x3e47c5c2,0x3e94a031
.long 0x3ec3ef15,0x3ef15aea,0x3f0e39da,0x3f226799,0x3ec3ef15,0x3ef15aea,0x3f0e39da,0x3f226799
.long 0x3ec3ef15,0x3ef15aea,0x3f0e39da,0x3f226799,0x3ec3ef15,0x3ef15aea,0x3f0e39da,0x3f226799
.long 0x3ec3ef15,0x3ef15aea,0x3f0e39da,0x3f226799,0x3ec3ef15,0x3ef15aea,0x3f0e39da,0x3f226799
.long 0x3ec3ef15,0x3ef15aea,0x3f0e39da,0x3f226799,0x3ec3ef15,0x3ef15aea,0x3f0e39da,0x3f226799
.long 0x3ec3ef15,0x3ef15aea,0x3f0e39da,0x3f226799,0x3ec3ef15,0x3ef15aea,0x3f0e39da,0x3f226799
.long 0x3ec3ef15,0x3ef15aea,0x3f0e39da,0x3f226799,0x3ec3ef15,0x3ef15aea,0x3f0e39da,0x3f226799
.long 0x3ec3ef15,0x3ef15aea,0x3f0e39da,0x3f226799,0x3ec3ef15,0x3ef15aea,0x3f0e39da,0x3f226799
.long 0x3ec3ef15,0x3ef15aea,0x3f0e39da,0x3f226799,0x3ec3ef15,0x3ef15aea,0x3f0e39da,0x3f226799
.long 0x3f3504f3,0x3f45e403,0x3f54db31,0x3f61c598,0x3f3504f3,0x3f45e403,0x3f54db31,0x3f61c598
.long 0x3f3504f3,0x3f45e403,0x3f54db31,0x3f61c598,0x3f3504f3,0x3f45e403,0x3f54db31,0x3f61c598
.long 0x3f3504f3,0x3f45e403,0x3f54db31,0x3f61c598,0x3f3504f3,0x3f45e403,0x3f54db31,0x3f61c598
.long 0x3f3504f3,0x3f45e403,0x3f54db31,0x3f61c598,0x3f3504f3,0x3f45e403,0x3f54db31,0x3f61c598
.long 0x3f3504f3,0x3f45e403,0x3f54db31,0x3f61c598,0x3f3504f3,0x3f45e403,0x3f54db31,0x3f61c598
.long 0x3f3504f3,0x3f45e403,0x3f54db31,0x3f61c598,0x3f3504f3,0x3f45e403,0x3f54db31,0x3f61c598
.long 0x3f3504f3,0x3f45e403,0x3f54db31,0x3f61c598,0x3f3504f3,0x3f45e403,0x3f54db31,0x3f61c598
.long 0x3f3504f3,0x3f45e403,0x3f54db31,0x3f61c598,0x3f3504f3,0x3f45e403,0x3f54db31,0x3f61c598
.long 0x3f6c835e,0x3f74fa0b,0x3f7b14be,0x3f7ec46d,0x3f6c835e,0x3f74fa0b,0x3f7b14be,0x3f7ec46d
.long 0x3f6c835e,0x3f74fa0b,0x3f7b14be,0x3f7ec46d,0x3f6c835e,0x3f74fa0b,0x3f7b14be,0x3f7ec46d
.long 0x3f6c835e,0x3f74fa0b,0x3f7b14be,0x3f7ec46d,0x3f6c835e,0x3f74fa0b,0x3f7b14be,0x3f7ec46d
.long 0x3f6c835e,0x3f74fa0b,0x3f7b14be,0x3f7ec46d,0x3f6c835e,0x3f74fa0b,0x3f7b14be,0x3f7ec46d
.long 0x3f6c835e,0x3f74fa0b,0x3f7b14be,0x3f7ec46d,0x3f6c835e,0x3f74fa0b,0x3f7b14be,0x3f7ec46d
.long 0x3f6c835e,0x3f74fa0b,0x3f7b14be,0x3f7ec46d,0x3f6c835e,0x3f74fa0b,0x3f7b14be,0x3f7ec46d
.long 0x3f6c835e,0x3f74fa0b,0x3f7b14be,0x3f7ec46d,0x3f6c835e,0x3f74fa0b,0x3f7b14be,0x3f7ec46d
.long 0x3f6c835e,0x3f74fa0b,0x3f7b14be,0x3f7ec46d,0x3f6c835e,0x3f74fa0b,0x3f7b14be,0x3f7ec46d
.long 0x3f800000,0x3f7ec46d,0x3f7b14be,0x3f74fa0b,0x3f800000,0x3f7ec46d,0x3f7b14be,0x3f74fa0b
.long 0x3f800000,0x3f7ec46d,0x3f7b14be,0x3f74fa0b,0x3f800000,0x3f7ec46d,0x3f7b14be,0x3f74fa0b
.long 0x3f800000,0x3f7ec46d,0x3f7b14be,0x3f74fa0b,0x3f800000,0x3f7ec46d,0x3f7b14be,0x3f74fa0b
.long 0x3f800000,0x3f7ec46d,0x3f7b14be,0x3f74fa0b,0x3f800000,0x3f7ec46d,0x3f7b14be,0x3f74fa0b
.long 0x3f800000,0x3f7ec46d,0x3f7b14be,0x3f74fa0b,0x3f800000,0x3f7ec46d,0x3f7b14be,0x3f74fa0b
.long 0x3f800000,0x3f7ec46d,0x3f7b14be,0x3f74fa0b,0x3f800000,0x3f7ec46d,0x3f7b14be,0x3f74fa0b
.long 0x3f800000,0x3f7ec46d,0x3f7b14be,0x3f74fa0b,0x3f800000,0x3f7ec46d,0x3f7b14be,0x3f74fa0b
.long 0x3f800000,0x3f7ec46d,0x3f7b14be,0x3f74fa0b,0x3f800000,0x3f7ec46d,0x3f7b14be,0x3f74fa0b
.long 0x3f6c835e,0x3f61c598,0x3f54db31,0x3f45e403,0x3f6c835e,0x3f61c598,0x3f54db31,0x3f45e403
.long 0x3f6c835e,0x3f61c598,0x3f54db31,0x3f45e403,0x3f6c835e,0x3f61c598,0x3f54db31,0x3f45e403
.long 0x3f6c835e,0x3f61c598,0x3f54db31,0x3f45e403,0x3f6c835e,0x3f61c598,0x3f54db31,0x3f45e403
.long 0x3f6c835e,0x3f61c598,0x3f54db31,0x3f45e403,0x3f6c835e,0x3f61c598,0x3f54db31,0x3f45e403
.long 0x3f6c835e,0x3f61c598,0x3f54db31,0x3f45e403,0x3f6c835e,0x3f61c598,0x3f54db31,0x3f45e403
.long 0x3f6c835e,0x3f61c598,0x3f54db31,0x3f45e403,0x3f6c835e,0x3f61c598,0x3f54db31,0x3f45e403
.long 0x3f6c835e,0x3f61c598,0x3f54db31,0x3f45e403,0x3f6c835e,0x3f61c598,0x3f54db31,0x3f45e403
.long 0x3f6c835e,0x3f61c598,0x3f54db31,0x3f45e403,0x3f6c835e,0x3f61c598,0x3f54db31,0x3f45e403
.long 0x3f3504f3,0x3f226799,0x3f0e39da,0x3ef15aea,0x3f3504f3,0x3f226799,0x3f0e39da,0x3ef15aea
.long 0x3f3504f3,0x3f226799,0x3f0e39da,0x3ef15aea,0x3f3504f3,0x3f226799,0x3f0e39da,0x3ef15aea
.long 0x3f3504f3,0x3f226799,0x3f0e39da,0x3ef15aea,0x3f3504f3,0x3f226799,0x3f0e39da,0x3ef15aea
.long 0x3f3504f3,0x3f226799,0x3f0e39da,0x3ef15aea,0x3f3504f3,0x3f226799,0x3f0e39da,0x3ef15aea
.long 0x3f3504f3,0x3f226799,0x3f0e39da,0x3ef15aea,0x3f3504f3,0x3f226799,0x3f0e39da,0x3ef15aea
.long 0x3f3504f3,0x3f226799,0x3f0e39da,0x3ef15aea,0x3f3504f3,0x3f226799,0x3f0e39da,0x3ef15aea
.long 0x3f3504f3,0x3f226799,0x3f0e39da,0x3ef15aea,0x3f3504f3,0x3f226799,0x3f0e39da,0x3ef15aea
.long 0x3f3504f3,0x3f226799,0x3f0e39da,0x3ef15aea,0x3f3504f3,0x3f226799,0x3f0e39da,0x3ef15aea
.long 0x3ec3ef15,0x3e94a031,0x3e47c5c2,0x3dc8bd36,0x3ec3ef15,0x3e94a031,0x3e47c5c2,0x3dc8bd36
.long 0x3ec3ef15,0x3e94a031,0x3e47c5c2,0x3dc8bd36,0x3ec3ef15,0x3e94a031,0x3e47c5c2,0x3dc8bd36
.long 0x3ec3ef15,0x3e94a031,0x3e47c5c2,0x3dc8bd36,0x3ec3ef15,0x3e94a031,0x3e47c5c2,0x3dc8bd36
.long 0x3ec3ef15,0x3e94a031,0x3e47c5c2,0x3dc8bd36,0x3ec3ef15,0x3e94a031,0x3e47c5c2,0x3dc8bd36
.long 0x3ec3ef15,0x3e94a031,0x3e47c5c2,0x3dc8bd36,0x3ec3ef15,0x3e94a031,0x3e47c5c2,0x3dc8bd36
.long 0x3ec3ef15,0x3e94a031,0x3e47c5c2,0x3dc8bd36,0x3ec3ef15,0x3e94a031,0x3e47c5c2,0x3dc8bd36
.long 0x3ec3ef15,0x3e94a031,0x3e47c5c2,0x3dc8bd36,0x3ec3ef15,0x3e94a031,0x3e47c5c2,0x3dc8bd36
.long 0x3ec3ef15,0x3e94a031,0x3e47c5c2,0x3dc8bd36,0x3ec3ef15,0x3e94a031,0x3e47c5c2,0x3dc8bd36
.size TABLE, 24576
.section .rodata,"a"
.p2align 6
.amdhsa_kernel concat_heads__linear_attn_block__spectral_gfnet__prompt_kernel
  .amdhsa_next_free_vgpr 256
  .amdhsa_next_free_sgpr 72
  .amdhsa_accum_offset 256
  .amdhsa_group_segment_fixed_size 0
  .amdhsa_kernarg_size 72
  .amdhsa_user_sgpr_count 2
  .amdhsa_user_sgpr_kernarg_segment_ptr 1
  .amdhsa_system_sgpr_workgroup_id_x 1
  .amdhsa_float_denorm_mode_32 3
.end_amdhsa_kernel
```
